```python
import torch

def _softmax(x, axis=-1):
    return torch.softmax(x, dim=axis)
def _gelu(x):
    return torch.nn.functional.gelu(x, approximate="tanh")
def _silu(x):
    return torch.nn.functional.silu(x)
def _sigmoid(x):
    return torch.sigmoid(x)
def _layernorm(x, axis=-1, eps=1e-5):
    m = x.mean(dim=axis, keepdim=True)
    v = x.var(dim=axis, keepdim=True, unbiased=False)
    return (x - m) / torch.sqrt(v + eps)
def _scatter_add(tgt, idx, src, axis=0):
    return tgt.clone().index_add_(axis, idx, src)
def _segment_sum(src, seg, n):
    out = torch.zeros((n,) + src.shape[1:], dtype=src.dtype)
    return out.index_add_(0, seg, src)
def _pad(x, pw):
    flat = tuple(v for pair in reversed(pw) for v in pair)
    return torch.nn.functional.pad(x, flat)

kernel_name = 'standalone__gqa_block_cached__near_ridge'

def setup_inputs():

    _w = (lambda a: (lambda t: t.to(torch.bfloat16) if t.is_floating_point() else t)(torch.as_tensor(a)))
    B, Sq, D = 8, 192, 640
    Hq, Hkv, Sk, Dh = 32, 32, 2048, 128
    assert Hq % Hkv == 0, (Hq, Hkv)
    return {
        "x": _w((lambda *s: torch.randn(*s, dtype=torch.bfloat16) * 0.8)(B, Sq, D)),
        "k_cache": _w((lambda *s: torch.randn(*s, dtype=torch.bfloat16) * 0.8)(B, Hkv, Sk, Dh)),
        "v_cache": _w((lambda *s: torch.randn(*s, dtype=torch.bfloat16) * 0.05)(B, Hkv, Sk, Dh)),
        "wq": _w((lambda *s: torch.randn(*s, dtype=torch.bfloat16) * 0.8)(D, Hq * Dh) * (D ** -0.5)),
        "wo": _w((lambda *s: torch.randn(*s, dtype=torch.bfloat16) * 0.05)(Hq * Dh, D) * ((Hq * Dh) ** -0.5)),
    }

def reference(x, k_cache, v_cache, wq, wo):
    B, Sq, D = x.shape
    Hq, Dh = 32, 128
    Hkv = k_cache.shape[1]
    rep = Hq // Hkv
    q = (lambda x, *d: x.permute(*d))((x @ wq).reshape(B, Sq, Hq, Dh), 0, 2, 1, 3)
    k = (lambda x, n, axis: torch.repeat_interleave(x, n, dim=axis))(k_cache, rep, axis=1)
    v = (lambda x, n, axis: torch.repeat_interleave(x, n, dim=axis))(v_cache, rep, axis=1)
    scores = torch.einsum("bhqd,bhkd->bhqk", q, k) * (Dh ** -0.5)
    p = _softmax(scores, axis=-1)
    o = torch.einsum("bhqk,bhkd->bhqd", p, v)
    return (lambda x, *d: x.permute(*d))(o, 0, 2, 1, 3).reshape(B, Sq, Hq * Dh) @ wo
```

```asm
; @launch kernel=attn_kernel grid=(256,1,1) block=(256,1,1) lds=163840
.amdgcn_target "amdgcn-amd-amdhsa--gfx950"
.text
.p2align 8
.globl attn_kernel
.type attn_kernel,@function
attn_kernel:
    s_cmp_ge_u32 s2, 256
    s_cbranch_scc1 L1_end
    s_load_dwordx8 s[4:11], s[0:1], 0
    s_load_dwordx2 s[12:13], s[0:1], 56
    s_load_dwordx4 s[56:59], s[0:1], 32
    s_load_dwordx2 s[28:29], s[0:1], 48
    v_lshrrev_b32 v1, 6, v0
    v_and_b32 v253, 63, v0
    s_and_b32 s45, s2, 7
    v_readfirstlane_b32 s32, v1
    s_lshr_b32 s46, s2, 3
    s_and_b32 s33, s45, 1
    s_lshl_b32 s33, s33, 2
    s_and_b32 s3, s46, 3
    s_or_b32 s33, s33, s3
    s_lshr_b32 s34, s45, 1
    s_lshl_b32 s34, s34, 3
    s_lshr_b32 s3, s46, 2
    s_or_b32 s34, s34, s3
    s_and_b32 s42, s34, 7
    s_mul_i32 s42, s42, 5
    s_add_u32 s42, s42, 2
    s_lshr_b32 s42, s42, 2
    s_and_b32 s3, s33, 3
    s_mul_i32 s3, s3, 5
    s_add_u32 s3, s3, 1
    s_lshr_b32 s3, s3, 1
    s_add_u32 s42, s42, s3
    s_cmp_ge_u32 s42, 10
    s_cselect_b32 s3, 10, 0
    s_sub_u32 s42, s42, s3
    v_lshrrev_b32 v1, 4, v253
    v_and_b32 v2, 15, v253
    v_lshlrev_b32 v3, 12, v1
    v_lshl_or_b32 v212, v2, 4, v3
    v_lshlrev_b32 v3, 17, v1
    v_lshl_or_b32 v219, v2, 4, v3
    v_lshrrev_b32 v3, 3, v253
    v_and_b32 v4, 7, v253
    v_mul_u32_u24 v3, 5120, v3
    v_lshl_add_u32 v218, v4, 4, v3
    s_lshr_b32 s52, s32, 1
    s_and_b32 s53, s32, 1
    s_mul_i32 s48, s32, 6176
    s_mul_i32 s50, s32, 1280
    s_mul_i32 s49, s32, 4224
    s_lshl_b32 s51, s53, 3
    s_lshl_b32 s3, s52, 2
    s_or_b32 s51, s51, s3
    s_lshl_b32 s51, s51, 13
    s_lshl_b32 s40, s32, 10
    s_mov_b32 s41, s49
    s_lshl_b32 s45, s33, 5
    s_add_u32 s45, s45, s34
    s_lshl_b32 s46, s45, 19
    s_lshr_b32 s45, s45, 13
    s_waitcnt lgkmcnt(0)
    s_add_u32 s16, s6, s46
    s_addc_u32 s17, s7, s45
    s_mov_b32 s18, 524288
    s_mov_b32 s19, 0x20000
    s_add_u32 s20, s8, s46
    s_addc_u32 s21, s9, s45
    s_mov_b32 s22, 524288
    s_mov_b32 s23, 0x20000
    s_mul_i32 s45, s33, 245760
    s_add_u32 s24, s4, s45
    s_addc_u32 s25, s5, 0
    s_mov_b32 s26, 245760
    s_mov_b32 s27, 0x20000
    s_lshl_b32 s45, s34, 8
    s_add_u32 s96, s10, s45
    s_addc_u32 s97, s11, 0
    s_sub_u32 s98, 5242880, s45
    s_mov_b32 s99, 0x20000
    s_mov_b32 s92, s56
    s_mov_b32 s93, s57
    s_mov_b32 s94, 5242880
    s_mov_b32 s95, 0x20000
    s_mul_i32 s37, s2, 20480
    s_mul_i32 s46, s32, 5120
    s_add_u32 s37, s37, s46
    v_lshlrev_b32 v252, 4, v253
    s_mov_b32 s39, s42
    s_lshl_b32 s44, s42, 19
    s_add_u32 s44, s44, s51
    s_add_u32 s42, s42, 1
    s_cmp_ge_u32 s42, 10
    s_cselect_b32 s42, 0, s42
    s_add_u32 m0, s49, 118272
    s_nop 0
    buffer_load_dwordx4 v219, s[96:99], s44 offen lds
    s_add_u32 s44, s44, 8192
    s_add_u32 m0, s49, 119328
    s_nop 0
    buffer_load_dwordx4 v219, s[96:99], s44 offen lds
    s_add_u32 s44, s44, 8192
    s_add_u32 m0, s49, 120384
    s_nop 0
    buffer_load_dwordx4 v219, s[96:99], s44 offen lds
    s_add_u32 s44, s44, 8192
    s_add_u32 m0, s49, 121440
    s_nop 0
    buffer_load_dwordx4 v219, s[96:99], s44 offen lds
    s_lshl_b32 s43, s39, 7
    s_add_u32 s43, s43, s50
    s_add_u32 s39, s39, 1
    s_cmp_ge_u32 s39, 10
    s_cselect_b32 s39, 0, s39
    s_add_u32 m0, s48, 135168
    s_nop 0
    buffer_load_dwordx4 v218, s[24:27], s43 offen lds
    s_add_u32 s43, s43, 40960
    s_add_u32 m0, s48, 136192
    s_nop 0
    buffer_load_dwordx4 v218, s[24:27], s43 offen lds
    s_add_u32 s43, s43, 40960
    s_add_u32 m0, s48, 137216
    s_nop 0
    buffer_load_dwordx4 v218, s[24:27], s43 offen lds
    s_add_u32 s43, s43, 40960
    s_add_u32 m0, s48, 138240
    s_nop 0
    buffer_load_dwordx4 v218, s[24:27], s43 offen lds
    s_add_u32 s43, s43, 40960
    s_add_u32 m0, s48, 139264
    s_nop 0
    buffer_load_dwordx4 v218, s[24:27], s43 offen lds
    s_add_u32 s43, s43, 40960
    s_add_u32 m0, s48, 140288
    s_nop 0
    buffer_load_dwordx4 v218, s[24:27], s43 offen lds
    s_lshl_b32 s44, s42, 19
    s_add_u32 s44, s44, s51
    s_add_u32 s42, s42, 1
    s_cmp_ge_u32 s42, 10
    s_cselect_b32 s42, 0, s42
    s_add_u32 m0, s49, 84480
    s_nop 0
    buffer_load_dwordx4 v219, s[96:99], s44 offen lds
    s_add_u32 s44, s44, 8192
    s_add_u32 m0, s49, 85536
    s_nop 0
    buffer_load_dwordx4 v219, s[96:99], s44 offen lds
    s_add_u32 s44, s44, 8192
    s_add_u32 m0, s49, 86592
    s_nop 0
    buffer_load_dwordx4 v219, s[96:99], s44 offen lds
    s_add_u32 s44, s44, 8192
    s_add_u32 m0, s49, 87648
    s_nop 0
    buffer_load_dwordx4 v219, s[96:99], s44 offen lds
    s_lshl_b32 s43, s39, 7
    s_add_u32 s43, s43, s50
    s_add_u32 s39, s39, 1
    s_cmp_ge_u32 s39, 10
    s_cselect_b32 s39, 0, s39
    s_add_u32 m0, s48, 16896
    s_nop 0
    buffer_load_dwordx4 v218, s[24:27], s43 offen lds
    s_add_u32 s43, s43, 40960
    s_add_u32 m0, s48, 17920
    s_nop 0
    buffer_load_dwordx4 v218, s[24:27], s43 offen lds
    s_add_u32 s43, s43, 40960
    s_add_u32 m0, s48, 18944
    s_nop 0
    buffer_load_dwordx4 v218, s[24:27], s43 offen lds
    s_add_u32 s43, s43, 40960
    s_add_u32 m0, s48, 19968
    s_nop 0
    buffer_load_dwordx4 v218, s[24:27], s43 offen lds
    s_add_u32 s43, s43, 40960
    s_add_u32 m0, s48, 20992
    s_nop 0
    buffer_load_dwordx4 v218, s[24:27], s43 offen lds
    s_add_u32 s43, s43, 40960
    s_add_u32 m0, s48, 22016
    s_nop 0
    buffer_load_dwordx4 v218, s[24:27], s43 offen lds
    v_bfe_u32 v3, v253, 2, 2
    v_and_b32 v4, 3, v253
    v_mul_u32_u24 v5, 1056, v2
    v_lshl_add_u32 v5, v1, 4, v5
    s_lshl_b32 s3, s53, 9
    v_add_u32 v209, s3, v5
    v_lshl_add_u32 v5, v1, 2, v3
    v_mul_u32_u24 v5, 1056, v5
    v_lshl_add_u32 v5, v4, 3, v5
    s_mul_i32 s3, s53, 640
    s_add_u32 s3, s3, 67584
    v_add_u32 v210, s3, v5
    s_mul_i32 s3, s53, 384
    s_add_u32 s3, s3, 67584
    v_add_u32 v211, s3, v5
    v_mul_u32_u24 v5, 6176, v4
    v_lshl_add_u32 v5, v3, 7, v5
    v_lshl_add_u32 v5, v1, 4, v5
    s_mul_i32 s3, s52, 3072
    v_add_u32 v214, s3, v5
    v_and_b32 v5, 1, v1
    v_lshl_add_u32 v5, v5, 2, v3
    v_mul_u32_u24 v5, 1056, v5
    v_lshrrev_b32 v6, 1, v1
    v_lshl_add_u32 v5, v6, 8, v5
    v_lshl_add_u32 v5, v4, 3, v5
    s_lshl_b32 s3, s53, 7
    v_add_u32 v215, s3, v5
    v_lshlrev_b32 v220, 4, v253
    v_add_u32 v220, s41, v220
    v_add_u32 v221, 67584, v220
    s_mov_b32 s36, 0x45800000
    v_mov_b32 v168, 0
    v_mov_b32 v169, 0
    v_mov_b32 v170, 0
    v_mov_b32 v171, 0
    v_mov_b32 v172, 0
    v_mov_b32 v173, 0
    v_mov_b32 v174, 0
    v_mov_b32 v175, 0
    v_mov_b32 v176, 0
    v_mov_b32 v177, 0
    v_mov_b32 v178, 0
    v_mov_b32 v179, 0
    v_mov_b32 v180, 0
    v_mov_b32 v181, 0
    v_mov_b32 v182, 0
    v_mov_b32 v183, 0
    v_mov_b32 v184, 0
    v_mov_b32 v185, 0
    v_mov_b32 v186, 0
    v_mov_b32 v187, 0
    v_mov_b32 v188, 0
    v_mov_b32 v189, 0
    v_mov_b32 v190, 0
    v_mov_b32 v191, 0
    v_mov_b32 v192, 0
    v_mov_b32 v193, 0
    v_mov_b32 v194, 0
    v_mov_b32 v195, 0
    v_mov_b32 v196, 0
    v_mov_b32 v197, 0
    s_waitcnt vmcnt(10)
    s_barrier
    v_add_u32 v216, 135168, v214
    v_add_u32 v217, 118272, v215
    ds_read_b128 a[0:3], v216 offset:0
    ds_read_b128 a[4:7], v216 offset:512
    ds_read_b128 a[8:11], v216 offset:1024
    ds_read_b128 a[12:15], v216 offset:1536
    ds_read_b128 a[16:19], v216 offset:2048
    ds_read_b128 a[20:23], v216 offset:2560
    ds_read_b64_tr_b16 a[48:49], v217 offset:0
    ds_read_b64_tr_b16 a[50:51], v217 offset:8448
    ds_read_b64_tr_b16 a[52:53], v217 offset:32
    ds_read_b64_tr_b16 a[54:55], v217 offset:8480
    ds_read_b64_tr_b16 a[56:57], v217 offset:64
    ds_read_b64_tr_b16 a[58:59], v217 offset:8512
    ds_read_b64_tr_b16 a[60:61], v217 offset:96
    ds_read_b64_tr_b16 a[62:63], v217 offset:8544
    ds_read_b128 a[24:27], v216 offset:64
    ds_read_b128 a[28:31], v216 offset:576
    ds_read_b128 a[32:35], v216 offset:1088
    ds_read_b128 a[36:39], v216 offset:1600
    ds_read_b128 a[40:43], v216 offset:2112
    ds_read_b128 a[44:47], v216 offset:2624
    ds_read_b64_tr_b16 a[64:65], v217 offset:512
    ds_read_b64_tr_b16 a[66:67], v217 offset:8960
    ds_read_b64_tr_b16 a[68:69], v217 offset:544
    ds_read_b64_tr_b16 a[70:71], v217 offset:8992
    ds_read_b64_tr_b16 a[72:73], v217 offset:576
    ds_read_b64_tr_b16 a[74:75], v217 offset:9024
    ds_read_b64_tr_b16 a[76:77], v217 offset:608
    ds_read_b64_tr_b16 a[78:79], v217 offset:9056
    s_lshl_b32 s44, s42, 19
    s_add_u32 s44, s44, s51
    s_add_u32 s42, s42, 1
    s_cmp_ge_u32 s42, 10
    s_cselect_b32 s42, 0, s42
    s_add_u32 m0, s49, 101376
    s_nop 0
    buffer_load_dwordx4 v219, s[96:99], s44 offen lds
    s_add_u32 s44, s44, 8192
    s_add_u32 m0, s49, 102432
    s_nop 0
    buffer_load_dwordx4 v219, s[96:99], s44 offen lds
    s_add_u32 s44, s44, 8192
    s_add_u32 m0, s49, 103488
    s_nop 0
    buffer_load_dwordx4 v219, s[96:99], s44 offen lds
    s_add_u32 s44, s44, 8192
    s_add_u32 m0, s49, 104544
    s_nop 0
    buffer_load_dwordx4 v219, s[96:99], s44 offen lds
    s_lshl_b32 s43, s39, 7
    s_add_u32 s43, s43, s50
    s_add_u32 s39, s39, 1
    s_cmp_ge_u32 s39, 10
    s_cselect_b32 s39, 0, s39
    s_add_u32 m0, s48, 41600
    s_nop 0
    buffer_load_dwordx4 v218, s[24:27], s43 offen lds
    s_add_u32 s43, s43, 40960
    s_add_u32 m0, s48, 42624
    s_nop 0
    buffer_load_dwordx4 v218, s[24:27], s43 offen lds
    s_add_u32 s43, s43, 40960
    s_add_u32 m0, s48, 43648
    s_nop 0
    buffer_load_dwordx4 v218, s[24:27], s43 offen lds
    s_add_u32 s43, s43, 40960
    s_add_u32 m0, s48, 44672
    s_nop 0
    buffer_load_dwordx4 v218, s[24:27], s43 offen lds
    s_add_u32 s43, s43, 40960
    s_add_u32 m0, s48, 45696
    s_nop 0
    buffer_load_dwordx4 v218, s[24:27], s43 offen lds
    s_add_u32 s43, s43, 40960
    s_add_u32 m0, s48, 46720
    s_nop 0
    buffer_load_dwordx4 v218, s[24:27], s43 offen lds
    s_waitcnt vmcnt(10) lgkmcnt(0)
    s_barrier
    v_add_u32 v216, 16896, v214
    v_add_u32 v217, 84480, v215
    s_lshl_b32 s44, s42, 19
    s_add_u32 s44, s44, s51
    s_add_u32 s42, s42, 1
    s_cmp_ge_u32 s42, 10
    s_cselect_b32 s42, 0, s42
    s_add_u32 m0, s49, 118272
    v_mfma_f32_16x16x32_bf16 v[0:3], a[48:51], a[0:3], 0
    v_mfma_f32_16x16x32_bf16 v[4:7], a[48:51], a[4:7], 0
    v_mfma_f32_16x16x32_bf16 v[8:11], a[48:51], a[8:11], 0
    buffer_load_dwordx4 v219, s[96:99], s44 offen lds
    ds_read_b128 a[80:83], v216 offset:0
    ds_read_b128 a[84:87], v216 offset:512
    s_add_u32 s44, s44, 8192
    s_add_u32 m0, s49, 119328
    v_mfma_f32_16x16x32_bf16 v[12:15], a[48:51], a[12:15], 0
    v_mfma_f32_16x16x32_bf16 v[16:19], a[48:51], a[16:19], 0
    v_mfma_f32_16x16x32_bf16 v[20:23], a[48:51], a[20:23], 0
    buffer_load_dwordx4 v219, s[96:99], s44 offen lds
    ds_read_b128 a[88:91], v216 offset:1024
    ds_read_b128 a[92:95], v216 offset:1536
    v_mfma_f32_16x16x32_bf16 v[24:27], a[52:55], a[0:3], 0
    v_mfma_f32_16x16x32_bf16 v[28:31], a[52:55], a[4:7], 0
    v_mfma_f32_16x16x32_bf16 v[32:35], a[52:55], a[8:11], 0
    ds_read_b128 a[96:99], v216 offset:2048
    ds_read_b128 a[100:103], v216 offset:2560
    ds_read_b64_tr_b16 a[128:129], v217 offset:0
    s_add_u32 s44, s44, 8192
    s_add_u32 m0, s49, 120384
    v_mfma_f32_16x16x32_bf16 v[36:39], a[52:55], a[12:15], 0
    v_mfma_f32_16x16x32_bf16 v[40:43], a[52:55], a[16:19], 0
    v_mfma_f32_16x16x32_bf16 v[44:47], a[52:55], a[20:23], 0
    buffer_load_dwordx4 v219, s[96:99], s44 offen lds
    ds_read_b64_tr_b16 a[130:131], v217 offset:8448
    ds_read_b64_tr_b16 a[132:133], v217 offset:32
    s_add_u32 s44, s44, 8192
    s_add_u32 m0, s49, 121440
    v_mfma_f32_16x16x32_bf16 v[48:51], a[56:59], a[0:3], 0
    v_mfma_f32_16x16x32_bf16 v[52:55], a[56:59], a[4:7], 0
    v_mfma_f32_16x16x32_bf16 v[56:59], a[56:59], a[8:11], 0
    buffer_load_dwordx4 v219, s[96:99], s44 offen lds
    ds_read_b64_tr_b16 a[134:135], v217 offset:8480
    ds_read_b64_tr_b16 a[136:137], v217 offset:64
    v_mfma_f32_16x16x32_bf16 v[60:63], a[56:59], a[12:15], 0
    v_mfma_f32_16x16x32_bf16 v[64:67], a[56:59], a[16:19], 0
    v_mfma_f32_16x16x32_bf16 v[68:71], a[56:59], a[20:23], 0
    ds_read_b64_tr_b16 a[138:139], v217 offset:8512
    ds_read_b64_tr_b16 a[140:141], v217 offset:96
    ds_read_b64_tr_b16 a[142:143], v217 offset:8544
    s_lshl_b32 s43, s39, 7
    s_add_u32 s43, s43, s50
    s_add_u32 s39, s39, 1
    s_cmp_ge_u32 s39, 10
    s_cselect_b32 s39, 0, s39
    s_add_u32 m0, s48, 135168
    v_mfma_f32_16x16x32_bf16 v[72:75], a[60:63], a[0:3], 0
    v_mfma_f32_16x16x32_bf16 v[76:79], a[60:63], a[4:7], 0
    v_mfma_f32_16x16x32_bf16 v[80:83], a[60:63], a[8:11], 0
    buffer_load_dwordx4 v218, s[24:27], s43 offen lds
    ds_read_b128 a[104:107], v216 offset:64
    ds_read_b128 a[108:111], v216 offset:576
    v_mfma_f32_16x16x32_bf16 v[84:87], a[60:63], a[12:15], 0
    v_mfma_f32_16x16x32_bf16 v[88:91], a[60:63], a[16:19], 0
    v_mfma_f32_16x16x32_bf16 v[92:95], a[60:63], a[20:23], 0
    ds_read_b128 a[112:115], v216 offset:1088
    ds_read_b128 a[116:119], v216 offset:1600
    s_add_u32 s43, s43, 40960
    s_add_u32 m0, s48, 136192
    v_mfma_f32_16x16x32_bf16 v[0:3], a[64:67], a[24:27], v[0:3]
    v_mfma_f32_16x16x32_bf16 v[4:7], a[64:67], a[28:31], v[4:7]
    v_mfma_f32_16x16x32_bf16 v[8:11], a[64:67], a[32:35], v[8:11]
    buffer_load_dwordx4 v218, s[24:27], s43 offen lds
    ds_read_b128 a[120:123], v216 offset:2112
    ds_read_b128 a[124:127], v216 offset:2624
    ds_read_b64_tr_b16 a[144:145], v217 offset:512
    s_add_u32 s43, s43, 40960
    s_add_u32 m0, s48, 137216
    v_mfma_f32_16x16x32_bf16 v[12:15], a[64:67], a[36:39], v[12:15]
    v_mfma_f32_16x16x32_bf16 v[16:19], a[64:67], a[40:43], v[16:19]
    v_mfma_f32_16x16x32_bf16 v[20:23], a[64:67], a[44:47], v[20:23]
    buffer_load_dwordx4 v218, s[24:27], s43 offen lds
    ds_read_b64_tr_b16 a[146:147], v217 offset:8960
    ds_read_b64_tr_b16 a[148:149], v217 offset:544
    v_mfma_f32_16x16x32_bf16 v[24:27], a[68:71], a[24:27], v[24:27]
    v_mfma_f32_16x16x32_bf16 v[28:31], a[68:71], a[28:31], v[28:31]
    v_mfma_f32_16x16x32_bf16 v[32:35], a[68:71], a[32:35], v[32:35]
    ds_read_b64_tr_b16 a[150:151], v217 offset:8992
    ds_read_b64_tr_b16 a[152:153], v217 offset:576
    s_add_u32 s43, s43, 40960
    s_add_u32 m0, s48, 138240
    v_mfma_f32_16x16x32_bf16 v[36:39], a[68:71], a[36:39], v[36:39]
    v_mfma_f32_16x16x32_bf16 v[40:43], a[68:71], a[40:43], v[40:43]
    v_mfma_f32_16x16x32_bf16 v[44:47], a[68:71], a[44:47], v[44:47]
    buffer_load_dwordx4 v218, s[24:27], s43 offen lds
    ds_read_b64_tr_b16 a[154:155], v217 offset:9024
    ds_read_b64_tr_b16 a[156:157], v217 offset:608
    ds_read_b64_tr_b16 a[158:159], v217 offset:9056
    s_add_u32 s43, s43, 40960
    s_add_u32 m0, s48, 139264
    v_mfma_f32_16x16x32_bf16 v[48:51], a[72:75], a[24:27], v[48:51]
    v_mfma_f32_16x16x32_bf16 v[52:55], a[72:75], a[28:31], v[52:55]
    v_mfma_f32_16x16x32_bf16 v[56:59], a[72:75], a[32:35], v[56:59]
    buffer_load_dwordx4 v218, s[24:27], s43 offen lds
    v_mfma_f32_16x16x32_bf16 v[60:63], a[72:75], a[36:39], v[60:63]
    v_mfma_f32_16x16x32_bf16 v[64:67], a[72:75], a[40:43], v[64:67]
    v_mfma_f32_16x16x32_bf16 v[68:71], a[72:75], a[44:47], v[68:71]
    s_add_u32 s43, s43, 40960
    s_add_u32 m0, s48, 140288
    v_mfma_f32_16x16x32_bf16 v[72:75], a[76:79], a[24:27], v[72:75]
    v_mfma_f32_16x16x32_bf16 v[76:79], a[76:79], a[28:31], v[76:79]
    v_mfma_f32_16x16x32_bf16 v[80:83], a[76:79], a[32:35], v[80:83]
    buffer_load_dwordx4 v218, s[24:27], s43 offen lds
    v_mfma_f32_16x16x32_bf16 v[84:87], a[76:79], a[36:39], v[84:87]
    v_mfma_f32_16x16x32_bf16 v[88:91], a[76:79], a[40:43], v[88:91]
    v_mfma_f32_16x16x32_bf16 v[92:95], a[76:79], a[44:47], v[92:95]
    s_waitcnt vmcnt(10) lgkmcnt(0)
    s_barrier
    v_add_u32 v216, 41600, v214
    v_add_u32 v217, 101376, v215
    s_lshl_b32 s44, s42, 19
    s_add_u32 s44, s44, s51
    s_add_u32 s42, s42, 1
    s_cmp_ge_u32 s42, 10
    s_cselect_b32 s42, 0, s42
    s_add_u32 m0, s49, 84480
    v_mfma_f32_16x16x32_bf16 v[0:3], a[128:131], a[80:83], v[0:3]
    v_mfma_f32_16x16x32_bf16 v[4:7], a[128:131], a[84:87], v[4:7]
    v_mfma_f32_16x16x32_bf16 v[8:11], a[128:131], a[88:91], v[8:11]
    buffer_load_dwordx4 v219, s[96:99], s44 offen lds
    ds_read_b128 a[0:3], v216 offset:0
    ds_read_b128 a[4:7], v216 offset:512
    s_add_u32 s44, s44, 8192
    s_add_u32 m0, s49, 85536
    v_mfma_f32_16x16x32_bf16 v[12:15], a[128:131], a[92:95], v[12:15]
    v_mfma_f32_16x16x32_bf16 v[16:19], a[128:131], a[96:99], v[16:19]
    v_mfma_f32_16x16x32_bf16 v[20:23], a[128:131], a[100:103], v[20:23]
    buffer_load_dwordx4 v219, s[96:99], s44 offen lds
    ds_read_b128 a[8:11], v216 offset:1024
    ds_read_b128 a[12:15], v216 offset:1536
    s_add_u32 s44, s44, 8192
    s_add_u32 m0, s49, 86592
    v_mfma_f32_16x16x32_bf16 v[24:27], a[132:135], a[80:83], v[24:27]
    v_mfma_f32_16x16x32_bf16 v[28:31], a[132:135], a[84:87], v[28:31]
    v_mfma_f32_16x16x32_bf16 v[32:35], a[132:135], a[88:91], v[32:35]
    buffer_load_dwordx4 v219, s[96:99], s44 offen lds
    ds_read_b128 a[16:19], v216 offset:2048
    ds_read_b128 a[20:23], v216 offset:2560
    ds_read_b64_tr_b16 a[48:49], v217 offset:0
    s_add_u32 s44, s44, 8192
    s_add_u32 m0, s49, 87648
    v_mfma_f32_16x16x32_bf16 v[36:39], a[132:135], a[92:95], v[36:39]
    v_mfma_f32_16x16x32_bf16 v[40:43], a[132:135], a[96:99], v[40:43]
    v_mfma_f32_16x16x32_bf16 v[44:47], a[132:135], a[100:103], v[44:47]
    buffer_load_dwordx4 v219, s[96:99], s44 offen lds
    ds_read_b64_tr_b16 a[50:51], v217 offset:8448
    ds_read_b64_tr_b16 a[52:53], v217 offset:32
    s_lshl_b32 s43, s39, 7
    s_add_u32 s43, s43, s50
    s_add_u32 s39, s39, 1
    s_cmp_ge_u32 s39, 10
    s_cselect_b32 s39, 0, s39
    s_add_u32 m0, s48, 16896
    v_mfma_f32_16x16x32_bf16 v[48:51], a[136:139], a[80:83], v[48:51]
    v_mfma_f32_16x16x32_bf16 v[52:55], a[136:139], a[84:87], v[52:55]
    v_mfma_f32_16x16x32_bf16 v[56:59], a[136:139], a[88:91], v[56:59]
    buffer_load_dwordx4 v218, s[24:27], s43 offen lds
    ds_read_b64_tr_b16 a[54:55], v217 offset:8480
    ds_read_b64_tr_b16 a[56:57], v217 offset:64
    s_add_u32 s43, s43, 40960
    s_add_u32 m0, s48, 17920
    v_mfma_f32_16x16x32_bf16 v[60:63], a[136:139], a[92:95], v[60:63]
    v_mfma_f32_16x16x32_bf16 v[64:67], a[136:139], a[96:99], v[64:67]
    v_mfma_f32_16x16x32_bf16 v[68:71], a[136:139], a[100:103], v[68:71]
    buffer_load_dwordx4 v218, s[24:27], s43 offen lds
    ds_read_b64_tr_b16 a[58:59], v217 offset:8512
    ds_read_b64_tr_b16 a[60:61], v217 offset:96
    ds_read_b64_tr_b16 a[62:63], v217 offset:8544
    s_add_u32 s43, s43, 40960
    s_add_u32 m0, s48, 18944
    v_mfma_f32_16x16x32_bf16 v[72:75], a[140:143], a[80:83], v[72:75]
    v_mfma_f32_16x16x32_bf16 v[76:79], a[140:143], a[84:87], v[76:79]
    v_mfma_f32_16x16x32_bf16 v[80:83], a[140:143], a[88:91], v[80:83]
    buffer_load_dwordx4 v218, s[24:27], s43 offen lds
    ds_read_b128 a[24:27], v216 offset:64
    ds_read_b128 a[28:31], v216 offset:576
    s_add_u32 s43, s43, 40960
    s_add_u32 m0, s48, 19968
    v_mfma_f32_16x16x32_bf16 v[84:87], a[140:143], a[92:95], v[84:87]
    v_mfma_f32_16x16x32_bf16 v[88:91], a[140:143], a[96:99], v[88:91]
    v_mfma_f32_16x16x32_bf16 v[92:95], a[140:143], a[100:103], v[92:95]
    buffer_load_dwordx4 v218, s[24:27], s43 offen lds
    ds_read_b128 a[32:35], v216 offset:1088
    ds_read_b128 a[36:39], v216 offset:1600
    s_add_u32 s43, s43, 40960
    s_add_u32 m0, s48, 20992
    v_mfma_f32_16x16x32_bf16 v[0:3], a[144:147], a[104:107], v[0:3]
    v_mfma_f32_16x16x32_bf16 v[4:7], a[144:147], a[108:111], v[4:7]
    v_mfma_f32_16x16x32_bf16 v[8:11], a[144:147], a[112:115], v[8:11]
    buffer_load_dwordx4 v218, s[24:27], s43 offen lds
    ds_read_b128 a[40:43], v216 offset:2112
    ds_read_b128 a[44:47], v216 offset:2624
    ds_read_b64_tr_b16 a[64:65], v217 offset:512
    s_add_u32 s43, s43, 40960
    s_add_u32 m0, s48, 22016
    v_mfma_f32_16x16x32_bf16 v[12:15], a[144:147], a[116:119], v[12:15]
    v_mfma_f32_16x16x32_bf16 v[16:19], a[144:147], a[120:123], v[16:19]
    v_mfma_f32_16x16x32_bf16 v[20:23], a[144:147], a[124:127], v[20:23]
    buffer_load_dwordx4 v218, s[24:27], s43 offen lds
    ds_read_b64_tr_b16 a[66:67], v217 offset:8960
    ds_read_b64_tr_b16 a[68:69], v217 offset:544
    s_mov_b32 m0, 162816
    v_mfma_f32_16x16x32_bf16 v[24:27], a[148:151], a[104:107], v[24:27]
    v_mfma_f32_16x16x32_bf16 v[28:31], a[148:151], a[108:111], v[28:31]
    v_mfma_f32_16x16x32_bf16 v[32:35], a[148:151], a[112:115], v[32:35]
    buffer_load_dwordx4 v252, s[92:95], s37 offen lds
    s_add_u32 s37, s37, 1024
    ds_read_b64_tr_b16 a[70:71], v217 offset:8992
    ds_read_b64_tr_b16 a[72:73], v217 offset:576
    s_mov_b32 m0, 162816
    v_mfma_f32_16x16x32_bf16 v[36:39], a[148:151], a[116:119], v[36:39]
    v_mfma_f32_16x16x32_bf16 v[40:43], a[148:151], a[120:123], v[40:43]
    v_mfma_f32_16x16x32_bf16 v[44:47], a[148:151], a[124:127], v[44:47]
    buffer_load_dwordx4 v252, s[92:95], s37 offen lds
    s_add_u32 s37, s37, 1024
    ds_read_b64_tr_b16 a[74:75], v217 offset:9024
    ds_read_b64_tr_b16 a[76:77], v217 offset:608
    ds_read_b64_tr_b16 a[78:79], v217 offset:9056
    s_mov_b32 m0, 162816
    v_mfma_f32_16x16x32_bf16 v[48:51], a[152:155], a[104:107], v[48:51]
    v_mfma_f32_16x16x32_bf16 v[52:55], a[152:155], a[108:111], v[52:55]
    v_mfma_f32_16x16x32_bf16 v[56:59], a[152:155], a[112:115], v[56:59]
    buffer_load_dwordx4 v252, s[92:95], s37 offen lds
    s_add_u32 s37, s37, 1024
    s_mov_b32 m0, 162816
    v_mfma_f32_16x16x32_bf16 v[60:63], a[152:155], a[116:119], v[60:63]
    v_mfma_f32_16x16x32_bf16 v[64:67], a[152:155], a[120:123], v[64:67]
    v_mfma_f32_16x16x32_bf16 v[68:71], a[152:155], a[124:127], v[68:71]
    buffer_load_dwordx4 v252, s[92:95], s37 offen lds
    s_add_u32 s37, s37, 1024
    s_mov_b32 m0, 162816
    v_mfma_f32_16x16x32_bf16 v[72:75], a[156:159], a[104:107], v[72:75]
    v_mfma_f32_16x16x32_bf16 v[76:79], a[156:159], a[108:111], v[76:79]
    v_mfma_f32_16x16x32_bf16 v[80:83], a[156:159], a[112:115], v[80:83]
    buffer_load_dwordx4 v252, s[92:95], s37 offen lds
    s_add_u32 s37, s37, 1024
    v_mfma_f32_16x16x32_bf16 v[84:87], a[156:159], a[116:119], v[84:87]
    v_mfma_f32_16x16x32_bf16 v[88:91], a[156:159], a[120:123], v[88:91]
    v_mfma_f32_16x16x32_bf16 v[92:95], a[156:159], a[124:127], v[92:95]
    s_waitcnt vmcnt(15) lgkmcnt(0)
    s_barrier
    v_add_u32 v216, 135168, v214
    v_add_u32 v217, 118272, v215
    s_lshl_b32 s44, s42, 19
    s_add_u32 s44, s44, s51
    s_add_u32 s42, s42, 1
    s_cmp_ge_u32 s42, 10
    s_cselect_b32 s42, 0, s42
    s_add_u32 m0, s49, 101376
    v_mfma_f32_16x16x32_bf16 v[0:3], a[48:51], a[0:3], v[0:3]
    v_mfma_f32_16x16x32_bf16 v[4:7], a[48:51], a[4:7], v[4:7]
    v_mfma_f32_16x16x32_bf16 v[8:11], a[48:51], a[8:11], v[8:11]
    buffer_load_dwordx4 v219, s[96:99], s44 offen lds
    ds_read_b128 a[80:83], v216 offset:0
    ds_read_b128 a[84:87], v216 offset:512
    s_add_u32 s44, s44, 8192
    s_add_u32 m0, s49, 102432
    v_mfma_f32_16x16x32_bf16 v[12:15], a[48:51], a[12:15], v[12:15]
    v_mfma_f32_16x16x32_bf16 v[16:19], a[48:51], a[16:19], v[16:19]
    v_mfma_f32_16x16x32_bf16 v[20:23], a[48:51], a[20:23], v[20:23]
    buffer_load_dwordx4 v219, s[96:99], s44 offen lds
    ds_read_b128 a[88:91], v216 offset:1024
    ds_read_b128 a[92:95], v216 offset:1536
    v_mfma_f32_16x16x32_bf16 v[24:27], a[52:55], a[0:3], v[24:27]
    v_mfma_f32_16x16x32_bf16 v[28:31], a[52:55], a[4:7], v[28:31]
    v_mfma_f32_16x16x32_bf16 v[32:35], a[52:55], a[8:11], v[32:35]
    ds_read_b128 a[96:99], v216 offset:2048
    ds_read_b128 a[100:103], v216 offset:2560
    ds_read_b64_tr_b16 a[128:129], v217 offset:0
    s_add_u32 s44, s44, 8192
    s_add_u32 m0, s49, 103488
    v_mfma_f32_16x16x32_bf16 v[36:39], a[52:55], a[12:15], v[36:39]
    v_mfma_f32_16x16x32_bf16 v[40:43], a[52:55], a[16:19], v[40:43]
    v_mfma_f32_16x16x32_bf16 v[44:47], a[52:55], a[20:23], v[44:47]
    buffer_load_dwordx4 v219, s[96:99], s44 offen lds
    ds_read_b64_tr_b16 a[130:131], v217 offset:8448
    ds_read_b64_tr_b16 a[132:133], v217 offset:32
    s_add_u32 s44, s44, 8192
    s_add_u32 m0, s49, 104544
    v_mfma_f32_16x16x32_bf16 v[48:51], a[56:59], a[0:3], v[48:51]
    v_mfma_f32_16x16x32_bf16 v[52:55], a[56:59], a[4:7], v[52:55]
    v_mfma_f32_16x16x32_bf16 v[56:59], a[56:59], a[8:11], v[56:59]
    buffer_load_dwordx4 v219, s[96:99], s44 offen lds
    ds_read_b64_tr_b16 a[134:135], v217 offset:8480
    ds_read_b64_tr_b16 a[136:137], v217 offset:64
    v_mfma_f32_16x16x32_bf16 v[60:63], a[56:59], a[12:15], v[60:63]
    v_mfma_f32_16x16x32_bf16 v[64:67], a[56:59], a[16:19], v[64:67]
    v_mfma_f32_16x16x32_bf16 v[68:71], a[56:59], a[20:23], v[68:71]
    ds_read_b64_tr_b16 a[138:139], v217 offset:8512
    ds_read_b64_tr_b16 a[140:141], v217 offset:96
    ds_read_b64_tr_b16 a[142:143], v217 offset:8544
    s_lshl_b32 s43, s39, 7
    s_add_u32 s43, s43, s50
    s_add_u32 s39, s39, 1
    s_cmp_ge_u32 s39, 10
    s_cselect_b32 s39, 0, s39
    s_add_u32 m0, s48, 41600
    v_mfma_f32_16x16x32_bf16 v[72:75], a[60:63], a[0:3], v[72:75]
    v_mfma_f32_16x16x32_bf16 v[76:79], a[60:63], a[4:7], v[76:79]
    v_mfma_f32_16x16x32_bf16 v[80:83], a[60:63], a[8:11], v[80:83]
    buffer_load_dwordx4 v218, s[24:27], s43 offen lds
    ds_read_b128 a[104:107], v216 offset:64
    ds_read_b128 a[108:111], v216 offset:576
    v_mfma_f32_16x16x32_bf16 v[84:87], a[60:63], a[12:15], v[84:87]
    v_mfma_f32_16x16x32_bf16 v[88:91], a[60:63], a[16:19], v[88:91]
    v_mfma_f32_16x16x32_bf16 v[92:95], a[60:63], a[20:23], v[92:95]
    ds_read_b128 a[112:115], v216 offset:1088
    ds_read_b128 a[116:119], v216 offset:1600
    s_add_u32 s43, s43, 40960
    s_add_u32 m0, s48, 42624
    v_mfma_f32_16x16x32_bf16 v[0:3], a[64:67], a[24:27], v[0:3]
    v_mfma_f32_16x16x32_bf16 v[4:7], a[64:67], a[28:31], v[4:7]
    v_mfma_f32_16x16x32_bf16 v[8:11], a[64:67], a[32:35], v[8:11]
    buffer_load_dwordx4 v218, s[24:27], s43 offen lds
    ds_read_b128 a[120:123], v216 offset:2112
    ds_read_b128 a[124:127], v216 offset:2624
    ds_read_b64_tr_b16 a[144:145], v217 offset:512
    s_add_u32 s43, s43, 40960
    s_add_u32 m0, s48, 43648
    v_mfma_f32_16x16x32_bf16 v[12:15], a[64:67], a[36:39], v[12:15]
    v_mfma_f32_16x16x32_bf16 v[16:19], a[64:67], a[40:43], v[16:19]
    v_mfma_f32_16x16x32_bf16 v[20:23], a[64:67], a[44:47], v[20:23]
    buffer_load_dwordx4 v218, s[24:27], s43 offen lds
    ds_read_b64_tr_b16 a[146:147], v217 offset:8960
    ds_read_b64_tr_b16 a[148:149], v217 offset:544
    v_mfma_f32_16x16x32_bf16 v[24:27], a[68:71], a[24:27], v[24:27]
    v_mfma_f32_16x16x32_bf16 v[28:31], a[68:71], a[28:31], v[28:31]
    v_mfma_f32_16x16x32_bf16 v[32:35], a[68:71], a[32:35], v[32:35]
    ds_read_b64_tr_b16 a[150:151], v217 offset:8992
    ds_read_b64_tr_b16 a[152:153], v217 offset:576
    s_add_u32 s43, s43, 40960
    s_add_u32 m0, s48, 44672
    v_mfma_f32_16x16x32_bf16 v[36:39], a[68:71], a[36:39], v[36:39]
    v_mfma_f32_16x16x32_bf16 v[40:43], a[68:71], a[40:43], v[40:43]
    v_mfma_f32_16x16x32_bf16 v[44:47], a[68:71], a[44:47], v[44:47]
    buffer_load_dwordx4 v218, s[24:27], s43 offen lds
    ds_read_b64_tr_b16 a[154:155], v217 offset:9024
    ds_read_b64_tr_b16 a[156:157], v217 offset:608
    ds_read_b64_tr_b16 a[158:159], v217 offset:9056
    s_add_u32 s43, s43, 40960
    s_add_u32 m0, s48, 45696
    v_mfma_f32_16x16x32_bf16 v[48:51], a[72:75], a[24:27], v[48:51]
    v_mfma_f32_16x16x32_bf16 v[52:55], a[72:75], a[28:31], v[52:55]
    v_mfma_f32_16x16x32_bf16 v[56:59], a[72:75], a[32:35], v[56:59]
    buffer_load_dwordx4 v218, s[24:27], s43 offen lds
    v_mfma_f32_16x16x32_bf16 v[60:63], a[72:75], a[36:39], v[60:63]
    v_mfma_f32_16x16x32_bf16 v[64:67], a[72:75], a[40:43], v[64:67]
    v_mfma_f32_16x16x32_bf16 v[68:71], a[72:75], a[44:47], v[68:71]
    s_add_u32 s43, s43, 40960
    s_add_u32 m0, s48, 46720
    v_mfma_f32_16x16x32_bf16 v[72:75], a[76:79], a[24:27], v[72:75]
    v_mfma_f32_16x16x32_bf16 v[76:79], a[76:79], a[28:31], v[76:79]
    v_mfma_f32_16x16x32_bf16 v[80:83], a[76:79], a[32:35], v[80:83]
    buffer_load_dwordx4 v218, s[24:27], s43 offen lds
    v_mfma_f32_16x16x32_bf16 v[84:87], a[76:79], a[36:39], v[84:87]
    v_mfma_f32_16x16x32_bf16 v[88:91], a[76:79], a[40:43], v[88:91]
    v_mfma_f32_16x16x32_bf16 v[92:95], a[76:79], a[44:47], v[92:95]
    s_waitcnt vmcnt(15) lgkmcnt(0)
    s_barrier
    v_add_u32 v216, 16896, v214
    v_add_u32 v217, 84480, v215
    s_lshl_b32 s44, s42, 19
    s_add_u32 s44, s44, s51
    s_add_u32 s42, s42, 1
    s_cmp_ge_u32 s42, 10
    s_cselect_b32 s42, 0, s42
    s_add_u32 m0, s49, 118272
    v_mfma_f32_16x16x32_bf16 v[0:3], a[128:131], a[80:83], v[0:3]
    v_mfma_f32_16x16x32_bf16 v[4:7], a[128:131], a[84:87], v[4:7]
    v_mfma_f32_16x16x32_bf16 v[8:11], a[128:131], a[88:91], v[8:11]
    buffer_load_dwordx4 v219, s[96:99], s44 offen lds
    ds_read_b128 a[0:3], v216 offset:0
    ds_read_b128 a[4:7], v216 offset:512
    s_add_u32 s44, s44, 8192
    s_add_u32 m0, s49, 119328
    v_mfma_f32_16x16x32_bf16 v[12:15], a[128:131], a[92:95], v[12:15]
    v_mfma_f32_16x16x32_bf16 v[16:19], a[128:131], a[96:99], v[16:19]
    v_mfma_f32_16x16x32_bf16 v[20:23], a[128:131], a[100:103], v[20:23]
    buffer_load_dwordx4 v219, s[96:99], s44 offen lds
    ds_read_b128 a[8:11], v216 offset:1024
    ds_read_b128 a[12:15], v216 offset:1536
    s_add_u32 s44, s44, 8192
    s_add_u32 m0, s49, 120384
    v_mfma_f32_16x16x32_bf16 v[24:27], a[132:135], a[80:83], v[24:27]
    v_mfma_f32_16x16x32_bf16 v[28:31], a[132:135], a[84:87], v[28:31]
    v_mfma_f32_16x16x32_bf16 v[32:35], a[132:135], a[88:91], v[32:35]
    buffer_load_dwordx4 v219, s[96:99], s44 offen lds
    ds_read_b128 a[16:19], v216 offset:2048
    ds_read_b128 a[20:23], v216 offset:2560
    ds_read_b64_tr_b16 a[48:49], v217 offset:0
    s_add_u32 s44, s44, 8192
    s_add_u32 m0, s49, 121440
    v_mfma_f32_16x16x32_bf16 v[36:39], a[132:135], a[92:95], v[36:39]
    v_mfma_f32_16x16x32_bf16 v[40:43], a[132:135], a[96:99], v[40:43]
    v_mfma_f32_16x16x32_bf16 v[44:47], a[132:135], a[100:103], v[44:47]
    buffer_load_dwordx4 v219, s[96:99], s44 offen lds
    ds_read_b64_tr_b16 a[50:51], v217 offset:8448
    ds_read_b64_tr_b16 a[52:53], v217 offset:32
    s_lshl_b32 s43, s39, 7
    s_add_u32 s43, s43, s50
    s_add_u32 s39, s39, 1
    s_cmp_ge_u32 s39, 10
    s_cselect_b32 s39, 0, s39
    s_add_u32 m0, s48, 135168
    v_mfma_f32_16x16x32_bf16 v[48:51], a[136:139], a[80:83], v[48:51]
    v_mfma_f32_16x16x32_bf16 v[52:55], a[136:139], a[84:87], v[52:55]
    v_mfma_f32_16x16x32_bf16 v[56:59], a[136:139], a[88:91], v[56:59]
    buffer_load_dwordx4 v218, s[24:27], s43 offen lds
    ds_read_b64_tr_b16 a[54:55], v217 offset:8480
    ds_read_b64_tr_b16 a[56:57], v217 offset:64
    s_add_u32 s43, s43, 40960
    s_add_u32 m0, s48, 136192
    v_mfma_f32_16x16x32_bf16 v[60:63], a[136:139], a[92:95], v[60:63]
    v_mfma_f32_16x16x32_bf16 v[64:67], a[136:139], a[96:99], v[64:67]
    v_mfma_f32_16x16x32_bf16 v[68:71], a[136:139], a[100:103], v[68:71]
    buffer_load_dwordx4 v218, s[24:27], s43 offen lds
    ds_read_b64_tr_b16 a[58:59], v217 offset:8512
    ds_read_b64_tr_b16 a[60:61], v217 offset:96
    ds_read_b64_tr_b16 a[62:63], v217 offset:8544
    s_add_u32 s43, s43, 40960
    s_add_u32 m0, s48, 137216
    v_mfma_f32_16x16x32_bf16 v[72:75], a[140:143], a[80:83], v[72:75]
    v_mfma_f32_16x16x32_bf16 v[76:79], a[140:143], a[84:87], v[76:79]
    v_mfma_f32_16x16x32_bf16 v[80:83], a[140:143], a[88:91], v[80:83]
    buffer_load_dwordx4 v218, s[24:27], s43 offen lds
    ds_read_b128 a[24:27], v216 offset:64
    ds_read_b128 a[28:31], v216 offset:576
    v_mfma_f32_16x16x32_bf16 v[84:87], a[140:143], a[92:95], v[84:87]
    v_mfma_f32_16x16x32_bf16 v[88:91], a[140:143], a[96:99], v[88:91]
    v_mfma_f32_16x16x32_bf16 v[92:95], a[140:143], a[100:103], v[92:95]
    ds_read_b128 a[32:35], v216 offset:1088
    ds_read_b128 a[36:39], v216 offset:1600
    s_add_u32 s43, s43, 40960
    s_add_u32 m0, s48, 138240
    v_mfma_f32_16x16x32_bf16 v[0:3], a[144:147], a[104:107], v[0:3]
    v_mfma_f32_16x16x32_bf16 v[4:7], a[144:147], a[108:111], v[4:7]
    v_mfma_f32_16x16x32_bf16 v[8:11], a[144:147], a[112:115], v[8:11]
    buffer_load_dwordx4 v218, s[24:27], s43 offen lds
    ds_read_b128 a[40:43], v216 offset:2112
    ds_read_b128 a[44:47], v216 offset:2624
    ds_read_b64_tr_b16 a[64:65], v217 offset:512
    s_add_u32 s43, s43, 40960
    s_add_u32 m0, s48, 139264
    v_mfma_f32_16x16x32_bf16 v[12:15], a[144:147], a[116:119], v[12:15]
    v_mfma_f32_16x16x32_bf16 v[16:19], a[144:147], a[120:123], v[16:19]
    v_mfma_f32_16x16x32_bf16 v[20:23], a[144:147], a[124:127], v[20:23]
    buffer_load_dwordx4 v218, s[24:27], s43 offen lds
    ds_read_b64_tr_b16 a[66:67], v217 offset:8960
    ds_read_b64_tr_b16 a[68:69], v217 offset:544
    s_add_u32 s43, s43, 40960
    s_add_u32 m0, s48, 140288
    v_mfma_f32_16x16x32_bf16 v[24:27], a[148:151], a[104:107], v[24:27]
    v_mfma_f32_16x16x32_bf16 v[28:31], a[148:151], a[108:111], v[28:31]
    v_mfma_f32_16x16x32_bf16 v[32:35], a[148:151], a[112:115], v[32:35]
    buffer_load_dwordx4 v218, s[24:27], s43 offen lds
    ds_read_b64_tr_b16 a[70:71], v217 offset:8992
    ds_read_b64_tr_b16 a[72:73], v217 offset:576
    s_add_u32 s46, s40, 0
    s_add_u32 m0, s41, 0
    v_mfma_f32_16x16x32_bf16 v[36:39], a[148:151], a[116:119], v[36:39]
    v_mfma_f32_16x16x32_bf16 v[40:43], a[148:151], a[120:123], v[40:43]
    v_mfma_f32_16x16x32_bf16 v[44:47], a[148:151], a[124:127], v[44:47]
    buffer_load_dwordx4 v212, s[16:19], s46 offen nt lds
    ds_read_b64_tr_b16 a[74:75], v217 offset:9024
    ds_read_b64_tr_b16 a[76:77], v217 offset:608
    ds_read_b64_tr_b16 a[78:79], v217 offset:9056
    s_add_u32 s46, s40, 0
    s_add_u32 m0, s41, 67584
    v_mfma_f32_16x16x32_bf16 v[48:51], a[152:155], a[104:107], v[48:51]
    v_mfma_f32_16x16x32_bf16 v[52:55], a[152:155], a[108:111], v[52:55]
    v_mfma_f32_16x16x32_bf16 v[56:59], a[152:155], a[112:115], v[56:59]
    buffer_load_dwordx4 v212, s[20:23], s46 offen nt lds
    s_add_u32 s46, s40, 0
    s_add_u32 m0, s41, 800
    v_mfma_f32_16x16x32_bf16 v[60:63], a[152:155], a[116:119], v[60:63]
    v_mfma_f32_16x16x32_bf16 v[64:67], a[152:155], a[120:123], v[64:67]
    v_mfma_f32_16x16x32_bf16 v[68:71], a[152:155], a[124:127], v[68:71]
    buffer_load_dwordx4 v212, s[16:19], s46 offen offset:256 nt lds
    s_add_u32 s46, s40, 0
    s_add_u32 m0, s41, 68384
    v_mfma_f32_16x16x32_bf16 v[72:75], a[156:159], a[104:107], v[72:75]
    v_mfma_f32_16x16x32_bf16 v[76:79], a[156:159], a[108:111], v[76:79]
    v_mfma_f32_16x16x32_bf16 v[80:83], a[156:159], a[112:115], v[80:83]
    buffer_load_dwordx4 v212, s[20:23], s46 offen offset:256 nt lds
    v_mfma_f32_16x16x32_bf16 v[84:87], a[156:159], a[116:119], v[84:87]
    v_mfma_f32_16x16x32_bf16 v[88:91], a[156:159], a[120:123], v[88:91]
    v_mfma_f32_16x16x32_bf16 v[92:95], a[156:159], a[124:127], v[92:95]
    s_waitcnt vmcnt(14) lgkmcnt(0)
    s_barrier
    v_add_u32 v216, 41600, v214
    v_add_u32 v217, 101376, v215
    s_lshl_b32 s44, s42, 19
    s_add_u32 s44, s44, s51
    s_add_u32 s42, s42, 1
    s_cmp_ge_u32 s42, 10
    s_cselect_b32 s42, 0, s42
    s_add_u32 m0, s49, 84480
    v_mfma_f32_16x16x32_bf16 v[0:3], a[48:51], a[0:3], v[0:3]
    v_mfma_f32_16x16x32_bf16 v[4:7], a[48:51], a[4:7], v[4:7]
    v_mfma_f32_16x16x32_bf16 v[8:11], a[48:51], a[8:11], v[8:11]
    buffer_load_dwordx4 v219, s[96:99], s44 offen lds
    ds_read_b128 a[80:83], v216 offset:0
    ds_read_b128 a[84:87], v216 offset:512
    s_add_u32 s44, s44, 8192
    s_add_u32 m0, s49, 85536
    v_mfma_f32_16x16x32_bf16 v[12:15], a[48:51], a[12:15], v[12:15]
    v_mfma_f32_16x16x32_bf16 v[16:19], a[48:51], a[16:19], v[16:19]
    v_mfma_f32_16x16x32_bf16 v[20:23], a[48:51], a[20:23], v[20:23]
    buffer_load_dwordx4 v219, s[96:99], s44 offen lds
    ds_read_b128 a[88:91], v216 offset:1024
    ds_read_b128 a[92:95], v216 offset:1536
    s_add_u32 s44, s44, 8192
    s_add_u32 m0, s49, 86592
    v_mfma_f32_16x16x32_bf16 v[24:27], a[52:55], a[0:3], v[24:27]
    v_mfma_f32_16x16x32_bf16 v[28:31], a[52:55], a[4:7], v[28:31]
    v_mfma_f32_16x16x32_bf16 v[32:35], a[52:55], a[8:11], v[32:35]
    buffer_load_dwordx4 v219, s[96:99], s44 offen lds
    ds_read_b128 a[96:99], v216 offset:2048
    ds_read_b128 a[100:103], v216 offset:2560
    ds_read_b64_tr_b16 a[128:129], v217 offset:0
    s_add_u32 s44, s44, 8192
    s_add_u32 m0, s49, 87648
    v_mfma_f32_16x16x32_bf16 v[36:39], a[52:55], a[12:15], v[36:39]
    v_mfma_f32_16x16x32_bf16 v[40:43], a[52:55], a[16:19], v[40:43]
    v_mfma_f32_16x16x32_bf16 v[44:47], a[52:55], a[20:23], v[44:47]
    buffer_load_dwordx4 v219, s[96:99], s44 offen lds
    ds_read_b64_tr_b16 a[130:131], v217 offset:8448
    ds_read_b64_tr_b16 a[132:133], v217 offset:32
    s_lshl_b32 s43, s39, 7
    s_add_u32 s43, s43, s50
    s_add_u32 s39, s39, 1
    s_cmp_ge_u32 s39, 10
    s_cselect_b32 s39, 0, s39
    s_add_u32 m0, s48, 16896
    v_mfma_f32_16x16x32_bf16 v[48:51], a[56:59], a[0:3], v[48:51]
    v_mfma_f32_16x16x32_bf16 v[52:55], a[56:59], a[4:7], v[52:55]
    v_mfma_f32_16x16x32_bf16 v[56:59], a[56:59], a[8:11], v[56:59]
    buffer_load_dwordx4 v218, s[24:27], s43 offen lds
    ds_read_b64_tr_b16 a[134:135], v217 offset:8480
    ds_read_b64_tr_b16 a[136:137], v217 offset:64
    s_add_u32 s43, s43, 40960
    s_add_u32 m0, s48, 17920
    v_mfma_f32_16x16x32_bf16 v[60:63], a[56:59], a[12:15], v[60:63]
    v_mfma_f32_16x16x32_bf16 v[64:67], a[56:59], a[16:19], v[64:67]
    v_mfma_f32_16x16x32_bf16 v[68:71], a[56:59], a[20:23], v[68:71]
    buffer_load_dwordx4 v218, s[24:27], s43 offen lds
    ds_read_b64_tr_b16 a[138:139], v217 offset:8512
    ds_read_b64_tr_b16 a[140:141], v217 offset:96
    ds_read_b64_tr_b16 a[142:143], v217 offset:8544
    s_add_u32 s43, s43, 40960
    s_add_u32 m0, s48, 18944
    v_mfma_f32_16x16x32_bf16 v[72:75], a[60:63], a[0:3], v[72:75]
    v_mfma_f32_16x16x32_bf16 v[76:79], a[60:63], a[4:7], v[76:79]
    v_mfma_f32_16x16x32_bf16 v[80:83], a[60:63], a[8:11], v[80:83]
    buffer_load_dwordx4 v218, s[24:27], s43 offen lds
    ds_read_b128 a[104:107], v216 offset:64
    ds_read_b128 a[108:111], v216 offset:576
    v_mfma_f32_16x16x32_bf16 v[84:87], a[60:63], a[12:15], v[84:87]
    v_mfma_f32_16x16x32_bf16 v[88:91], a[60:63], a[16:19], v[88:91]
    v_mfma_f32_16x16x32_bf16 v[92:95], a[60:63], a[20:23], v[92:95]
    ds_read_b128 a[112:115], v216 offset:1088
    ds_read_b128 a[116:119], v216 offset:1600
    s_add_u32 s43, s43, 40960
    s_add_u32 m0, s48, 19968
    v_mfma_f32_16x16x32_bf16 v[0:3], a[64:67], a[24:27], v[0:3]
    v_mfma_f32_16x16x32_bf16 v[4:7], a[64:67], a[28:31], v[4:7]
    v_mfma_f32_16x16x32_bf16 v[8:11], a[64:67], a[32:35], v[8:11]
    buffer_load_dwordx4 v218, s[24:27], s43 offen lds
    ds_read_b128 a[120:123], v216 offset:2112
    ds_read_b128 a[124:127], v216 offset:2624
    ds_read_b64_tr_b16 a[144:145], v217 offset:512
    s_add_u32 s43, s43, 40960
    s_add_u32 m0, s48, 20992
    v_mfma_f32_16x16x32_bf16 v[12:15], a[64:67], a[36:39], v[12:15]
    v_mfma_f32_16x16x32_bf16 v[16:19], a[64:67], a[40:43], v[16:19]
    v_mfma_f32_16x16x32_bf16 v[20:23], a[64:67], a[44:47], v[20:23]
    buffer_load_dwordx4 v218, s[24:27], s43 offen lds
    ds_read_b64_tr_b16 a[146:147], v217 offset:8960
    ds_read_b64_tr_b16 a[148:149], v217 offset:544
    s_add_u32 s43, s43, 40960
    s_add_u32 m0, s48, 22016
    v_mfma_f32_16x16x32_bf16 v[24:27], a[68:71], a[24:27], v[24:27]
    v_mfma_f32_16x16x32_bf16 v[28:31], a[68:71], a[28:31], v[28:31]
    v_mfma_f32_16x16x32_bf16 v[32:35], a[68:71], a[32:35], v[32:35]
    buffer_load_dwordx4 v218, s[24:27], s43 offen lds
    ds_read_b64_tr_b16 a[150:151], v217 offset:8992
    ds_read_b64_tr_b16 a[152:153], v217 offset:576
    s_add_u32 s46, s40, 0
    s_add_u32 m0, s41, 1600
    v_mfma_f32_16x16x32_bf16 v[36:39], a[68:71], a[36:39], v[36:39]
    v_mfma_f32_16x16x32_bf16 v[40:43], a[68:71], a[40:43], v[40:43]
    v_mfma_f32_16x16x32_bf16 v[44:47], a[68:71], a[44:47], v[44:47]
    buffer_load_dwordx4 v212, s[16:19], s46 offen offset:512 nt lds
    ds_read_b64_tr_b16 a[154:155], v217 offset:9024
    ds_read_b64_tr_b16 a[156:157], v217 offset:608
    ds_read_b64_tr_b16 a[158:159], v217 offset:9056
    s_add_u32 s46, s40, 0
    s_add_u32 m0, s41, 69184
    v_mfma_f32_16x16x32_bf16 v[48:51], a[72:75], a[24:27], v[48:51]
    v_mfma_f32_16x16x32_bf16 v[52:55], a[72:75], a[28:31], v[52:55]
    v_mfma_f32_16x16x32_bf16 v[56:59], a[72:75], a[32:35], v[56:59]
    buffer_load_dwordx4 v212, s[20:23], s46 offen offset:512 nt lds
    s_add_u32 s46, s40, 0
    s_add_u32 m0, s41, 2400
    v_mfma_f32_16x16x32_bf16 v[60:63], a[72:75], a[36:39], v[60:63]
    v_mfma_f32_16x16x32_bf16 v[64:67], a[72:75], a[40:43], v[64:67]
    v_mfma_f32_16x16x32_bf16 v[68:71], a[72:75], a[44:47], v[68:71]
    buffer_load_dwordx4 v212, s[16:19], s46 offen offset:768 nt lds
    s_add_u32 s46, s40, 0
    s_add_u32 m0, s41, 69984
    v_mfma_f32_16x16x32_bf16 v[72:75], a[76:79], a[24:27], v[72:75]
    v_mfma_f32_16x16x32_bf16 v[76:79], a[76:79], a[28:31], v[76:79]
    v_mfma_f32_16x16x32_bf16 v[80:83], a[76:79], a[32:35], v[80:83]
    buffer_load_dwordx4 v212, s[20:23], s46 offen offset:768 nt lds
    v_mfma_f32_16x16x32_bf16 v[84:87], a[76:79], a[36:39], v[84:87]
    v_mfma_f32_16x16x32_bf16 v[88:91], a[76:79], a[40:43], v[88:91]
    v_mfma_f32_16x16x32_bf16 v[92:95], a[76:79], a[44:47], v[92:95]
    s_waitcnt vmcnt(18) lgkmcnt(0)
    s_barrier
    v_add_u32 v216, 135168, v214
    v_add_u32 v217, 118272, v215
    s_lshl_b32 s44, s42, 19
    s_add_u32 s44, s44, s51
    s_add_u32 s42, s42, 1
    s_cmp_ge_u32 s42, 10
    s_cselect_b32 s42, 0, s42
    s_add_u32 m0, s49, 101376
    v_mfma_f32_16x16x32_bf16 v[0:3], a[128:131], a[80:83], v[0:3]
    v_mfma_f32_16x16x32_bf16 v[4:7], a[128:131], a[84:87], v[4:7]
    v_mfma_f32_16x16x32_bf16 v[8:11], a[128:131], a[88:91], v[8:11]
    buffer_load_dwordx4 v219, s[96:99], s44 offen lds
    ds_read_b128 a[0:3], v216 offset:0
    ds_read_b128 a[4:7], v216 offset:512
    s_add_u32 s44, s44, 8192
    s_add_u32 m0, s49, 102432
    v_mfma_f32_16x16x32_bf16 v[12:15], a[128:131], a[92:95], v[12:15]
    v_mfma_f32_16x16x32_bf16 v[16:19], a[128:131], a[96:99], v[16:19]
    v_mfma_f32_16x16x32_bf16 v[20:23], a[128:131], a[100:103], v[20:23]
    buffer_load_dwordx4 v219, s[96:99], s44 offen lds
    ds_read_b128 a[8:11], v216 offset:1024
    ds_read_b128 a[12:15], v216 offset:1536
    s_add_u32 s44, s44, 8192
    s_add_u32 m0, s49, 103488
    v_mfma_f32_16x16x32_bf16 v[24:27], a[132:135], a[80:83], v[24:27]
    v_mfma_f32_16x16x32_bf16 v[28:31], a[132:135], a[84:87], v[28:31]
    v_mfma_f32_16x16x32_bf16 v[32:35], a[132:135], a[88:91], v[32:35]
    buffer_load_dwordx4 v219, s[96:99], s44 offen lds
    ds_read_b128 a[16:19], v216 offset:2048
    ds_read_b128 a[20:23], v216 offset:2560
    ds_read_b64_tr_b16 a[48:49], v217 offset:0
    s_add_u32 s44, s44, 8192
    s_add_u32 m0, s49, 104544
    v_mfma_f32_16x16x32_bf16 v[36:39], a[132:135], a[92:95], v[36:39]
    v_mfma_f32_16x16x32_bf16 v[40:43], a[132:135], a[96:99], v[40:43]
    v_mfma_f32_16x16x32_bf16 v[44:47], a[132:135], a[100:103], v[44:47]
    buffer_load_dwordx4 v219, s[96:99], s44 offen lds
    ds_read_b64_tr_b16 a[50:51], v217 offset:8448
    ds_read_b64_tr_b16 a[52:53], v217 offset:32
    s_lshl_b32 s43, s39, 7
    s_add_u32 s43, s43, s50
    s_add_u32 s39, s39, 1
    s_cmp_ge_u32 s39, 10
    s_cselect_b32 s39, 0, s39
    s_add_u32 m0, s48, 41600
    v_mfma_f32_16x16x32_bf16 v[48:51], a[136:139], a[80:83], v[48:51]
    v_mfma_f32_16x16x32_bf16 v[52:55], a[136:139], a[84:87], v[52:55]
    v_mfma_f32_16x16x32_bf16 v[56:59], a[136:139], a[88:91], v[56:59]
    buffer_load_dwordx4 v218, s[24:27], s43 offen lds
    ds_read_b64_tr_b16 a[54:55], v217 offset:8480
    ds_read_b64_tr_b16 a[56:57], v217 offset:64
    s_add_u32 s43, s43, 40960
    s_add_u32 m0, s48, 42624
    v_mfma_f32_16x16x32_bf16 v[60:63], a[136:139], a[92:95], v[60:63]
    v_mfma_f32_16x16x32_bf16 v[64:67], a[136:139], a[96:99], v[64:67]
    v_mfma_f32_16x16x32_bf16 v[68:71], a[136:139], a[100:103], v[68:71]
    buffer_load_dwordx4 v218, s[24:27], s43 offen lds
    ds_read_b64_tr_b16 a[58:59], v217 offset:8512
    ds_read_b64_tr_b16 a[60:61], v217 offset:96
    ds_read_b64_tr_b16 a[62:63], v217 offset:8544
    s_add_u32 s43, s43, 40960
    s_add_u32 m0, s48, 43648
    v_mfma_f32_16x16x32_bf16 v[72:75], a[140:143], a[80:83], v[72:75]
    v_mfma_f32_16x16x32_bf16 v[76:79], a[140:143], a[84:87], v[76:79]
    v_mfma_f32_16x16x32_bf16 v[80:83], a[140:143], a[88:91], v[80:83]
    buffer_load_dwordx4 v218, s[24:27], s43 offen lds
    ds_read_b128 a[24:27], v216 offset:64
    ds_read_b128 a[28:31], v216 offset:576
    v_mfma_f32_16x16x32_bf16 v[84:87], a[140:143], a[92:95], v[84:87]
    v_mfma_f32_16x16x32_bf16 v[88:91], a[140:143], a[96:99], v[88:91]
    v_mfma_f32_16x16x32_bf16 v[92:95], a[140:143], a[100:103], v[92:95]
    ds_read_b128 a[32:35], v216 offset:1088
    ds_read_b128 a[36:39], v216 offset:1600
    s_add_u32 s43, s43, 40960
    s_add_u32 m0, s48, 44672
    v_mfma_f32_16x16x32_bf16 v[0:3], a[144:147], a[104:107], v[0:3]
    v_mfma_f32_16x16x32_bf16 v[4:7], a[144:147], a[108:111], v[4:7]
    v_mfma_f32_16x16x32_bf16 v[8:11], a[144:147], a[112:115], v[8:11]
    buffer_load_dwordx4 v218, s[24:27], s43 offen lds
    ds_read_b128 a[40:43], v216 offset:2112
    ds_read_b128 a[44:47], v216 offset:2624
    ds_read_b64_tr_b16 a[64:65], v217 offset:512
    s_add_u32 s43, s43, 40960
    s_add_u32 m0, s48, 45696
    v_mfma_f32_16x16x32_bf16 v[12:15], a[144:147], a[116:119], v[12:15]
    v_mfma_f32_16x16x32_bf16 v[16:19], a[144:147], a[120:123], v[16:19]
    v_mfma_f32_16x16x32_bf16 v[20:23], a[144:147], a[124:127], v[20:23]
    buffer_load_dwordx4 v218, s[24:27], s43 offen lds
    ds_read_b64_tr_b16 a[66:67], v217 offset:8960
    ds_read_b64_tr_b16 a[68:69], v217 offset:544
    s_add_u32 s43, s43, 40960
    s_add_u32 m0, s48, 46720
    v_mfma_f32_16x16x32_bf16 v[24:27], a[148:151], a[104:107], v[24:27]
    v_mfma_f32_16x16x32_bf16 v[28:31], a[148:151], a[108:111], v[28:31]
    v_mfma_f32_16x16x32_bf16 v[32:35], a[148:151], a[112:115], v[32:35]
    buffer_load_dwordx4 v218, s[24:27], s43 offen lds
    ds_read_b64_tr_b16 a[70:71], v217 offset:8992
    ds_read_b64_tr_b16 a[72:73], v217 offset:576
    s_add_u32 s46, s40, 16384
    v_mfma_f32_16x16x32_bf16 v[36:39], a[148:151], a[116:119], v[36:39]
    v_mfma_f32_16x16x32_bf16 v[40:43], a[148:151], a[120:123], v[40:43]
    v_mfma_f32_16x16x32_bf16 v[44:47], a[148:151], a[124:127], v[44:47]
    buffer_load_dwordx4 a[160:163], v212, s[16:19], s46 offen nt
    ds_read_b64_tr_b16 a[74:75], v217 offset:9024
    ds_read_b64_tr_b16 a[76:77], v217 offset:608
    ds_read_b64_tr_b16 a[78:79], v217 offset:9056
    s_add_u32 s46, s40, 16384
    v_mfma_f32_16x16x32_bf16 v[48:51], a[152:155], a[104:107], v[48:51]
    v_mfma_f32_16x16x32_bf16 v[52:55], a[152:155], a[108:111], v[52:55]
    v_mfma_f32_16x16x32_bf16 v[56:59], a[152:155], a[112:115], v[56:59]
    buffer_load_dwordx4 a[164:167], v212, s[20:23], s46 offen nt
    s_add_u32 s46, s40, 16384
    v_mfma_f32_16x16x32_bf16 v[60:63], a[152:155], a[116:119], v[60:63]
    v_mfma_f32_16x16x32_bf16 v[64:67], a[152:155], a[120:123], v[64:67]
    v_mfma_f32_16x16x32_bf16 v[68:71], a[152:155], a[124:127], v[68:71]
    buffer_load_dwordx4 a[168:171], v212, s[16:19], s46 offen offset:256 nt
    s_add_u32 s46, s40, 16384
    v_mfma_f32_16x16x32_bf16 v[72:75], a[156:159], a[104:107], v[72:75]
    v_mfma_f32_16x16x32_bf16 v[76:79], a[156:159], a[108:111], v[76:79]
    v_mfma_f32_16x16x32_bf16 v[80:83], a[156:159], a[112:115], v[80:83]
    buffer_load_dwordx4 a[172:175], v212, s[20:23], s46 offen offset:256 nt
    v_mfma_f32_16x16x32_bf16 v[84:87], a[156:159], a[116:119], v[84:87]
    v_mfma_f32_16x16x32_bf16 v[88:91], a[156:159], a[120:123], v[88:91]
    v_mfma_f32_16x16x32_bf16 v[92:95], a[156:159], a[124:127], v[92:95]
    s_waitcnt vmcnt(18) lgkmcnt(0)
    s_barrier
    v_add_u32 v216, 16896, v214
    v_add_u32 v217, 84480, v215
    s_lshl_b32 s44, s42, 19
    s_add_u32 s44, s44, s51
    s_add_u32 s42, s42, 1
    s_cmp_ge_u32 s42, 10
    s_cselect_b32 s42, 0, s42
    s_add_u32 m0, s49, 118272
    v_mfma_f32_16x16x32_bf16 v[0:3], a[48:51], a[0:3], v[0:3]
    v_mfma_f32_16x16x32_bf16 v[4:7], a[48:51], a[4:7], v[4:7]
    v_mfma_f32_16x16x32_bf16 v[8:11], a[48:51], a[8:11], v[8:11]
    buffer_load_dwordx4 v219, s[96:99], s44 offen lds
    ds_read_b128 a[80:83], v216 offset:0
    ds_read_b128 a[84:87], v216 offset:512
    s_add_u32 s44, s44, 8192
    s_add_u32 m0, s49, 119328
    v_mfma_f32_16x16x32_bf16 v[12:15], a[48:51], a[12:15], v[12:15]
    v_mfma_f32_16x16x32_bf16 v[16:19], a[48:51], a[16:19], v[16:19]
    v_mfma_f32_16x16x32_bf16 v[20:23], a[48:51], a[20:23], v[20:23]
    buffer_load_dwordx4 v219, s[96:99], s44 offen lds
    ds_read_b128 a[88:91], v216 offset:1024
    ds_read_b128 a[92:95], v216 offset:1536
    s_add_u32 s44, s44, 8192
    s_add_u32 m0, s49, 120384
    v_mfma_f32_16x16x32_bf16 v[24:27], a[52:55], a[0:3], v[24:27]
    v_mfma_f32_16x16x32_bf16 v[28:31], a[52:55], a[4:7], v[28:31]
    v_mfma_f32_16x16x32_bf16 v[32:35], a[52:55], a[8:11], v[32:35]
    buffer_load_dwordx4 v219, s[96:99], s44 offen lds
    ds_read_b128 a[96:99], v216 offset:2048
    ds_read_b128 a[100:103], v216 offset:2560
    ds_read_b64_tr_b16 a[128:129], v217 offset:0
    s_add_u32 s44, s44, 8192
    s_add_u32 m0, s49, 121440
    v_mfma_f32_16x16x32_bf16 v[36:39], a[52:55], a[12:15], v[36:39]
    v_mfma_f32_16x16x32_bf16 v[40:43], a[52:55], a[16:19], v[40:43]
    v_mfma_f32_16x16x32_bf16 v[44:47], a[52:55], a[20:23], v[44:47]
    buffer_load_dwordx4 v219, s[96:99], s44 offen lds
    ds_read_b64_tr_b16 a[130:131], v217 offset:8448
    ds_read_b64_tr_b16 a[132:133], v217 offset:32
    s_lshl_b32 s43, s39, 7
    s_add_u32 s43, s43, s50
    s_add_u32 s39, s39, 1
    s_cmp_ge_u32 s39, 10
    s_cselect_b32 s39, 0, s39
    s_add_u32 m0, s48, 135168
    v_mfma_f32_16x16x32_bf16 v[48:51], a[56:59], a[0:3], v[48:51]
    v_mfma_f32_16x16x32_bf16 v[52:55], a[56:59], a[4:7], v[52:55]
    v_mfma_f32_16x16x32_bf16 v[56:59], a[56:59], a[8:11], v[56:59]
    buffer_load_dwordx4 v218, s[24:27], s43 offen lds
    ds_read_b64_tr_b16 a[134:135], v217 offset:8480
    ds_read_b64_tr_b16 a[136:137], v217 offset:64
    s_add_u32 s43, s43, 40960
    s_add_u32 m0, s48, 136192
    v_mfma_f32_16x16x32_bf16 v[60:63], a[56:59], a[12:15], v[60:63]
    v_mfma_f32_16x16x32_bf16 v[64:67], a[56:59], a[16:19], v[64:67]
    v_mfma_f32_16x16x32_bf16 v[68:71], a[56:59], a[20:23], v[68:71]
    buffer_load_dwordx4 v218, s[24:27], s43 offen lds
    ds_read_b64_tr_b16 a[138:139], v217 offset:8512
    ds_read_b64_tr_b16 a[140:141], v217 offset:96
    ds_read_b64_tr_b16 a[142:143], v217 offset:8544
    s_add_u32 s43, s43, 40960
    s_add_u32 m0, s48, 137216
    v_mfma_f32_16x16x32_bf16 v[72:75], a[60:63], a[0:3], v[72:75]
    v_mfma_f32_16x16x32_bf16 v[76:79], a[60:63], a[4:7], v[76:79]
    v_mfma_f32_16x16x32_bf16 v[80:83], a[60:63], a[8:11], v[80:83]
    buffer_load_dwordx4 v218, s[24:27], s43 offen lds
    ds_read_b128 a[104:107], v216 offset:64
    ds_read_b128 a[108:111], v216 offset:576
    v_mfma_f32_16x16x32_bf16 v[84:87], a[60:63], a[12:15], v[84:87]
    v_mfma_f32_16x16x32_bf16 v[88:91], a[60:63], a[16:19], v[88:91]
    v_mfma_f32_16x16x32_bf16 v[92:95], a[60:63], a[20:23], v[92:95]
    ds_read_b128 a[112:115], v216 offset:1088
    ds_read_b128 a[116:119], v216 offset:1600
    s_add_u32 s43, s43, 40960
    s_add_u32 m0, s48, 138240
    v_mfma_f32_16x16x32_bf16 v[0:3], a[64:67], a[24:27], v[0:3]
    v_mfma_f32_16x16x32_bf16 v[4:7], a[64:67], a[28:31], v[4:7]
    v_mfma_f32_16x16x32_bf16 v[8:11], a[64:67], a[32:35], v[8:11]
    buffer_load_dwordx4 v218, s[24:27], s43 offen lds
    ds_read_b128 a[120:123], v216 offset:2112
    ds_read_b128 a[124:127], v216 offset:2624
    ds_read_b64_tr_b16 a[144:145], v217 offset:512
    s_add_u32 s43, s43, 40960
    s_add_u32 m0, s48, 139264
    v_mfma_f32_16x16x32_bf16 v[12:15], a[64:67], a[36:39], v[12:15]
    v_mfma_f32_16x16x32_bf16 v[16:19], a[64:67], a[40:43], v[16:19]
    v_mfma_f32_16x16x32_bf16 v[20:23], a[64:67], a[44:47], v[20:23]
    buffer_load_dwordx4 v218, s[24:27], s43 offen lds
    ds_read_b64_tr_b16 a[146:147], v217 offset:8960
    ds_read_b64_tr_b16 a[148:149], v217 offset:544
    s_add_u32 s43, s43, 40960
    s_add_u32 m0, s48, 140288
    v_mfma_f32_16x16x32_bf16 v[24:27], a[68:71], a[24:27], v[24:27]
    v_mfma_f32_16x16x32_bf16 v[28:31], a[68:71], a[28:31], v[28:31]
    v_mfma_f32_16x16x32_bf16 v[32:35], a[68:71], a[32:35], v[32:35]
    buffer_load_dwordx4 v218, s[24:27], s43 offen lds
    ds_read_b64_tr_b16 a[150:151], v217 offset:8992
    ds_read_b64_tr_b16 a[152:153], v217 offset:576
    s_add_u32 s46, s40, 16384
    v_mfma_f32_16x16x32_bf16 v[36:39], a[68:71], a[36:39], v[36:39]
    v_mfma_f32_16x16x32_bf16 v[40:43], a[68:71], a[40:43], v[40:43]
    v_mfma_f32_16x16x32_bf16 v[44:47], a[68:71], a[44:47], v[44:47]
    buffer_load_dwordx4 a[176:179], v212, s[16:19], s46 offen offset:512 nt
    ds_read_b64_tr_b16 a[154:155], v217 offset:9024
    ds_read_b64_tr_b16 a[156:157], v217 offset:608
    ds_read_b64_tr_b16 a[158:159], v217 offset:9056
    s_add_u32 s46, s40, 16384
    v_mfma_f32_16x16x32_bf16 v[48:51], a[72:75], a[24:27], v[48:51]
    v_mfma_f32_16x16x32_bf16 v[52:55], a[72:75], a[28:31], v[52:55]
    v_mfma_f32_16x16x32_bf16 v[56:59], a[72:75], a[32:35], v[56:59]
    buffer_load_dwordx4 a[180:183], v212, s[20:23], s46 offen offset:512 nt
    s_add_u32 s46, s40, 16384
    v_mfma_f32_16x16x32_bf16 v[60:63], a[72:75], a[36:39], v[60:63]
    v_mfma_f32_16x16x32_bf16 v[64:67], a[72:75], a[40:43], v[64:67]
    v_mfma_f32_16x16x32_bf16 v[68:71], a[72:75], a[44:47], v[68:71]
    buffer_load_dwordx4 a[184:187], v212, s[16:19], s46 offen offset:768 nt
    s_add_u32 s46, s40, 16384
    v_mfma_f32_16x16x32_bf16 v[72:75], a[76:79], a[24:27], v[72:75]
    v_mfma_f32_16x16x32_bf16 v[76:79], a[76:79], a[28:31], v[76:79]
    v_mfma_f32_16x16x32_bf16 v[80:83], a[76:79], a[32:35], v[80:83]
    buffer_load_dwordx4 a[188:191], v212, s[20:23], s46 offen offset:768 nt
    v_mfma_f32_16x16x32_bf16 v[84:87], a[76:79], a[36:39], v[84:87]
    v_mfma_f32_16x16x32_bf16 v[88:91], a[76:79], a[40:43], v[88:91]
    v_mfma_f32_16x16x32_bf16 v[92:95], a[76:79], a[44:47], v[92:95]
    s_waitcnt vmcnt(18) lgkmcnt(0)
    s_barrier
    v_add_u32 v216, 41600, v214
    v_add_u32 v217, 101376, v215
    v_mfma_f32_16x16x32_bf16 v[0:3], a[128:131], a[80:83], v[0:3]
    v_mfma_f32_16x16x32_bf16 v[4:7], a[128:131], a[84:87], v[4:7]
    v_mfma_f32_16x16x32_bf16 v[8:11], a[128:131], a[88:91], v[8:11]
    ds_read_b128 a[0:3], v216 offset:0
    ds_read_b128 a[4:7], v216 offset:512
    v_mfma_f32_16x16x32_bf16 v[12:15], a[128:131], a[92:95], v[12:15]
    v_mfma_f32_16x16x32_bf16 v[16:19], a[128:131], a[96:99], v[16:19]
    v_mfma_f32_16x16x32_bf16 v[20:23], a[128:131], a[100:103], v[20:23]
    ds_read_b128 a[8:11], v216 offset:1024
    ds_read_b128 a[12:15], v216 offset:1536
    v_mfma_f32_16x16x32_bf16 v[24:27], a[132:135], a[80:83], v[24:27]
    v_mfma_f32_16x16x32_bf16 v[28:31], a[132:135], a[84:87], v[28:31]
    v_mfma_f32_16x16x32_bf16 v[32:35], a[132:135], a[88:91], v[32:35]
    ds_read_b128 a[16:19], v216 offset:2048
    ds_read_b128 a[20:23], v216 offset:2560
    ds_read_b64_tr_b16 a[48:49], v217 offset:0
    v_mfma_f32_16x16x32_bf16 v[36:39], a[132:135], a[92:95], v[36:39]
    v_mfma_f32_16x16x32_bf16 v[40:43], a[132:135], a[96:99], v[40:43]
    v_mfma_f32_16x16x32_bf16 v[44:47], a[132:135], a[100:103], v[44:47]
    ds_read_b64_tr_b16 a[50:51], v217 offset:8448
    ds_read_b64_tr_b16 a[52:53], v217 offset:32
    v_mfma_f32_16x16x32_bf16 v[48:51], a[136:139], a[80:83], v[48:51]
    v_mfma_f32_16x16x32_bf16 v[52:55], a[136:139], a[84:87], v[52:55]
    v_mfma_f32_16x16x32_bf16 v[56:59], a[136:139], a[88:91], v[56:59]
    ds_read_b64_tr_b16 a[54:55], v217 offset:8480
    ds_read_b64_tr_b16 a[56:57], v217 offset:64
    v_mfma_f32_16x16x32_bf16 v[60:63], a[136:139], a[92:95], v[60:63]
    v_mfma_f32_16x16x32_bf16 v[64:67], a[136:139], a[96:99], v[64:67]
    v_mfma_f32_16x16x32_bf16 v[68:71], a[136:139], a[100:103], v[68:71]
    ds_read_b64_tr_b16 a[58:59], v217 offset:8512
    ds_read_b64_tr_b16 a[60:61], v217 offset:96
    ds_read_b64_tr_b16 a[62:63], v217 offset:8544
    v_mfma_f32_16x16x32_bf16 v[72:75], a[140:143], a[80:83], v[72:75]
    v_mfma_f32_16x16x32_bf16 v[76:79], a[140:143], a[84:87], v[76:79]
    v_mfma_f32_16x16x32_bf16 v[80:83], a[140:143], a[88:91], v[80:83]
    ds_read_b128 a[24:27], v216 offset:64
    ds_read_b128 a[28:31], v216 offset:576
    v_mfma_f32_16x16x32_bf16 v[84:87], a[140:143], a[92:95], v[84:87]
    v_mfma_f32_16x16x32_bf16 v[88:91], a[140:143], a[96:99], v[88:91]
    v_mfma_f32_16x16x32_bf16 v[92:95], a[140:143], a[100:103], v[92:95]
    ds_read_b128 a[32:35], v216 offset:1088
    ds_read_b128 a[36:39], v216 offset:1600
    v_mfma_f32_16x16x32_bf16 v[0:3], a[144:147], a[104:107], v[0:3]
    v_mfma_f32_16x16x32_bf16 v[4:7], a[144:147], a[108:111], v[4:7]
    v_mfma_f32_16x16x32_bf16 v[8:11], a[144:147], a[112:115], v[8:11]
    ds_read_b128 a[40:43], v216 offset:2112
    ds_read_b128 a[44:47], v216 offset:2624
    ds_read_b64_tr_b16 a[64:65], v217 offset:512
    v_mfma_f32_16x16x32_bf16 v[12:15], a[144:147], a[116:119], v[12:15]
    v_mfma_f32_16x16x32_bf16 v[16:19], a[144:147], a[120:123], v[16:19]
    v_mfma_f32_16x16x32_bf16 v[20:23], a[144:147], a[124:127], v[20:23]
    ds_read_b64_tr_b16 a[66:67], v217 offset:8960
    ds_read_b64_tr_b16 a[68:69], v217 offset:544
    v_mfma_f32_16x16x32_bf16 v[24:27], a[148:151], a[104:107], v[24:27]
    v_mfma_f32_16x16x32_bf16 v[28:31], a[148:151], a[108:111], v[28:31]
    v_mfma_f32_16x16x32_bf16 v[32:35], a[148:151], a[112:115], v[32:35]
    ds_read_b64_tr_b16 a[70:71], v217 offset:8992
    ds_read_b64_tr_b16 a[72:73], v217 offset:576
    v_mfma_f32_16x16x32_bf16 v[36:39], a[148:151], a[116:119], v[36:39]
    v_mfma_f32_16x16x32_bf16 v[40:43], a[148:151], a[120:123], v[40:43]
    v_mfma_f32_16x16x32_bf16 v[44:47], a[148:151], a[124:127], v[44:47]
    ds_read_b64_tr_b16 a[74:75], v217 offset:9024
    ds_read_b64_tr_b16 a[76:77], v217 offset:608
    ds_read_b64_tr_b16 a[78:79], v217 offset:9056
    v_mfma_f32_16x16x32_bf16 v[48:51], a[152:155], a[104:107], v[48:51]
    v_mfma_f32_16x16x32_bf16 v[52:55], a[152:155], a[108:111], v[52:55]
    v_mfma_f32_16x16x32_bf16 v[56:59], a[152:155], a[112:115], v[56:59]
    v_mfma_f32_16x16x32_bf16 v[60:63], a[152:155], a[116:119], v[60:63]
    v_mfma_f32_16x16x32_bf16 v[64:67], a[152:155], a[120:123], v[64:67]
    v_mfma_f32_16x16x32_bf16 v[68:71], a[152:155], a[124:127], v[68:71]
    v_mfma_f32_16x16x32_bf16 v[72:75], a[156:159], a[104:107], v[72:75]
    v_mfma_f32_16x16x32_bf16 v[76:79], a[156:159], a[108:111], v[76:79]
    v_mfma_f32_16x16x32_bf16 v[80:83], a[156:159], a[112:115], v[80:83]
    v_mfma_f32_16x16x32_bf16 v[84:87], a[156:159], a[116:119], v[84:87]
    v_mfma_f32_16x16x32_bf16 v[88:91], a[156:159], a[120:123], v[88:91]
    v_mfma_f32_16x16x32_bf16 v[92:95], a[156:159], a[124:127], v[92:95]
    s_waitcnt vmcnt(4) lgkmcnt(0)
    s_barrier
    v_add_u32 v216, 135168, v214
    v_add_u32 v217, 118272, v215
    v_mfma_f32_16x16x32_bf16 v[0:3], a[48:51], a[0:3], v[0:3]
    v_mfma_f32_16x16x32_bf16 v[4:7], a[48:51], a[4:7], v[4:7]
    v_mfma_f32_16x16x32_bf16 v[8:11], a[48:51], a[8:11], v[8:11]
    ds_read_b128 a[80:83], v216 offset:0
    ds_read_b128 a[84:87], v216 offset:512
    v_mfma_f32_16x16x32_bf16 v[12:15], a[48:51], a[12:15], v[12:15]
    v_mfma_f32_16x16x32_bf16 v[16:19], a[48:51], a[16:19], v[16:19]
    v_mfma_f32_16x16x32_bf16 v[20:23], a[48:51], a[20:23], v[20:23]
    ds_read_b128 a[88:91], v216 offset:1024
    ds_read_b128 a[92:95], v216 offset:1536
    v_mfma_f32_16x16x32_bf16 v[24:27], a[52:55], a[0:3], v[24:27]
    v_mfma_f32_16x16x32_bf16 v[28:31], a[52:55], a[4:7], v[28:31]
    v_mfma_f32_16x16x32_bf16 v[32:35], a[52:55], a[8:11], v[32:35]
    ds_read_b128 a[96:99], v216 offset:2048
    ds_read_b128 a[100:103], v216 offset:2560
    ds_read_b64_tr_b16 a[128:129], v217 offset:0
    v_mfma_f32_16x16x32_bf16 v[36:39], a[52:55], a[12:15], v[36:39]
    v_mfma_f32_16x16x32_bf16 v[40:43], a[52:55], a[16:19], v[40:43]
    v_mfma_f32_16x16x32_bf16 v[44:47], a[52:55], a[20:23], v[44:47]
    ds_read_b64_tr_b16 a[130:131], v217 offset:8448
    ds_read_b64_tr_b16 a[132:133], v217 offset:32
    v_mfma_f32_16x16x32_bf16 v[48:51], a[56:59], a[0:3], v[48:51]
    v_mfma_f32_16x16x32_bf16 v[52:55], a[56:59], a[4:7], v[52:55]
    v_mfma_f32_16x16x32_bf16 v[56:59], a[56:59], a[8:11], v[56:59]
    ds_read_b64_tr_b16 a[134:135], v217 offset:8480
    ds_read_b64_tr_b16 a[136:137], v217 offset:64
    v_mfma_f32_16x16x32_bf16 v[60:63], a[56:59], a[12:15], v[60:63]
    v_mfma_f32_16x16x32_bf16 v[64:67], a[56:59], a[16:19], v[64:67]
    v_mfma_f32_16x16x32_bf16 v[68:71], a[56:59], a[20:23], v[68:71]
    ds_read_b64_tr_b16 a[138:139], v217 offset:8512
    ds_read_b64_tr_b16 a[140:141], v217 offset:96
    ds_read_b64_tr_b16 a[142:143], v217 offset:8544
    v_mfma_f32_16x16x32_bf16 v[72:75], a[60:63], a[0:3], v[72:75]
    v_mfma_f32_16x16x32_bf16 v[76:79], a[60:63], a[4:7], v[76:79]
    v_mfma_f32_16x16x32_bf16 v[80:83], a[60:63], a[8:11], v[80:83]
    ds_read_b128 a[104:107], v216 offset:64
    ds_read_b128 a[108:111], v216 offset:576
    v_mfma_f32_16x16x32_bf16 v[84:87], a[60:63], a[12:15], v[84:87]
    v_mfma_f32_16x16x32_bf16 v[88:91], a[60:63], a[16:19], v[88:91]
    v_mfma_f32_16x16x32_bf16 v[92:95], a[60:63], a[20:23], v[92:95]
    ds_read_b128 a[112:115], v216 offset:1088
    ds_read_b128 a[116:119], v216 offset:1600
    v_mfma_f32_16x16x32_bf16 v[0:3], a[64:67], a[24:27], v[0:3]
    v_mfma_f32_16x16x32_bf16 v[4:7], a[64:67], a[28:31], v[4:7]
    v_mfma_f32_16x16x32_bf16 v[8:11], a[64:67], a[32:35], v[8:11]
    ds_read_b128 a[120:123], v216 offset:2112
    ds_read_b128 a[124:127], v216 offset:2624
    ds_read_b64_tr_b16 a[144:145], v217 offset:512
    v_mfma_f32_16x16x32_bf16 v[12:15], a[64:67], a[36:39], v[12:15]
    v_mfma_f32_16x16x32_bf16 v[16:19], a[64:67], a[40:43], v[16:19]
    v_mfma_f32_16x16x32_bf16 v[20:23], a[64:67], a[44:47], v[20:23]
    ds_read_b64_tr_b16 a[146:147], v217 offset:8960
    ds_read_b64_tr_b16 a[148:149], v217 offset:544
    v_mfma_f32_16x16x32_bf16 v[24:27], a[68:71], a[24:27], v[24:27]
    v_mfma_f32_16x16x32_bf16 v[28:31], a[68:71], a[28:31], v[28:31]
    v_mfma_f32_16x16x32_bf16 v[32:35], a[68:71], a[32:35], v[32:35]
    ds_read_b64_tr_b16 a[150:151], v217 offset:8992
    ds_read_b64_tr_b16 a[152:153], v217 offset:576
    v_mfma_f32_16x16x32_bf16 v[36:39], a[68:71], a[36:39], v[36:39]
    v_mfma_f32_16x16x32_bf16 v[40:43], a[68:71], a[40:43], v[40:43]
    v_mfma_f32_16x16x32_bf16 v[44:47], a[68:71], a[44:47], v[44:47]
    ds_read_b64_tr_b16 a[154:155], v217 offset:9024
    ds_read_b64_tr_b16 a[156:157], v217 offset:608
    ds_read_b64_tr_b16 a[158:159], v217 offset:9056
    s_waitcnt vmcnt(0)
    ds_write_b128 v220, a[160:163] offset:16896
    ds_write_b128 v221, a[164:167] offset:16896
    ds_write_b128 v220, a[168:171] offset:17952
    ds_write_b128 v221, a[172:175] offset:17952
    ds_write_b128 v220, a[176:179] offset:19008
    ds_write_b128 v221, a[180:183] offset:19008
    ds_write_b128 v220, a[184:187] offset:20064
    ds_write_b128 v221, a[188:191] offset:20064
    v_mfma_f32_16x16x32_bf16 v[48:51], a[72:75], a[24:27], v[48:51]
    v_mfma_f32_16x16x32_bf16 v[52:55], a[72:75], a[28:31], v[52:55]
    v_mfma_f32_16x16x32_bf16 v[56:59], a[72:75], a[32:35], v[56:59]
    v_mfma_f32_16x16x32_bf16 v[60:63], a[72:75], a[36:39], v[60:63]
    v_mfma_f32_16x16x32_bf16 v[64:67], a[72:75], a[40:43], v[64:67]
    v_mfma_f32_16x16x32_bf16 v[68:71], a[72:75], a[44:47], v[68:71]
    v_mfma_f32_16x16x32_bf16 v[72:75], a[76:79], a[24:27], v[72:75]
    v_mfma_f32_16x16x32_bf16 v[76:79], a[76:79], a[28:31], v[76:79]
    v_mfma_f32_16x16x32_bf16 v[80:83], a[76:79], a[32:35], v[80:83]
    v_mfma_f32_16x16x32_bf16 v[84:87], a[76:79], a[36:39], v[84:87]
    v_mfma_f32_16x16x32_bf16 v[88:91], a[76:79], a[40:43], v[88:91]
    v_mfma_f32_16x16x32_bf16 v[92:95], a[76:79], a[44:47], v[92:95]
    s_waitcnt lgkmcnt(0)
    s_barrier
    s_mul_i32 s45, s52, 27648
    s_add_u32 s45, s45, 118272
    s_cmp_eq_u32 s52, 0
    s_mov_b32 s46, 50688
    s_cselect_b32 s46, 132096, s46
    v_and_b32 v206, 15, v253
    v_mul_u32_u24 v206, 288, v206
    v_lshrrev_b32 v207, 4, v253
    v_lshl_add_u32 v208, v207, 4, v206
    v_add_u32 v202, s45, v208
    v_add_u32 v203, s46, v208
    v_lshl_add_u32 v208, v207, 3, v206
    s_lshl_b32 s43, s53, 7
    v_add_u32 v208, s43, v208
    v_add_u32 v204, s45, v208
    v_add_u32 v205, s46, v208
    v_mov_b32 v206, 0x3e0293ee
    v_mfma_f32_16x16x32_bf16 v[0:3], a[128:131], a[80:83], v[0:3]
    v_mfma_f32_16x16x32_bf16 v[4:7], a[128:131], a[84:87], v[4:7]
    v_mfma_f32_16x16x32_bf16 v[8:11], a[128:131], a[88:91], v[8:11]
    v_mfma_f32_16x16x32_bf16 v[0:3], a[144:147], a[104:107], v[0:3]
    v_mfma_f32_16x16x32_bf16 v[4:7], a[144:147], a[108:111], v[4:7]
    v_mfma_f32_16x16x32_bf16 v[8:11], a[144:147], a[112:115], v[8:11]
    v_mfma_f32_16x16x32_bf16 v[12:15], a[128:131], a[92:95], v[12:15]
    v_mfma_f32_16x16x32_bf16 v[16:19], a[128:131], a[96:99], v[16:19]
    v_mfma_f32_16x16x32_bf16 v[20:23], a[128:131], a[100:103], v[20:23]
    v_mfma_f32_16x16x32_bf16 v[12:15], a[144:147], a[116:119], v[12:15]
    v_mfma_f32_16x16x32_bf16 v[16:19], a[144:147], a[120:123], v[16:19]
    v_mfma_f32_16x16x32_bf16 v[20:23], a[144:147], a[124:127], v[20:23]
    v_mfma_f32_16x16x32_bf16 v[24:27], a[132:135], a[80:83], v[24:27]
    v_pk_mul_f32 v[0:1], v[0:1], v[206:207] op_sel_hi:[1,0]
    v_pk_mul_f32 v[2:3], v[2:3], v[206:207] op_sel_hi:[1,0]
    v_cvt_pk_bf16_f32 v0, v0, v1
    v_mfma_f32_16x16x32_bf16 v[28:31], a[132:135], a[84:87], v[28:31]
    v_cvt_pk_bf16_f32 v1, v2, v3
    ds_write_b64 v204, v[0:1] offset:0
    v_pk_mul_f32 v[4:5], v[4:5], v[206:207] op_sel_hi:[1,0]
    v_mfma_f32_16x16x32_bf16 v[32:35], a[132:135], a[88:91], v[32:35]
    v_pk_mul_f32 v[6:7], v[6:7], v[206:207] op_sel_hi:[1,0]
    v_cvt_pk_bf16_f32 v4, v4, v5
    v_cvt_pk_bf16_f32 v5, v6, v7
    v_mfma_f32_16x16x32_bf16 v[24:27], a[148:151], a[104:107], v[24:27]
    ds_write_b64 v204, v[4:5] offset:4608
    v_pk_mul_f32 v[8:9], v[8:9], v[206:207] op_sel_hi:[1,0]
    v_pk_mul_f32 v[10:11], v[10:11], v[206:207] op_sel_hi:[1,0]
    v_mfma_f32_16x16x32_bf16 v[28:31], a[148:151], a[108:111], v[28:31]
    v_cvt_pk_bf16_f32 v8, v8, v9
    v_cvt_pk_bf16_f32 v9, v10, v11
    ds_write_b64 v204, v[8:9] offset:9216
    v_mfma_f32_16x16x32_bf16 v[32:35], a[148:151], a[112:115], v[32:35]
    v_mfma_f32_16x16x32_bf16 v[36:39], a[132:135], a[92:95], v[36:39]
    v_pk_mul_f32 v[12:13], v[12:13], v[206:207] op_sel_hi:[1,0]
    v_pk_mul_f32 v[14:15], v[14:15], v[206:207] op_sel_hi:[1,0]
    v_cvt_pk_bf16_f32 v12, v12, v13
    v_mfma_f32_16x16x32_bf16 v[40:43], a[132:135], a[96:99], v[40:43]
    v_cvt_pk_bf16_f32 v13, v14, v15
    ds_write_b64 v205, v[12:13] offset:0
    v_pk_mul_f32 v[16:17], v[16:17], v[206:207] op_sel_hi:[1,0]
    v_mfma_f32_16x16x32_bf16 v[44:47], a[132:135], a[100:103], v[44:47]
    v_pk_mul_f32 v[18:19], v[18:19], v[206:207] op_sel_hi:[1,0]
    v_cvt_pk_bf16_f32 v16, v16, v17
    v_cvt_pk_bf16_f32 v17, v18, v19
    v_mfma_f32_16x16x32_bf16 v[36:39], a[148:151], a[116:119], v[36:39]
    ds_write_b64 v205, v[16:17] offset:4608
    v_pk_mul_f32 v[20:21], v[20:21], v[206:207] op_sel_hi:[1,0]
    v_pk_mul_f32 v[22:23], v[22:23], v[206:207] op_sel_hi:[1,0]
    v_mfma_f32_16x16x32_bf16 v[40:43], a[148:151], a[120:123], v[40:43]
    v_cvt_pk_bf16_f32 v20, v20, v21
    v_cvt_pk_bf16_f32 v21, v22, v23
    ds_write_b64 v205, v[20:21] offset:9216
    v_mfma_f32_16x16x32_bf16 v[44:47], a[148:151], a[124:127], v[44:47]
    v_mfma_f32_16x16x32_bf16 v[48:51], a[136:139], a[80:83], v[48:51]
    v_pk_mul_f32 v[24:25], v[24:25], v[206:207] op_sel_hi:[1,0]
    v_pk_mul_f32 v[26:27], v[26:27], v[206:207] op_sel_hi:[1,0]
    v_cvt_pk_bf16_f32 v24, v24, v25
    v_mfma_f32_16x16x32_bf16 v[52:55], a[136:139], a[84:87], v[52:55]
    v_cvt_pk_bf16_f32 v25, v26, v27
    ds_write_b64 v204, v[24:25] offset:32
    v_pk_mul_f32 v[28:29], v[28:29], v[206:207] op_sel_hi:[1,0]
    v_mfma_f32_16x16x32_bf16 v[56:59], a[136:139], a[88:91], v[56:59]
    v_pk_mul_f32 v[30:31], v[30:31], v[206:207] op_sel_hi:[1,0]
    v_cvt_pk_bf16_f32 v28, v28, v29
    v_cvt_pk_bf16_f32 v29, v30, v31
    v_mfma_f32_16x16x32_bf16 v[48:51], a[152:155], a[104:107], v[48:51]
    ds_write_b64 v204, v[28:29] offset:4640
    v_pk_mul_f32 v[32:33], v[32:33], v[206:207] op_sel_hi:[1,0]
    v_pk_mul_f32 v[34:35], v[34:35], v[206:207] op_sel_hi:[1,0]
    v_mfma_f32_16x16x32_bf16 v[52:55], a[152:155], a[108:111], v[52:55]
    v_cvt_pk_bf16_f32 v32, v32, v33
    v_cvt_pk_bf16_f32 v33, v34, v35
    ds_write_b64 v204, v[32:33] offset:9248
    v_mfma_f32_16x16x32_bf16 v[56:59], a[152:155], a[112:115], v[56:59]
    v_mfma_f32_16x16x32_bf16 v[60:63], a[136:139], a[92:95], v[60:63]
    v_pk_mul_f32 v[36:37], v[36:37], v[206:207] op_sel_hi:[1,0]
    v_pk_mul_f32 v[38:39], v[38:39], v[206:207] op_sel_hi:[1,0]
    v_cvt_pk_bf16_f32 v36, v36, v37
    v_mfma_f32_16x16x32_bf16 v[64:67], a[136:139], a[96:99], v[64:67]
    v_cvt_pk_bf16_f32 v37, v38, v39
    ds_write_b64 v205, v[36:37] offset:32
    v_pk_mul_f32 v[40:41], v[40:41], v[206:207] op_sel_hi:[1,0]
    v_mfma_f32_16x16x32_bf16 v[68:71], a[136:139], a[100:103], v[68:71]
    v_pk_mul_f32 v[42:43], v[42:43], v[206:207] op_sel_hi:[1,0]
    v_cvt_pk_bf16_f32 v40, v40, v41
    v_cvt_pk_bf16_f32 v41, v42, v43
    v_mfma_f32_16x16x32_bf16 v[60:63], a[152:155], a[116:119], v[60:63]
    ds_write_b64 v205, v[40:41] offset:4640
    v_pk_mul_f32 v[44:45], v[44:45], v[206:207] op_sel_hi:[1,0]
    v_pk_mul_f32 v[46:47], v[46:47], v[206:207] op_sel_hi:[1,0]
    v_mfma_f32_16x16x32_bf16 v[64:67], a[152:155], a[120:123], v[64:67]
    v_cvt_pk_bf16_f32 v44, v44, v45
    v_cvt_pk_bf16_f32 v45, v46, v47
    ds_write_b64 v205, v[44:45] offset:9248
    v_mfma_f32_16x16x32_bf16 v[68:71], a[152:155], a[124:127], v[68:71]
    v_mfma_f32_16x16x32_bf16 v[72:75], a[140:143], a[80:83], v[72:75]
    v_pk_mul_f32 v[48:49], v[48:49], v[206:207] op_sel_hi:[1,0]
    v_pk_mul_f32 v[50:51], v[50:51], v[206:207] op_sel_hi:[1,0]
    v_cvt_pk_bf16_f32 v48, v48, v49
    v_mfma_f32_16x16x32_bf16 v[76:79], a[140:143], a[84:87], v[76:79]
    v_cvt_pk_bf16_f32 v49, v50, v51
    ds_write_b64 v204, v[48:49] offset:64
    v_pk_mul_f32 v[52:53], v[52:53], v[206:207] op_sel_hi:[1,0]
    v_mfma_f32_16x16x32_bf16 v[80:83], a[140:143], a[88:91], v[80:83]
    v_pk_mul_f32 v[54:55], v[54:55], v[206:207] op_sel_hi:[1,0]
    v_cvt_pk_bf16_f32 v52, v52, v53
    v_cvt_pk_bf16_f32 v53, v54, v55
    v_mfma_f32_16x16x32_bf16 v[72:75], a[156:159], a[104:107], v[72:75]
    ds_write_b64 v204, v[52:53] offset:4672
    v_pk_mul_f32 v[56:57], v[56:57], v[206:207] op_sel_hi:[1,0]
    v_pk_mul_f32 v[58:59], v[58:59], v[206:207] op_sel_hi:[1,0]
    v_mfma_f32_16x16x32_bf16 v[76:79], a[156:159], a[108:111], v[76:79]
    v_cvt_pk_bf16_f32 v56, v56, v57
    v_cvt_pk_bf16_f32 v57, v58, v59
    ds_write_b64 v204, v[56:57] offset:9280
    v_mfma_f32_16x16x32_bf16 v[80:83], a[156:159], a[112:115], v[80:83]
    v_mfma_f32_16x16x32_bf16 v[84:87], a[140:143], a[92:95], v[84:87]
    v_pk_mul_f32 v[60:61], v[60:61], v[206:207] op_sel_hi:[1,0]
    v_pk_mul_f32 v[62:63], v[62:63], v[206:207] op_sel_hi:[1,0]
    v_cvt_pk_bf16_f32 v60, v60, v61
    v_mfma_f32_16x16x32_bf16 v[88:91], a[140:143], a[96:99], v[88:91]
    v_cvt_pk_bf16_f32 v61, v62, v63
    ds_write_b64 v205, v[60:61] offset:64
    v_pk_mul_f32 v[64:65], v[64:65], v[206:207] op_sel_hi:[1,0]
    v_mfma_f32_16x16x32_bf16 v[92:95], a[140:143], a[100:103], v[92:95]
    v_pk_mul_f32 v[66:67], v[66:67], v[206:207] op_sel_hi:[1,0]
    v_cvt_pk_bf16_f32 v64, v64, v65
    v_cvt_pk_bf16_f32 v65, v66, v67
    v_mfma_f32_16x16x32_bf16 v[84:87], a[156:159], a[116:119], v[84:87]
    ds_write_b64 v205, v[64:65] offset:4672
    v_pk_mul_f32 v[68:69], v[68:69], v[206:207] op_sel_hi:[1,0]
    v_pk_mul_f32 v[70:71], v[70:71], v[206:207] op_sel_hi:[1,0]
    v_mfma_f32_16x16x32_bf16 v[88:91], a[156:159], a[120:123], v[88:91]
    v_cvt_pk_bf16_f32 v68, v68, v69
    v_cvt_pk_bf16_f32 v69, v70, v71
    ds_write_b64 v205, v[68:69] offset:9280
    v_mfma_f32_16x16x32_bf16 v[92:95], a[156:159], a[124:127], v[92:95]
    s_nop 4
    v_pk_mul_f32 v[72:73], v[72:73], v[206:207] op_sel_hi:[1,0]
    v_pk_mul_f32 v[74:75], v[74:75], v[206:207] op_sel_hi:[1,0]
    v_cvt_pk_bf16_f32 v72, v72, v73
    v_cvt_pk_bf16_f32 v73, v74, v75
    ds_write_b64 v204, v[72:73] offset:96
    v_pk_mul_f32 v[76:77], v[76:77], v[206:207] op_sel_hi:[1,0]
    v_pk_mul_f32 v[78:79], v[78:79], v[206:207] op_sel_hi:[1,0]
    v_cvt_pk_bf16_f32 v76, v76, v77
    v_cvt_pk_bf16_f32 v77, v78, v79
    ds_write_b64 v204, v[76:77] offset:4704
    v_pk_mul_f32 v[80:81], v[80:81], v[206:207] op_sel_hi:[1,0]
    v_pk_mul_f32 v[82:83], v[82:83], v[206:207] op_sel_hi:[1,0]
    v_cvt_pk_bf16_f32 v80, v80, v81
    v_cvt_pk_bf16_f32 v81, v82, v83
    ds_write_b64 v204, v[80:81] offset:9312
    v_pk_mul_f32 v[84:85], v[84:85], v[206:207] op_sel_hi:[1,0]
    v_pk_mul_f32 v[86:87], v[86:87], v[206:207] op_sel_hi:[1,0]
    v_cvt_pk_bf16_f32 v84, v84, v85
    v_cvt_pk_bf16_f32 v85, v86, v87
    ds_write_b64 v205, v[84:85] offset:96
    v_pk_mul_f32 v[88:89], v[88:89], v[206:207] op_sel_hi:[1,0]
    v_pk_mul_f32 v[90:91], v[90:91], v[206:207] op_sel_hi:[1,0]
    v_cvt_pk_bf16_f32 v88, v88, v89
    v_cvt_pk_bf16_f32 v89, v90, v91
    ds_write_b64 v205, v[88:89] offset:4704
    v_pk_mul_f32 v[92:93], v[92:93], v[206:207] op_sel_hi:[1,0]
    v_pk_mul_f32 v[94:95], v[94:95], v[206:207] op_sel_hi:[1,0]
    v_cvt_pk_bf16_f32 v92, v92, v93
    v_cvt_pk_bf16_f32 v93, v94, v95
    ds_write_b64 v205, v[92:93] offset:9312
    s_waitcnt lgkmcnt(0)
    s_barrier
    ds_read_b128 a[96:99], v202 offset:0
    ds_read_b128 a[100:103], v202 offset:4608
    ds_read_b128 a[104:107], v202 offset:9216
    ds_read_b128 a[108:111], v203 offset:0
    ds_read_b128 a[112:115], v203 offset:4608
    ds_read_b128 a[116:119], v203 offset:9216
    ds_read_b128 a[120:123], v202 offset:64
    ds_read_b128 a[124:127], v202 offset:4672
    ds_read_b128 a[128:131], v202 offset:9280
    ds_read_b128 a[132:135], v203 offset:64
    ds_read_b128 a[136:139], v203 offset:4672
    ds_read_b128 a[140:143], v203 offset:9280
    ds_read_b128 a[144:147], v202 offset:128
    ds_read_b128 a[148:151], v202 offset:4736
    ds_read_b128 a[152:155], v202 offset:9344
    ds_read_b128 a[156:159], v203 offset:128
    ds_read_b128 a[160:163], v203 offset:4736
    ds_read_b128 a[164:167], v203 offset:9344
    ds_read_b128 a[168:171], v202 offset:192
    ds_read_b128 a[172:175], v202 offset:4800
    ds_read_b128 a[176:179], v202 offset:9408
    ds_read_b128 a[180:183], v203 offset:192
    ds_read_b128 a[184:187], v203 offset:4800
    ds_read_b128 a[188:191], v203 offset:9408
    s_lshr_b32 s3, s2, 3
    s_mul_i32 s37, s3, 163840
    s_mul_i32 s3, s32, 10240
    s_add_u32 s37, s37, s3
    s_bfe_u32 s3, s2, 0x10002
    s_mul_i32 s3, s3, 640
    s_add_u32 s37, s37, s3
    s_mov_b32 s39, 0
    s_movk_i32 s46, 128
    v_lshrrev_b32 v252, 3, v253
    v_mul_u32_u24 v252, 1280, v252
    v_and_b32 v202, 7, v253
    v_lshl_add_u32 v252, v202, 4, v252
    s_add_u32 s31, s40, 32768
    s_waitcnt vmcnt(0) lgkmcnt(0)
    s_barrier
    ds_read_b128 a[192:195], v209 offset:0
    ds_read_b128 a[196:199], v209 offset:64
    ds_read_b128 a[200:203], v209 offset:128
    ds_read_b128 a[204:207], v209 offset:192
    ds_read_b128 a[208:211], v209 offset:256
    ds_read_b128 a[212:215], v209 offset:320
    ds_read_b128 a[216:219], v209 offset:384
    ds_read_b128 a[220:223], v209 offset:448
    ds_read_b64_tr_b16 a[224:225], v210 offset:0
    ds_read_b64_tr_b16 a[226:227], v210 offset:256
    ds_read_b64_tr_b16 a[228:229], v210 offset:32
    ds_read_b64_tr_b16 a[230:231], v210 offset:288
    ds_read_b64_tr_b16 a[232:233], v210 offset:64
    ds_read_b64_tr_b16 a[234:235], v210 offset:320
    ds_read_b64_tr_b16 a[236:237], v210 offset:96
    ds_read_b64_tr_b16 a[238:239], v210 offset:352
    ds_read_b64_tr_b16 a[240:241], v211 offset:128
    ds_read_b64_tr_b16 a[242:243], v211 offset:384
    ds_read_b64_tr_b16 a[244:245], v211 offset:160
    ds_read_b64_tr_b16 a[246:247], v211 offset:416
    ds_read_b64_tr_b16 a[248:249], v211 offset:192
    ds_read_b64_tr_b16 a[250:251], v211 offset:448
    ds_read_b64_tr_b16 a[252:253], v211 offset:224
    ds_read_b64_tr_b16 a[254:255], v211 offset:480
    s_add_u32 m0, s41, 33792
    s_waitcnt lgkmcnt(15)
    v_mfma_f32_16x16x32_bf16 v[96:99], a[192:195], a[96:99], v[168:171]
    buffer_load_dwordx4 v212, s[16:19], s31 offen nt lds
    v_mfma_f32_16x16x32_bf16 v[96:99], a[196:199], a[120:123], v[96:99]
    v_mfma_f32_16x16x32_bf16 v[96:99], a[200:203], a[144:147], v[96:99]
    s_add_u32 m0, s41, 101376
    v_mfma_f32_16x16x32_bf16 v[96:99], a[204:207], a[168:171], v[96:99]
    buffer_load_dwordx4 v212, s[20:23], s31 offen nt lds
    v_mfma_f32_16x16x32_bf16 v[100:103], a[192:195], a[100:103], v[172:175]
    v_mfma_f32_16x16x32_bf16 v[100:103], a[196:199], a[124:127], v[100:103]
    s_add_u32 m0, s41, 34592
    v_mfma_f32_16x16x32_bf16 v[100:103], a[200:203], a[148:151], v[100:103]
    buffer_load_dwordx4 v212, s[16:19], s31 offen offset:256 nt lds
    v_mfma_f32_16x16x32_bf16 v[100:103], a[204:207], a[172:175], v[100:103]
    v_mfma_f32_16x16x32_bf16 v[104:107], a[192:195], a[104:107], v[176:179]
    v_max3_f32 v226, v96, v97, v98
    s_add_u32 m0, s41, 102176
    v_mfma_f32_16x16x32_bf16 v[104:107], a[196:199], a[128:131], v[104:107]
    buffer_load_dwordx4 v212, s[20:23], s31 offen offset:256 nt lds
    v_mfma_f32_16x16x32_bf16 v[104:107], a[200:203], a[152:155], v[104:107]
    v_mfma_f32_16x16x32_bf16 v[104:107], a[204:207], a[176:179], v[104:107]
    s_add_u32 m0, s41, 35392
    v_mfma_f32_16x16x32_bf16 v[108:111], a[208:211], a[96:99], v[168:171]
    buffer_load_dwordx4 v212, s[16:19], s31 offen offset:512 nt lds
    v_max3_f32 v227, v100, v101, v102
    v_mfma_f32_16x16x32_bf16 v[108:111], a[212:215], a[120:123], v[108:111]
    v_mfma_f32_16x16x32_bf16 v[108:111], a[216:219], a[144:147], v[108:111]
    s_add_u32 m0, s41, 102976
    v_mfma_f32_16x16x32_bf16 v[108:111], a[220:223], a[168:171], v[108:111]
    buffer_load_dwordx4 v212, s[20:23], s31 offen offset:512 nt lds
    v_max3_f32 v228, v104, v105, v106
    v_mfma_f32_16x16x32_bf16 v[112:115], a[208:211], a[100:103], v[172:175]
    v_mfma_f32_16x16x32_bf16 v[112:115], a[212:215], a[124:127], v[112:115]
    s_add_u32 m0, s41, 36192
    v_mfma_f32_16x16x32_bf16 v[112:115], a[216:219], a[148:151], v[112:115]
    buffer_load_dwordx4 v212, s[16:19], s31 offen offset:768 nt lds
    v_mfma_f32_16x16x32_bf16 v[112:115], a[220:223], a[172:175], v[112:115]
    v_max3_f32 v226, v226, v99, v108
    v_max3_f32 v226, v226, v109, v110
    v_max_f32 v226, v226, v111
    v_mfma_f32_16x16x32_bf16 v[116:119], a[208:211], a[104:107], v[176:179]
    s_add_u32 m0, s41, 103776
    v_mfma_f32_16x16x32_bf16 v[116:119], a[212:215], a[128:131], v[116:119]
    buffer_load_dwordx4 v212, s[20:23], s31 offen offset:768 nt lds
    v_mfma_f32_16x16x32_bf16 v[116:119], a[216:219], a[152:155], v[116:119]
    v_max3_f32 v227, v227, v103, v112
    v_max3_f32 v227, v227, v113, v114
    v_max_f32 v227, v227, v115
    v_mfma_f32_16x16x32_bf16 v[116:119], a[220:223], a[176:179], v[116:119]
    v_mfma_f32_16x16x32_bf16 v[120:123], a[192:195], a[108:111], v[180:183]
    v_mfma_f32_16x16x32_bf16 v[120:123], a[196:199], a[132:135], v[120:123]
    v_mfma_f32_16x16x32_bf16 v[120:123], a[200:203], a[156:159], v[120:123]
    v_mfma_f32_16x16x32_bf16 v[120:123], a[204:207], a[180:183], v[120:123]
    v_mfma_f32_16x16x32_bf16 v[124:127], a[192:195], a[112:115], v[184:187]
    v_mfma_f32_16x16x32_bf16 v[124:127], a[196:199], a[136:139], v[124:127]
    v_mfma_f32_16x16x32_bf16 v[124:127], a[200:203], a[160:163], v[124:127]
    v_mfma_f32_16x16x32_bf16 v[124:127], a[204:207], a[184:187], v[124:127]
    v_max3_f32 v228, v228, v107, v116
    v_max3_f32 v228, v228, v117, v118
    v_max_f32 v228, v228, v119
    v_mov_b32 v229, v226
    v_mfma_f32_16x16x32_bf16 v[128:131], a[192:195], a[116:119], v[188:191]
    v_mov_b32 v230, v227
    v_mov_b32 v231, v228
    s_nop 1
    v_permlane16_swap_b32 v226, v229
    v_mfma_f32_16x16x32_bf16 v[128:131], a[196:199], a[140:143], v[128:131]
    v_permlane16_swap_b32 v227, v230
    v_permlane16_swap_b32 v228, v231
    v_max_f32 v226, v226, v229
    v_max_f32 v227, v227, v230
    v_mfma_f32_16x16x32_bf16 v[128:131], a[200:203], a[164:167], v[128:131]
    v_max_f32 v228, v228, v231
    v_mov_b32 v229, v226
    v_mov_b32 v230, v227
    v_mov_b32 v231, v228
    v_mfma_f32_16x16x32_bf16 v[128:131], a[204:207], a[188:191], v[128:131]
    s_nop 1
    v_permlane32_swap_b32 v226, v229
    v_permlane32_swap_b32 v227, v230
    v_permlane32_swap_b32 v228, v231
    v_mfma_f32_16x16x32_bf16 v[132:135], a[208:211], a[108:111], v[180:183]
    v_max_f32 v226, v226, v229
    v_max_f32 v227, v227, v230
    v_max_f32 v228, v228, v231
    v_sub_f32 v96, v96, v226
    v_mfma_f32_16x16x32_bf16 v[132:135], a[212:215], a[132:135], v[132:135]
    v_sub_f32 v97, v97, v226
    v_sub_f32 v98, v98, v226
    v_sub_f32 v99, v99, v226
    v_sub_f32 v108, v108, v226
    v_mfma_f32_16x16x32_bf16 v[132:135], a[216:219], a[156:159], v[132:135]
    v_sub_f32 v109, v109, v226
    v_sub_f32 v110, v110, v226
    v_sub_f32 v111, v111, v226
    v_sub_f32 v168, 0, v226
    v_mfma_f32_16x16x32_bf16 v[132:135], a[220:223], a[180:183], v[132:135]
    v_sub_f32 v169, 0, v226
    v_sub_f32 v170, 0, v226
    v_sub_f32 v171, 0, v226
    v_sub_f32 v100, v100, v227
    v_mfma_f32_16x16x32_bf16 v[136:139], a[208:211], a[112:115], v[184:187]
    v_sub_f32 v101, v101, v227
    v_sub_f32 v102, v102, v227
    v_sub_f32 v103, v103, v227
    v_sub_f32 v112, v112, v227
    v_mfma_f32_16x16x32_bf16 v[136:139], a[212:215], a[136:139], v[136:139]
    v_sub_f32 v113, v113, v227
    v_sub_f32 v114, v114, v227
    v_sub_f32 v115, v115, v227
    v_sub_f32 v172, 0, v227
    v_mfma_f32_16x16x32_bf16 v[136:139], a[216:219], a[160:163], v[136:139]
    v_sub_f32 v173, 0, v227
    v_sub_f32 v174, 0, v227
    v_sub_f32 v175, 0, v227
    v_sub_f32 v104, v104, v228
    v_mfma_f32_16x16x32_bf16 v[136:139], a[220:223], a[184:187], v[136:139]
    v_sub_f32 v105, v105, v228
    v_sub_f32 v106, v106, v228
    v_sub_f32 v107, v107, v228
    v_sub_f32 v116, v116, v228
    v_mfma_f32_16x16x32_bf16 v[140:143], a[208:211], a[116:119], v[188:191]
    v_sub_f32 v117, v117, v228
    v_sub_f32 v118, v118, v228
    v_sub_f32 v119, v119, v228
    v_sub_f32 v176, 0, v228
    v_mfma_f32_16x16x32_bf16 v[140:143], a[212:215], a[140:143], v[140:143]
    v_sub_f32 v177, 0, v228
    v_sub_f32 v178, 0, v228
    v_sub_f32 v179, 0, v228
    v_mfma_f32_16x16x32_bf16 v[140:143], a[216:219], a[164:167], v[140:143]
    v_exp_f32 v202, v96
    v_exp_f32 v203, v97
    v_mfma_f32_16x16x32_bf16 v[140:143], a[220:223], a[188:191], v[140:143]
    v_exp_f32 v204, v98
    v_exp_f32 v205, v99
    v_add_f32 v198, v202, v203
    v_cvt_pk_bf16_f32 v144, v202, v203
    v_exp_f32 v206, v100
    v_exp_f32 v207, v101
    v_add_f32 v198, v198, v204
    v_add_f32 v198, v198, v205
    v_cvt_pk_bf16_f32 v145, v204, v205
    v_exp_f32 v202, v102
    v_exp_f32 v203, v103
    v_add_f32 v199, v206, v207
    v_cvt_pk_bf16_f32 v148, v206, v207
    v_exp_f32 v204, v104
    v_exp_f32 v205, v105
    v_add_f32 v199, v199, v202
    v_add_f32 v199, v199, v203
    v_cvt_pk_bf16_f32 v149, v202, v203
    v_exp_f32 v206, v106
    v_exp_f32 v207, v107
    v_add_f32 v200, v204, v205
    v_cvt_pk_bf16_f32 v152, v204, v205
    v_exp_f32 v202, v108
    v_exp_f32 v203, v109
    v_add_f32 v200, v200, v206
    v_add_f32 v200, v200, v207
    v_cvt_pk_bf16_f32 v153, v206, v207
    v_exp_f32 v204, v110
    v_exp_f32 v205, v111
    v_add_f32 v198, v198, v202
    v_add_f32 v198, v198, v203
    v_cvt_pk_bf16_f32 v146, v202, v203
    v_exp_f32 v206, v112
    v_exp_f32 v207, v113
    v_add_f32 v198, v198, v204
    v_add_f32 v198, v198, v205
    v_cvt_pk_bf16_f32 v147, v204, v205
    v_exp_f32 v202, v114
    v_exp_f32 v203, v115
    v_add_f32 v199, v199, v206
    v_add_f32 v199, v199, v207
    v_cvt_pk_bf16_f32 v150, v206, v207
    v_exp_f32 v204, v116
    v_exp_f32 v205, v117
    v_add_f32 v199, v199, v202
    v_add_f32 v199, v199, v203
    v_cvt_pk_bf16_f32 v151, v202, v203
    v_exp_f32 v206, v118
    v_exp_f32 v207, v119
    v_add_f32 v200, v200, v204
    v_add_f32 v200, v200, v205
    v_cvt_pk_bf16_f32 v154, v204, v205
    v_add_f32 v201, v198, v199
    v_add_f32 v200, v200, v206
    v_add_f32 v200, v200, v207
    v_add_f32 v201, v201, v200
    v_cmp_lt_f32 vcc, s36, v201
    v_cvt_pk_bf16_f32 v155, v206, v207
    v_max3_f32 v226, v120, v121, v122
    v_max3_f32 v227, v124, v125, v126
    v_max3_f32 v228, v128, v129, v130
    v_max3_f32 v226, v226, v123, v132
    v_max3_f32 v226, v226, v133, v134
    v_max_f32 v226, v226, v135
    v_max3_f32 v227, v227, v127, v136
    v_max3_f32 v227, v227, v137, v138
    v_max_f32 v227, v227, v139
    v_max3_f32 v228, v228, v131, v140
    v_max3_f32 v228, v228, v141, v142
    v_max_f32 v228, v228, v143
    v_mov_b32 v229, v226
    v_mov_b32 v230, v227
    v_mov_b32 v231, v228
    s_nop 1
    v_permlane16_swap_b32 v226, v229
    v_permlane16_swap_b32 v227, v230
    v_permlane16_swap_b32 v228, v231
    v_max_f32 v226, v226, v229
    v_max_f32 v227, v227, v230
    v_max_f32 v228, v228, v231
    v_mov_b32 v229, v226
    v_mov_b32 v230, v227
    v_mov_b32 v231, v228
    s_nop 1
    v_permlane32_swap_b32 v226, v229
    v_permlane32_swap_b32 v227, v230
    v_permlane32_swap_b32 v228, v231
    v_max_f32 v226, v226, v229
    v_max_f32 v227, v227, v230
    v_max_f32 v228, v228, v231
    v_sub_f32 v120, v120, v226
    v_sub_f32 v121, v121, v226
    v_sub_f32 v122, v122, v226
    v_sub_f32 v123, v123, v226
    v_sub_f32 v132, v132, v226
    v_sub_f32 v133, v133, v226
    v_sub_f32 v134, v134, v226
    v_sub_f32 v135, v135, v226
    v_sub_f32 v180, 0, v226
    v_sub_f32 v181, 0, v226
    v_sub_f32 v182, 0, v226
    v_sub_f32 v183, 0, v226
    v_sub_f32 v124, v124, v227
    v_sub_f32 v125, v125, v227
    v_sub_f32 v126, v126, v227
    v_sub_f32 v127, v127, v227
    v_sub_f32 v136, v136, v227
    v_sub_f32 v137, v137, v227
    v_sub_f32 v138, v138, v227
    v_sub_f32 v139, v139, v227
    v_sub_f32 v184, 0, v227
    v_sub_f32 v185, 0, v227
    v_sub_f32 v186, 0, v227
    v_sub_f32 v187, 0, v227
    v_sub_f32 v128, v128, v228
    v_sub_f32 v129, v129, v228
    v_sub_f32 v130, v130, v228
    v_sub_f32 v131, v131, v228
    v_sub_f32 v140, v140, v228
    v_sub_f32 v141, v141, v228
    v_sub_f32 v142, v142, v228
    v_sub_f32 v143, v143, v228
    v_sub_f32 v188, 0, v228
    v_sub_f32 v189, 0, v228
    v_sub_f32 v190, 0, v228
    v_sub_f32 v191, 0, v228
    v_exp_f32 v202, v120
    v_exp_f32 v203, v121
    v_exp_f32 v204, v122
    v_exp_f32 v205, v123
    v_add_f32 v222, v202, v203
    v_cvt_pk_bf16_f32 v156, v202, v203
    v_exp_f32 v206, v124
    v_exp_f32 v207, v125
    v_add_f32 v222, v222, v204
    v_add_f32 v222, v222, v205
    v_cvt_pk_bf16_f32 v157, v204, v205
    v_exp_f32 v202, v126
    s_cbranch_vccnz L_stub_1
    L_ret_2:
    s_add_u32 s31, s31, 16384
    s_waitcnt vmcnt(3) lgkmcnt(0)
    s_barrier
    s_add_u32 m0, s41, 50688
    v_mfma_f32_16x16x32_bf16 v[0:3], a[224:227], v[144:147], 0
    buffer_load_dwordx4 v212, s[16:19], s31 offen nt lds
    v_mfma_f32_16x16x32_bf16 v[4:7], a[224:227], v[148:151], 0
    v_add_f32 v192, v192, v198
    v_add_f32 v193, v193, v199
    v_mfma_f32_16x16x32_bf16 v[8:11], a[224:227], v[152:155], 0
    ds_read_b128 a[192:195], v209 offset:16896
    v_add_f32 v194, v194, v200
    v_mfma_f32_16x16x32_bf16 v[24:27], a[228:231], v[144:147], 0
    v_exp_f32 v203, v127
    v_add_f32 v223, v206, v207
    v_mfma_f32_16x16x32_bf16 v[28:31], a[228:231], v[148:151], 0
    v_cvt_pk_bf16_f32 v160, v206, v207
    v_exp_f32 v204, v128
    v_mfma_f32_16x16x32_bf16 v[32:35], a[228:231], v[152:155], 0
    ds_read_b128 a[196:199], v209 offset:16960
    v_mfma_f32_16x16x32_bf16 v[48:51], a[232:235], v[144:147], 0
    v_exp_f32 v205, v129
    v_add_f32 v223, v223, v202
    v_mfma_f32_16x16x32_bf16 v[52:55], a[232:235], v[148:151], 0
    v_add_f32 v223, v223, v203
    v_cvt_pk_bf16_f32 v161, v202, v203
    v_mfma_f32_16x16x32_bf16 v[56:59], a[232:235], v[152:155], 0
    ds_read_b128 a[200:203], v209 offset:17024
    v_exp_f32 v206, v130
    s_add_u32 m0, s41, 118272
    v_mfma_f32_16x16x32_bf16 v[72:75], a[236:239], v[144:147], 0
    buffer_load_dwordx4 v212, s[20:23], s31 offen nt lds
    v_mfma_f32_16x16x32_bf16 v[76:79], a[236:239], v[148:151], 0
    v_exp_f32 v207, v131
    v_mfma_f32_16x16x32_bf16 v[80:83], a[236:239], v[152:155], 0
    ds_read_b128 a[204:207], v209 offset:17088
    v_add_f32 v224, v204, v205
    v_mfma_f32_16x16x32_bf16 a[0:3], a[240:243], v[144:147], 0
    v_cvt_pk_bf16_f32 v164, v204, v205
    v_exp_f32 v202, v132
    v_mfma_f32_16x16x32_bf16 a[4:7], a[240:243], v[148:151], 0
    v_exp_f32 v203, v133
    v_mfma_f32_16x16x32_bf16 a[8:11], a[240:243], v[152:155], 0
    ds_read_b128 a[208:211], v209 offset:17152
    v_add_f32 v224, v224, v206
    v_mfma_f32_16x16x32_bf16 a[24:27], a[244:247], v[144:147], 0
    v_add_f32 v224, v224, v207
    v_cvt_pk_bf16_f32 v165, v206, v207
    v_mfma_f32_16x16x32_bf16 a[28:31], a[244:247], v[148:151], 0
    v_exp_f32 v204, v134
    v_mfma_f32_16x16x32_bf16 a[32:35], a[244:247], v[152:155], 0
    ds_read_b128 a[212:215], v209 offset:17216
    v_exp_f32 v205, v135
    v_mfma_f32_16x16x32_bf16 a[48:51], a[248:251], v[144:147], 0
    v_add_f32 v222, v222, v202
    v_add_f32 v222, v222, v203
    v_cvt_pk_bf16_f32 v158, v202, v203
    v_mfma_f32_16x16x32_bf16 a[52:55], a[248:251], v[148:151], 0
    v_exp_f32 v206, v136
    v_mfma_f32_16x16x32_bf16 a[56:59], a[248:251], v[152:155], 0
    ds_read_b128 a[216:219], v209 offset:17280
    v_exp_f32 v207, v137
    s_add_u32 m0, s41, 51488
    v_mfma_f32_16x16x32_bf16 a[72:75], a[252:255], v[144:147], 0
    buffer_load_dwordx4 v212, s[16:19], s31 offen offset:256 nt lds
    v_mfma_f32_16x16x32_bf16 a[76:79], a[252:255], v[148:151], 0
    v_add_f32 v222, v222, v204
    v_add_f32 v222, v222, v205
    v_mfma_f32_16x16x32_bf16 a[80:83], a[252:255], v[152:155], 0
    ds_read_b128 a[220:223], v209 offset:17344
    v_cvt_pk_bf16_f32 v159, v204, v205
    s_waitcnt lgkmcnt(7)
    v_mfma_f32_16x16x32_bf16 v[96:99], a[192:195], a[96:99], v[168:171]
    v_exp_f32 v202, v138
    s_waitcnt lgkmcnt(6)
    v_mfma_f32_16x16x32_bf16 v[96:99], a[196:199], a[120:123], v[96:99]
    v_exp_f32 v203, v139
    s_waitcnt lgkmcnt(5)
    v_mfma_f32_16x16x32_bf16 v[96:99], a[200:203], a[144:147], v[96:99]
    v_add_f32 v223, v223, v206
    v_add_f32 v223, v223, v207
    s_waitcnt lgkmcnt(4)
    v_mfma_f32_16x16x32_bf16 v[96:99], a[204:207], a[168:171], v[96:99]
    v_cvt_pk_bf16_f32 v162, v206, v207
    v_mfma_f32_16x16x32_bf16 v[100:103], a[192:195], a[100:103], v[172:175]
    v_exp_f32 v204, v140
    v_mfma_f32_16x16x32_bf16 v[100:103], a[196:199], a[124:127], v[100:103]
    v_exp_f32 v205, v141
    v_mfma_f32_16x16x32_bf16 v[100:103], a[200:203], a[148:151], v[100:103]
    v_add_f32 v223, v223, v202
    v_add_f32 v223, v223, v203
    v_mfma_f32_16x16x32_bf16 v[100:103], a[204:207], a[172:175], v[100:103]
    v_cvt_pk_bf16_f32 v163, v202, v203
    v_exp_f32 v206, v142
    v_mfma_f32_16x16x32_bf16 v[104:107], a[192:195], a[104:107], v[176:179]
    v_exp_f32 v207, v143
    s_add_u32 m0, s41, 119072
    v_mfma_f32_16x16x32_bf16 v[104:107], a[196:199], a[128:131], v[104:107]
    buffer_load_dwordx4 v212, s[20:23], s31 offen offset:256 nt lds
    v_mfma_f32_16x16x32_bf16 v[104:107], a[200:203], a[152:155], v[104:107]
    v_add_f32 v224, v224, v204
    v_add_f32 v224, v224, v205
    v_mfma_f32_16x16x32_bf16 v[104:107], a[204:207], a[176:179], v[104:107]
    v_cvt_pk_bf16_f32 v166, v204, v205
    v_add_f32 v208, v222, v223
    s_waitcnt lgkmcnt(3)
    v_mfma_f32_16x16x32_bf16 v[108:111], a[208:211], a[96:99], v[168:171]
    v_add_f32 v224, v224, v206
    v_add_f32 v224, v224, v207
    s_waitcnt lgkmcnt(2)
    v_mfma_f32_16x16x32_bf16 v[108:111], a[212:215], a[120:123], v[108:111]
    v_add_f32 v208, v208, v224
    v_cmp_lt_f32 vcc, s36, v208
    s_waitcnt lgkmcnt(1)
    v_mfma_f32_16x16x32_bf16 v[108:111], a[216:219], a[144:147], v[108:111]
    v_cvt_pk_bf16_f32 v167, v206, v207
    s_waitcnt lgkmcnt(0)
    v_mfma_f32_16x16x32_bf16 v[108:111], a[220:223], a[168:171], v[108:111]
    v_exp_f32 v202, v96
    v_mfma_f32_16x16x32_bf16 v[112:115], a[208:211], a[100:103], v[172:175]
    v_exp_f32 v203, v97
    v_mfma_f32_16x16x32_bf16 v[112:115], a[212:215], a[124:127], v[112:115]
    v_exp_f32 v204, v98
    v_mfma_f32_16x16x32_bf16 v[112:115], a[216:219], a[148:151], v[112:115]
    v_exp_f32 v205, v99
    v_mfma_f32_16x16x32_bf16 v[112:115], a[220:223], a[172:175], v[112:115]
    v_add_f32 v198, v202, v203
    v_cvt_pk_bf16_f32 v144, v202, v203
    v_mfma_f32_16x16x32_bf16 v[116:119], a[208:211], a[104:107], v[176:179]
    v_exp_f32 v206, v100
    s_add_u32 m0, s41, 52288
    v_mfma_f32_16x16x32_bf16 v[116:119], a[212:215], a[128:131], v[116:119]
    buffer_load_dwordx4 v212, s[16:19], s31 offen offset:512 nt lds
    v_mfma_f32_16x16x32_bf16 v[116:119], a[216:219], a[152:155], v[116:119]
    v_exp_f32 v207, v101
    v_mfma_f32_16x16x32_bf16 v[116:119], a[220:223], a[176:179], v[116:119]
    v_add_f32 v198, v198, v204
    v_add_f32 v198, v198, v205
    s_cbranch_vccnz L_stub_3
    L_ret_4:
    v_mfma_f32_16x16x32_bf16 v[12:15], a[224:227], v[156:159], 0
    v_add_f32 v195, v195, v222
    v_add_f32 v196, v196, v223
    v_mfma_f32_16x16x32_bf16 v[16:19], a[224:227], v[160:163], 0
    v_add_f32 v197, v197, v224
    v_cvt_pk_bf16_f32 v145, v204, v205
    v_mfma_f32_16x16x32_bf16 v[20:23], a[224:227], v[164:167], 0
    ds_read_b64_tr_b16 a[224:225], v210 offset:16896
    ds_read_b64_tr_b16 a[226:227], v210 offset:17152
    v_mfma_f32_16x16x32_bf16 v[36:39], a[228:231], v[156:159], 0
    v_exp_f32 v202, v102
    v_mfma_f32_16x16x32_bf16 v[40:43], a[228:231], v[160:163], 0
    v_exp_f32 v203, v103
    v_add_f32 v199, v206, v207
    v_mfma_f32_16x16x32_bf16 v[44:47], a[228:231], v[164:167], 0
    ds_read_b64_tr_b16 a[228:229], v210 offset:16928
    ds_read_b64_tr_b16 a[230:231], v210 offset:17184
    v_cvt_pk_bf16_f32 v148, v206, v207
    v_mfma_f32_16x16x32_bf16 v[60:63], a[232:235], v[156:159], 0
    v_exp_f32 v204, v104
    v_mfma_f32_16x16x32_bf16 v[64:67], a[232:235], v[160:163], 0
    v_exp_f32 v205, v105
    v_mfma_f32_16x16x32_bf16 v[68:71], a[232:235], v[164:167], 0
    ds_read_b64_tr_b16 a[232:233], v210 offset:16960
    ds_read_b64_tr_b16 a[234:235], v210 offset:17216
    v_add_f32 v199, v199, v202
    s_add_u32 m0, s41, 119872
    v_mfma_f32_16x16x32_bf16 v[84:87], a[236:239], v[156:159], 0
    buffer_load_dwordx4 v212, s[20:23], s31 offen offset:512 nt lds
    v_mfma_f32_16x16x32_bf16 v[88:91], a[236:239], v[160:163], 0
    v_add_f32 v199, v199, v203
    v_cvt_pk_bf16_f32 v149, v202, v203
    v_mfma_f32_16x16x32_bf16 v[92:95], a[236:239], v[164:167], 0
    ds_read_b64_tr_b16 a[236:237], v210 offset:16992
    ds_read_b64_tr_b16 a[238:239], v210 offset:17248
    v_mfma_f32_16x16x32_bf16 a[12:15], a[240:243], v[156:159], 0
    v_exp_f32 v206, v106
    v_mfma_f32_16x16x32_bf16 a[16:19], a[240:243], v[160:163], 0
    v_exp_f32 v207, v107
    v_add_f32 v200, v204, v205
    v_mfma_f32_16x16x32_bf16 a[20:23], a[240:243], v[164:167], 0
    ds_read_b64_tr_b16 a[240:241], v211 offset:17024
    ds_read_b64_tr_b16 a[242:243], v211 offset:17280
    v_mfma_f32_16x16x32_bf16 a[36:39], a[244:247], v[156:159], 0
    v_cvt_pk_bf16_f32 v152, v204, v205
    v_exp_f32 v202, v108
    v_mfma_f32_16x16x32_bf16 a[40:43], a[244:247], v[160:163], 0
    v_exp_f32 v203, v109
    v_mfma_f32_16x16x32_bf16 a[44:47], a[244:247], v[164:167], 0
    ds_read_b64_tr_b16 a[244:245], v211 offset:17056
    ds_read_b64_tr_b16 a[246:247], v211 offset:17312
    v_mfma_f32_16x16x32_bf16 a[60:63], a[248:251], v[156:159], 0
    v_add_f32 v200, v200, v206
    v_add_f32 v200, v200, v207
    v_cvt_pk_bf16_f32 v153, v206, v207
    v_mfma_f32_16x16x32_bf16 a[64:67], a[248:251], v[160:163], 0
    v_exp_f32 v204, v110
    v_mfma_f32_16x16x32_bf16 a[68:71], a[248:251], v[164:167], 0
    ds_read_b64_tr_b16 a[248:249], v211 offset:17088
    ds_read_b64_tr_b16 a[250:251], v211 offset:17344
    v_mfma_f32_16x16x32_bf16 a[84:87], a[252:255], v[156:159], 0
    v_exp_f32 v205, v111
    v_add_f32 v198, v198, v202
    v_mfma_f32_16x16x32_bf16 a[88:91], a[252:255], v[160:163], 0
    v_add_f32 v198, v198, v203
    v_cvt_pk_bf16_f32 v146, v202, v203
    v_mfma_f32_16x16x32_bf16 a[92:95], a[252:255], v[164:167], 0
    ds_read_b64_tr_b16 a[252:253], v211 offset:17120
    ds_read_b64_tr_b16 a[254:255], v211 offset:17376
    s_add_u32 m0, s41, 53088
    v_mfma_f32_16x16x32_bf16 v[120:123], a[192:195], a[108:111], v[180:183]
    buffer_load_dwordx4 v212, s[16:19], s31 offen offset:768 nt lds
    v_mfma_f32_16x16x32_bf16 v[120:123], a[196:199], a[132:135], v[120:123]
    v_exp_f32 v206, v112
    v_mfma_f32_16x16x32_bf16 v[120:123], a[200:203], a[156:159], v[120:123]
    v_exp_f32 v207, v113
    v_add_f32 v198, v198, v204
    v_mfma_f32_16x16x32_bf16 v[120:123], a[204:207], a[180:183], v[120:123]
    v_add_f32 v198, v198, v205
    v_cvt_pk_bf16_f32 v147, v204, v205
    v_mfma_f32_16x16x32_bf16 v[124:127], a[192:195], a[112:115], v[184:187]
    v_exp_f32 v202, v114
    v_mfma_f32_16x16x32_bf16 v[124:127], a[196:199], a[136:139], v[124:127]
    v_exp_f32 v203, v115
    v_add_f32 v199, v199, v206
    v_mfma_f32_16x16x32_bf16 v[124:127], a[200:203], a[160:163], v[124:127]
    v_add_f32 v199, v199, v207
    v_cvt_pk_bf16_f32 v150, v206, v207
    v_mfma_f32_16x16x32_bf16 v[124:127], a[204:207], a[184:187], v[124:127]
    v_exp_f32 v204, v116
    v_mfma_f32_16x16x32_bf16 v[128:131], a[192:195], a[116:119], v[188:191]
    v_exp_f32 v205, v117
    v_add_f32 v199, v199, v202
    v_mfma_f32_16x16x32_bf16 v[128:131], a[196:199], a[140:143], v[128:131]
    v_add_f32 v199, v199, v203
    v_cvt_pk_bf16_f32 v151, v202, v203
    v_mfma_f32_16x16x32_bf16 v[128:131], a[200:203], a[164:167], v[128:131]
    v_exp_f32 v206, v118
    v_mfma_f32_16x16x32_bf16 v[128:131], a[204:207], a[188:191], v[128:131]
    v_exp_f32 v207, v119
    v_add_f32 v200, v200, v204
    v_add_f32 v200, v200, v205
    s_add_u32 m0, s41, 120672
    v_mfma_f32_16x16x32_bf16 v[132:135], a[208:211], a[108:111], v[180:183]
    buffer_load_dwordx4 v212, s[20:23], s31 offen offset:768 nt lds
    v_mfma_f32_16x16x32_bf16 v[132:135], a[212:215], a[132:135], v[132:135]
    v_cvt_pk_bf16_f32 v154, v204, v205
    v_add_f32 v201, v198, v199
    v_mfma_f32_16x16x32_bf16 v[132:135], a[216:219], a[156:159], v[132:135]
    v_add_f32 v200, v200, v206
    v_add_f32 v200, v200, v207
    v_mfma_f32_16x16x32_bf16 v[132:135], a[220:223], a[180:183], v[132:135]
    v_add_f32 v201, v201, v200
    v_cmp_lt_f32 vcc, s36, v201
    v_mfma_f32_16x16x32_bf16 v[136:139], a[208:211], a[112:115], v[184:187]
    v_cvt_pk_bf16_f32 v155, v206, v207
    v_exp_f32 v202, v120
    v_mfma_f32_16x16x32_bf16 v[136:139], a[212:215], a[136:139], v[136:139]
    v_exp_f32 v203, v121
    s_mov_b32 m0, 162816
    v_mfma_f32_16x16x32_bf16 v[136:139], a[216:219], a[160:163], v[136:139]
    buffer_load_dwordx4 v252, s[92:95], s37 offen lds
    s_add_u32 s39, s39, 1
    s_cmp_eq_u32 s39, 5
    s_cselect_b32 s3, 40448, s46
    s_cselect_b32 s39, 0, s39
    s_add_u32 s37, s37, s3
    v_mfma_f32_16x16x32_bf16 v[136:139], a[220:223], a[184:187], v[136:139]
    v_exp_f32 v204, v122
    v_mfma_f32_16x16x32_bf16 v[140:143], a[208:211], a[116:119], v[188:191]
    v_exp_f32 v205, v123
    v_mfma_f32_16x16x32_bf16 v[140:143], a[212:215], a[140:143], v[140:143]
    v_add_f32 v222, v202, v203
    v_cvt_pk_bf16_f32 v156, v202, v203
    v_mfma_f32_16x16x32_bf16 v[140:143], a[216:219], a[164:167], v[140:143]
    v_exp_f32 v206, v124
    v_mfma_f32_16x16x32_bf16 v[140:143], a[220:223], a[188:191], v[140:143]
    v_exp_f32 v207, v125
    v_add_f32 v222, v222, v204
    v_add_f32 v222, v222, v205
    v_cvt_pk_bf16_f32 v157, v204, v205
    v_exp_f32 v202, v126
    s_mov_b32 s47, 0
L1_loop:
    s_cbranch_vccnz L_stub_5
    L_ret_6:
    s_add_u32 s31, s31, 16384
    s_waitcnt vmcnt(3) lgkmcnt(0)
    s_barrier
    s_add_u32 m0, s41, 0
    v_mfma_f32_16x16x32_bf16 v[0:3], a[224:227], v[144:147], v[0:3]
    buffer_load_dwordx4 v212, s[16:19], s31 offen nt lds
    v_mfma_f32_16x16x32_bf16 v[4:7], a[224:227], v[148:151], v[4:7]
    v_add_f32 v192, v192, v198
    v_add_f32 v193, v193, v199
    v_mfma_f32_16x16x32_bf16 v[8:11], a[224:227], v[152:155], v[8:11]
    ds_read_b128 a[192:195], v209 offset:33792
    v_add_f32 v194, v194, v200
    v_mfma_f32_16x16x32_bf16 v[24:27], a[228:231], v[144:147], v[24:27]
    v_exp_f32 v203, v127
    v_add_f32 v223, v206, v207
    v_mfma_f32_16x16x32_bf16 v[28:31], a[228:231], v[148:151], v[28:31]
    v_cvt_pk_bf16_f32 v160, v206, v207
    v_exp_f32 v204, v128
    v_mfma_f32_16x16x32_bf16 v[32:35], a[228:231], v[152:155], v[32:35]
    ds_read_b128 a[196:199], v209 offset:33856
    v_mfma_f32_16x16x32_bf16 v[48:51], a[232:235], v[144:147], v[48:51]
    v_exp_f32 v205, v129
    v_add_f32 v223, v223, v202
    v_mfma_f32_16x16x32_bf16 v[52:55], a[232:235], v[148:151], v[52:55]
    v_add_f32 v223, v223, v203
    v_cvt_pk_bf16_f32 v161, v202, v203
    v_mfma_f32_16x16x32_bf16 v[56:59], a[232:235], v[152:155], v[56:59]
    ds_read_b128 a[200:203], v209 offset:33920
    v_exp_f32 v206, v130
    s_add_u32 m0, s41, 67584
    v_mfma_f32_16x16x32_bf16 v[72:75], a[236:239], v[144:147], v[72:75]
    buffer_load_dwordx4 v212, s[20:23], s31 offen nt lds
    v_mfma_f32_16x16x32_bf16 v[76:79], a[236:239], v[148:151], v[76:79]
    v_exp_f32 v207, v131
    v_mfma_f32_16x16x32_bf16 v[80:83], a[236:239], v[152:155], v[80:83]
    ds_read_b128 a[204:207], v209 offset:33984
    v_add_f32 v224, v204, v205
    v_mfma_f32_16x16x32_bf16 a[0:3], a[240:243], v[144:147], a[0:3]
    v_cvt_pk_bf16_f32 v164, v204, v205
    v_exp_f32 v202, v132
    v_mfma_f32_16x16x32_bf16 a[4:7], a[240:243], v[148:151], a[4:7]
    v_exp_f32 v203, v133
    v_mfma_f32_16x16x32_bf16 a[8:11], a[240:243], v[152:155], a[8:11]
    ds_read_b128 a[208:211], v209 offset:34048
    v_add_f32 v224, v224, v206
    v_mfma_f32_16x16x32_bf16 a[24:27], a[244:247], v[144:147], a[24:27]
    v_add_f32 v224, v224, v207
    v_cvt_pk_bf16_f32 v165, v206, v207
    v_mfma_f32_16x16x32_bf16 a[28:31], a[244:247], v[148:151], a[28:31]
    v_exp_f32 v204, v134
    v_mfma_f32_16x16x32_bf16 a[32:35], a[244:247], v[152:155], a[32:35]
    ds_read_b128 a[212:215], v209 offset:34112
    v_exp_f32 v205, v135
    v_mfma_f32_16x16x32_bf16 a[48:51], a[248:251], v[144:147], a[48:51]
    v_add_f32 v222, v222, v202
    v_add_f32 v222, v222, v203
    v_cvt_pk_bf16_f32 v158, v202, v203
    v_mfma_f32_16x16x32_bf16 a[52:55], a[248:251], v[148:151], a[52:55]
    v_exp_f32 v206, v136
    v_mfma_f32_16x16x32_bf16 a[56:59], a[248:251], v[152:155], a[56:59]
    ds_read_b128 a[216:219], v209 offset:34176
    v_exp_f32 v207, v137
    s_add_u32 m0, s41, 800
    v_mfma_f32_16x16x32_bf16 a[72:75], a[252:255], v[144:147], a[72:75]
    buffer_load_dwordx4 v212, s[16:19], s31 offen offset:256 nt lds
    v_mfma_f32_16x16x32_bf16 a[76:79], a[252:255], v[148:151], a[76:79]
    v_add_f32 v222, v222, v204
    v_add_f32 v222, v222, v205
    v_mfma_f32_16x16x32_bf16 a[80:83], a[252:255], v[152:155], a[80:83]
    ds_read_b128 a[220:223], v209 offset:34240
    v_cvt_pk_bf16_f32 v159, v204, v205
    s_waitcnt lgkmcnt(7)
    v_mfma_f32_16x16x32_bf16 v[96:99], a[192:195], a[96:99], v[168:171]
    v_exp_f32 v202, v138
    s_waitcnt lgkmcnt(6)
    v_mfma_f32_16x16x32_bf16 v[96:99], a[196:199], a[120:123], v[96:99]
    v_exp_f32 v203, v139
    s_waitcnt lgkmcnt(5)
    v_mfma_f32_16x16x32_bf16 v[96:99], a[200:203], a[144:147], v[96:99]
    v_add_f32 v223, v223, v206
    v_add_f32 v223, v223, v207
    s_waitcnt lgkmcnt(4)
    v_mfma_f32_16x16x32_bf16 v[96:99], a[204:207], a[168:171], v[96:99]
    v_cvt_pk_bf16_f32 v162, v206, v207
    v_mfma_f32_16x16x32_bf16 v[100:103], a[192:195], a[100:103], v[172:175]
    v_exp_f32 v204, v140
    v_mfma_f32_16x16x32_bf16 v[100:103], a[196:199], a[124:127], v[100:103]
    v_exp_f32 v205, v141
    v_mfma_f32_16x16x32_bf16 v[100:103], a[200:203], a[148:151], v[100:103]
    v_add_f32 v223, v223, v202
    v_add_f32 v223, v223, v203
    v_mfma_f32_16x16x32_bf16 v[100:103], a[204:207], a[172:175], v[100:103]
    v_cvt_pk_bf16_f32 v163, v202, v203
    v_exp_f32 v206, v142
    v_mfma_f32_16x16x32_bf16 v[104:107], a[192:195], a[104:107], v[176:179]
    v_exp_f32 v207, v143
    s_add_u32 m0, s41, 68384
    v_mfma_f32_16x16x32_bf16 v[104:107], a[196:199], a[128:131], v[104:107]
    buffer_load_dwordx4 v212, s[20:23], s31 offen offset:256 nt lds
    v_mfma_f32_16x16x32_bf16 v[104:107], a[200:203], a[152:155], v[104:107]
    v_add_f32 v224, v224, v204
    v_add_f32 v224, v224, v205
    v_mfma_f32_16x16x32_bf16 v[104:107], a[204:207], a[176:179], v[104:107]
    v_cvt_pk_bf16_f32 v166, v204, v205
    v_add_f32 v208, v222, v223
    s_waitcnt lgkmcnt(3)
    v_mfma_f32_16x16x32_bf16 v[108:111], a[208:211], a[96:99], v[168:171]
    v_add_f32 v224, v224, v206
    v_add_f32 v224, v224, v207
    s_waitcnt lgkmcnt(2)
    v_mfma_f32_16x16x32_bf16 v[108:111], a[212:215], a[120:123], v[108:111]
    v_add_f32 v208, v208, v224
    v_cmp_lt_f32 vcc, s36, v208
    s_waitcnt lgkmcnt(1)
    v_mfma_f32_16x16x32_bf16 v[108:111], a[216:219], a[144:147], v[108:111]
    v_cvt_pk_bf16_f32 v167, v206, v207
    s_waitcnt lgkmcnt(0)
    v_mfma_f32_16x16x32_bf16 v[108:111], a[220:223], a[168:171], v[108:111]
    v_exp_f32 v202, v96
    v_mfma_f32_16x16x32_bf16 v[112:115], a[208:211], a[100:103], v[172:175]
    v_exp_f32 v203, v97
    v_mfma_f32_16x16x32_bf16 v[112:115], a[212:215], a[124:127], v[112:115]
    v_exp_f32 v204, v98
    v_mfma_f32_16x16x32_bf16 v[112:115], a[216:219], a[148:151], v[112:115]
    v_exp_f32 v205, v99
    v_mfma_f32_16x16x32_bf16 v[112:115], a[220:223], a[172:175], v[112:115]
    v_add_f32 v198, v202, v203
    v_cvt_pk_bf16_f32 v144, v202, v203
    v_mfma_f32_16x16x32_bf16 v[116:119], a[208:211], a[104:107], v[176:179]
    v_exp_f32 v206, v100
    s_add_u32 m0, s41, 1600
    v_mfma_f32_16x16x32_bf16 v[116:119], a[212:215], a[128:131], v[116:119]
    buffer_load_dwordx4 v212, s[16:19], s31 offen offset:512 nt lds
    v_mfma_f32_16x16x32_bf16 v[116:119], a[216:219], a[152:155], v[116:119]
    v_exp_f32 v207, v101
    v_mfma_f32_16x16x32_bf16 v[116:119], a[220:223], a[176:179], v[116:119]
    v_add_f32 v198, v198, v204
    v_add_f32 v198, v198, v205
    s_cbranch_vccnz L_stub_7
    L_ret_8:
    v_mfma_f32_16x16x32_bf16 v[12:15], a[224:227], v[156:159], v[12:15]
    v_add_f32 v195, v195, v222
    v_add_f32 v196, v196, v223
    v_mfma_f32_16x16x32_bf16 v[16:19], a[224:227], v[160:163], v[16:19]
    v_add_f32 v197, v197, v224
    v_cvt_pk_bf16_f32 v145, v204, v205
    v_mfma_f32_16x16x32_bf16 v[20:23], a[224:227], v[164:167], v[20:23]
    ds_read_b64_tr_b16 a[224:225], v210 offset:33792
    ds_read_b64_tr_b16 a[226:227], v210 offset:34048
    v_mfma_f32_16x16x32_bf16 v[36:39], a[228:231], v[156:159], v[36:39]
    v_exp_f32 v202, v102
    v_mfma_f32_16x16x32_bf16 v[40:43], a[228:231], v[160:163], v[40:43]
    v_exp_f32 v203, v103
    v_add_f32 v199, v206, v207
    v_mfma_f32_16x16x32_bf16 v[44:47], a[228:231], v[164:167], v[44:47]
    ds_read_b64_tr_b16 a[228:229], v210 offset:33824
    ds_read_b64_tr_b16 a[230:231], v210 offset:34080
    v_cvt_pk_bf16_f32 v148, v206, v207
    v_mfma_f32_16x16x32_bf16 v[60:63], a[232:235], v[156:159], v[60:63]
    v_exp_f32 v204, v104
    v_mfma_f32_16x16x32_bf16 v[64:67], a[232:235], v[160:163], v[64:67]
    v_exp_f32 v205, v105
    v_mfma_f32_16x16x32_bf16 v[68:71], a[232:235], v[164:167], v[68:71]
    ds_read_b64_tr_b16 a[232:233], v210 offset:33856
    ds_read_b64_tr_b16 a[234:235], v210 offset:34112
    v_add_f32 v199, v199, v202
    s_add_u32 m0, s41, 69184
    v_mfma_f32_16x16x32_bf16 v[84:87], a[236:239], v[156:159], v[84:87]
    buffer_load_dwordx4 v212, s[20:23], s31 offen offset:512 nt lds
    v_mfma_f32_16x16x32_bf16 v[88:91], a[236:239], v[160:163], v[88:91]
    v_add_f32 v199, v199, v203
    v_cvt_pk_bf16_f32 v149, v202, v203
    v_mfma_f32_16x16x32_bf16 v[92:95], a[236:239], v[164:167], v[92:95]
    ds_read_b64_tr_b16 a[236:237], v210 offset:33888
    ds_read_b64_tr_b16 a[238:239], v210 offset:34144
    v_mfma_f32_16x16x32_bf16 a[12:15], a[240:243], v[156:159], a[12:15]
    v_exp_f32 v206, v106
    v_mfma_f32_16x16x32_bf16 a[16:19], a[240:243], v[160:163], a[16:19]
    v_exp_f32 v207, v107
    v_add_f32 v200, v204, v205
    v_mfma_f32_16x16x32_bf16 a[20:23], a[240:243], v[164:167], a[20:23]
    ds_read_b64_tr_b16 a[240:241], v211 offset:33920
    ds_read_b64_tr_b16 a[242:243], v211 offset:34176
    v_mfma_f32_16x16x32_bf16 a[36:39], a[244:247], v[156:159], a[36:39]
    v_cvt_pk_bf16_f32 v152, v204, v205
    v_exp_f32 v202, v108
    v_mfma_f32_16x16x32_bf16 a[40:43], a[244:247], v[160:163], a[40:43]
    v_exp_f32 v203, v109
    v_mfma_f32_16x16x32_bf16 a[44:47], a[244:247], v[164:167], a[44:47]
    ds_read_b64_tr_b16 a[244:245], v211 offset:33952
    ds_read_b64_tr_b16 a[246:247], v211 offset:34208
    v_mfma_f32_16x16x32_bf16 a[60:63], a[248:251], v[156:159], a[60:63]
    v_add_f32 v200, v200, v206
    v_add_f32 v200, v200, v207
    v_cvt_pk_bf16_f32 v153, v206, v207
    v_mfma_f32_16x16x32_bf16 a[64:67], a[248:251], v[160:163], a[64:67]
    v_exp_f32 v204, v110
    v_mfma_f32_16x16x32_bf16 a[68:71], a[248:251], v[164:167], a[68:71]
    ds_read_b64_tr_b16 a[248:249], v211 offset:33984
    ds_read_b64_tr_b16 a[250:251], v211 offset:34240
    v_mfma_f32_16x16x32_bf16 a[84:87], a[252:255], v[156:159], a[84:87]
    v_exp_f32 v205, v111
    v_add_f32 v198, v198, v202
    v_mfma_f32_16x16x32_bf16 a[88:91], a[252:255], v[160:163], a[88:91]
    v_add_f32 v198, v198, v203
    v_cvt_pk_bf16_f32 v146, v202, v203
    v_mfma_f32_16x16x32_bf16 a[92:95], a[252:255], v[164:167], a[92:95]
    ds_read_b64_tr_b16 a[252:253], v211 offset:34016
    ds_read_b64_tr_b16 a[254:255], v211 offset:34272
    s_add_u32 m0, s41, 2400
    v_mfma_f32_16x16x32_bf16 v[120:123], a[192:195], a[108:111], v[180:183]
    buffer_load_dwordx4 v212, s[16:19], s31 offen offset:768 nt lds
    v_mfma_f32_16x16x32_bf16 v[120:123], a[196:199], a[132:135], v[120:123]
    v_exp_f32 v206, v112
    v_mfma_f32_16x16x32_bf16 v[120:123], a[200:203], a[156:159], v[120:123]
    v_exp_f32 v207, v113
    v_add_f32 v198, v198, v204
    v_mfma_f32_16x16x32_bf16 v[120:123], a[204:207], a[180:183], v[120:123]
    v_add_f32 v198, v198, v205
    v_cvt_pk_bf16_f32 v147, v204, v205
    v_mfma_f32_16x16x32_bf16 v[124:127], a[192:195], a[112:115], v[184:187]
    v_exp_f32 v202, v114
    v_mfma_f32_16x16x32_bf16 v[124:127], a[196:199], a[136:139], v[124:127]
    v_exp_f32 v203, v115
    v_add_f32 v199, v199, v206
    v_mfma_f32_16x16x32_bf16 v[124:127], a[200:203], a[160:163], v[124:127]
    v_add_f32 v199, v199, v207
    v_cvt_pk_bf16_f32 v150, v206, v207
    v_mfma_f32_16x16x32_bf16 v[124:127], a[204:207], a[184:187], v[124:127]
    v_exp_f32 v204, v116
    v_mfma_f32_16x16x32_bf16 v[128:131], a[192:195], a[116:119], v[188:191]
    v_exp_f32 v205, v117
    v_add_f32 v199, v199, v202
    v_mfma_f32_16x16x32_bf16 v[128:131], a[196:199], a[140:143], v[128:131]
    v_add_f32 v199, v199, v203
    v_cvt_pk_bf16_f32 v151, v202, v203
    v_mfma_f32_16x16x32_bf16 v[128:131], a[200:203], a[164:167], v[128:131]
    v_exp_f32 v206, v118
    v_mfma_f32_16x16x32_bf16 v[128:131], a[204:207], a[188:191], v[128:131]
    v_exp_f32 v207, v119
    v_add_f32 v200, v200, v204
    v_add_f32 v200, v200, v205
    s_add_u32 m0, s41, 69984
    v_mfma_f32_16x16x32_bf16 v[132:135], a[208:211], a[108:111], v[180:183]
    buffer_load_dwordx4 v212, s[20:23], s31 offen offset:768 nt lds
    v_mfma_f32_16x16x32_bf16 v[132:135], a[212:215], a[132:135], v[132:135]
    v_cvt_pk_bf16_f32 v154, v204, v205
    v_add_f32 v201, v198, v199
    v_mfma_f32_16x16x32_bf16 v[132:135], a[216:219], a[156:159], v[132:135]
    v_add_f32 v200, v200, v206
    v_add_f32 v200, v200, v207
    v_mfma_f32_16x16x32_bf16 v[132:135], a[220:223], a[180:183], v[132:135]
    v_add_f32 v201, v201, v200
    v_cmp_lt_f32 vcc, s36, v201
    v_mfma_f32_16x16x32_bf16 v[136:139], a[208:211], a[112:115], v[184:187]
    v_cvt_pk_bf16_f32 v155, v206, v207
    v_exp_f32 v202, v120
    v_mfma_f32_16x16x32_bf16 v[136:139], a[212:215], a[136:139], v[136:139]
    v_exp_f32 v203, v121
    s_mov_b32 m0, 162816
    v_mfma_f32_16x16x32_bf16 v[136:139], a[216:219], a[160:163], v[136:139]
    buffer_load_dwordx4 v252, s[92:95], s37 offen lds
    s_add_u32 s39, s39, 1
    s_cmp_eq_u32 s39, 5
    s_cselect_b32 s3, 40448, s46
    s_cselect_b32 s39, 0, s39
    s_add_u32 s37, s37, s3
    v_mfma_f32_16x16x32_bf16 v[136:139], a[220:223], a[184:187], v[136:139]
    v_exp_f32 v204, v122
    v_mfma_f32_16x16x32_bf16 v[140:143], a[208:211], a[116:119], v[188:191]
    v_exp_f32 v205, v123
    v_mfma_f32_16x16x32_bf16 v[140:143], a[212:215], a[140:143], v[140:143]
    v_add_f32 v222, v202, v203
    v_cvt_pk_bf16_f32 v156, v202, v203
    v_mfma_f32_16x16x32_bf16 v[140:143], a[216:219], a[164:167], v[140:143]
    v_exp_f32 v206, v124
    v_mfma_f32_16x16x32_bf16 v[140:143], a[220:223], a[188:191], v[140:143]
    v_exp_f32 v207, v125
    v_add_f32 v222, v222, v204
    v_add_f32 v222, v222, v205
    v_cvt_pk_bf16_f32 v157, v204, v205
    v_exp_f32 v202, v126
    s_cbranch_vccnz L_stub_9
    L_ret_10:
    s_add_u32 s31, s31, 16384
    s_waitcnt vmcnt(3) lgkmcnt(0)
    s_barrier
    s_add_u32 m0, s41, 16896
    v_mfma_f32_16x16x32_bf16 v[0:3], a[224:227], v[144:147], v[0:3]
    buffer_load_dwordx4 v212, s[16:19], s31 offen nt lds
    v_mfma_f32_16x16x32_bf16 v[4:7], a[224:227], v[148:151], v[4:7]
    v_add_f32 v192, v192, v198
    v_add_f32 v193, v193, v199
    v_mfma_f32_16x16x32_bf16 v[8:11], a[224:227], v[152:155], v[8:11]
    ds_read_b128 a[192:195], v209 offset:50688
    v_add_f32 v194, v194, v200
    v_mfma_f32_16x16x32_bf16 v[24:27], a[228:231], v[144:147], v[24:27]
    v_exp_f32 v203, v127
    v_add_f32 v223, v206, v207
    v_mfma_f32_16x16x32_bf16 v[28:31], a[228:231], v[148:151], v[28:31]
    v_cvt_pk_bf16_f32 v160, v206, v207
    v_exp_f32 v204, v128
    v_mfma_f32_16x16x32_bf16 v[32:35], a[228:231], v[152:155], v[32:35]
    ds_read_b128 a[196:199], v209 offset:50752
    v_mfma_f32_16x16x32_bf16 v[48:51], a[232:235], v[144:147], v[48:51]
    v_exp_f32 v205, v129
    v_add_f32 v223, v223, v202
    v_mfma_f32_16x16x32_bf16 v[52:55], a[232:235], v[148:151], v[52:55]
    v_add_f32 v223, v223, v203
    v_cvt_pk_bf16_f32 v161, v202, v203
    v_mfma_f32_16x16x32_bf16 v[56:59], a[232:235], v[152:155], v[56:59]
    ds_read_b128 a[200:203], v209 offset:50816
    v_exp_f32 v206, v130
    s_add_u32 m0, s41, 84480
    v_mfma_f32_16x16x32_bf16 v[72:75], a[236:239], v[144:147], v[72:75]
    buffer_load_dwordx4 v212, s[20:23], s31 offen nt lds
    v_mfma_f32_16x16x32_bf16 v[76:79], a[236:239], v[148:151], v[76:79]
    v_exp_f32 v207, v131
    v_mfma_f32_16x16x32_bf16 v[80:83], a[236:239], v[152:155], v[80:83]
    ds_read_b128 a[204:207], v209 offset:50880
    v_add_f32 v224, v204, v205
    v_mfma_f32_16x16x32_bf16 a[0:3], a[240:243], v[144:147], a[0:3]
    v_cvt_pk_bf16_f32 v164, v204, v205
    v_exp_f32 v202, v132
    v_mfma_f32_16x16x32_bf16 a[4:7], a[240:243], v[148:151], a[4:7]
    v_exp_f32 v203, v133
    v_mfma_f32_16x16x32_bf16 a[8:11], a[240:243], v[152:155], a[8:11]
    ds_read_b128 a[208:211], v209 offset:50944
    v_add_f32 v224, v224, v206
    v_mfma_f32_16x16x32_bf16 a[24:27], a[244:247], v[144:147], a[24:27]
    v_add_f32 v224, v224, v207
    v_cvt_pk_bf16_f32 v165, v206, v207
    v_mfma_f32_16x16x32_bf16 a[28:31], a[244:247], v[148:151], a[28:31]
    v_exp_f32 v204, v134
    v_mfma_f32_16x16x32_bf16 a[32:35], a[244:247], v[152:155], a[32:35]
    ds_read_b128 a[212:215], v209 offset:51008
    v_exp_f32 v205, v135
    v_mfma_f32_16x16x32_bf16 a[48:51], a[248:251], v[144:147], a[48:51]
    v_add_f32 v222, v222, v202
    v_add_f32 v222, v222, v203
    v_cvt_pk_bf16_f32 v158, v202, v203
    v_mfma_f32_16x16x32_bf16 a[52:55], a[248:251], v[148:151], a[52:55]
    v_exp_f32 v206, v136
    v_mfma_f32_16x16x32_bf16 a[56:59], a[248:251], v[152:155], a[56:59]
    ds_read_b128 a[216:219], v209 offset:51072
    v_exp_f32 v207, v137
    s_add_u32 m0, s41, 17696
    v_mfma_f32_16x16x32_bf16 a[72:75], a[252:255], v[144:147], a[72:75]
    buffer_load_dwordx4 v212, s[16:19], s31 offen offset:256 nt lds
    v_mfma_f32_16x16x32_bf16 a[76:79], a[252:255], v[148:151], a[76:79]
    v_add_f32 v222, v222, v204
    v_add_f32 v222, v222, v205
    v_mfma_f32_16x16x32_bf16 a[80:83], a[252:255], v[152:155], a[80:83]
    ds_read_b128 a[220:223], v209 offset:51136
    v_cvt_pk_bf16_f32 v159, v204, v205
    s_waitcnt lgkmcnt(7)
    v_mfma_f32_16x16x32_bf16 v[96:99], a[192:195], a[96:99], v[168:171]
    v_exp_f32 v202, v138
    s_waitcnt lgkmcnt(6)
    v_mfma_f32_16x16x32_bf16 v[96:99], a[196:199], a[120:123], v[96:99]
    v_exp_f32 v203, v139
    s_waitcnt lgkmcnt(5)
    v_mfma_f32_16x16x32_bf16 v[96:99], a[200:203], a[144:147], v[96:99]
    v_add_f32 v223, v223, v206
    v_add_f32 v223, v223, v207
    s_waitcnt lgkmcnt(4)
    v_mfma_f32_16x16x32_bf16 v[96:99], a[204:207], a[168:171], v[96:99]
    v_cvt_pk_bf16_f32 v162, v206, v207
    v_mfma_f32_16x16x32_bf16 v[100:103], a[192:195], a[100:103], v[172:175]
    v_exp_f32 v204, v140
    v_mfma_f32_16x16x32_bf16 v[100:103], a[196:199], a[124:127], v[100:103]
    v_exp_f32 v205, v141
    v_mfma_f32_16x16x32_bf16 v[100:103], a[200:203], a[148:151], v[100:103]
    v_add_f32 v223, v223, v202
    v_add_f32 v223, v223, v203
    v_mfma_f32_16x16x32_bf16 v[100:103], a[204:207], a[172:175], v[100:103]
    v_cvt_pk_bf16_f32 v163, v202, v203
    v_exp_f32 v206, v142
    v_mfma_f32_16x16x32_bf16 v[104:107], a[192:195], a[104:107], v[176:179]
    v_exp_f32 v207, v143
    s_add_u32 m0, s41, 85280
    v_mfma_f32_16x16x32_bf16 v[104:107], a[196:199], a[128:131], v[104:107]
    buffer_load_dwordx4 v212, s[20:23], s31 offen offset:256 nt lds
    v_mfma_f32_16x16x32_bf16 v[104:107], a[200:203], a[152:155], v[104:107]
    v_add_f32 v224, v224, v204
    v_add_f32 v224, v224, v205
    v_mfma_f32_16x16x32_bf16 v[104:107], a[204:207], a[176:179], v[104:107]
    v_cvt_pk_bf16_f32 v166, v204, v205
    v_add_f32 v208, v222, v223
    s_waitcnt lgkmcnt(3)
    v_mfma_f32_16x16x32_bf16 v[108:111], a[208:211], a[96:99], v[168:171]
    v_add_f32 v224, v224, v206
    v_add_f32 v224, v224, v207
    s_waitcnt lgkmcnt(2)
    v_mfma_f32_16x16x32_bf16 v[108:111], a[212:215], a[120:123], v[108:111]
    v_add_f32 v208, v208, v224
    v_cmp_lt_f32 vcc, s36, v208
    s_waitcnt lgkmcnt(1)
    v_mfma_f32_16x16x32_bf16 v[108:111], a[216:219], a[144:147], v[108:111]
    v_cvt_pk_bf16_f32 v167, v206, v207
    s_waitcnt lgkmcnt(0)
    v_mfma_f32_16x16x32_bf16 v[108:111], a[220:223], a[168:171], v[108:111]
    v_exp_f32 v202, v96
    v_mfma_f32_16x16x32_bf16 v[112:115], a[208:211], a[100:103], v[172:175]
    v_exp_f32 v203, v97
    v_mfma_f32_16x16x32_bf16 v[112:115], a[212:215], a[124:127], v[112:115]
    v_exp_f32 v204, v98
    v_mfma_f32_16x16x32_bf16 v[112:115], a[216:219], a[148:151], v[112:115]
    v_exp_f32 v205, v99
    v_mfma_f32_16x16x32_bf16 v[112:115], a[220:223], a[172:175], v[112:115]
    v_add_f32 v198, v202, v203
    v_cvt_pk_bf16_f32 v144, v202, v203
    v_mfma_f32_16x16x32_bf16 v[116:119], a[208:211], a[104:107], v[176:179]
    v_exp_f32 v206, v100
    s_add_u32 m0, s41, 18496
    v_mfma_f32_16x16x32_bf16 v[116:119], a[212:215], a[128:131], v[116:119]
    buffer_load_dwordx4 v212, s[16:19], s31 offen offset:512 nt lds
    v_mfma_f32_16x16x32_bf16 v[116:119], a[216:219], a[152:155], v[116:119]
    v_exp_f32 v207, v101
    v_mfma_f32_16x16x32_bf16 v[116:119], a[220:223], a[176:179], v[116:119]
    v_add_f32 v198, v198, v204
    v_add_f32 v198, v198, v205
    s_cbranch_vccnz L_stub_11
    L_ret_12:
    v_mfma_f32_16x16x32_bf16 v[12:15], a[224:227], v[156:159], v[12:15]
    v_add_f32 v195, v195, v222
    v_add_f32 v196, v196, v223
    v_mfma_f32_16x16x32_bf16 v[16:19], a[224:227], v[160:163], v[16:19]
    v_add_f32 v197, v197, v224
    v_cvt_pk_bf16_f32 v145, v204, v205
    v_mfma_f32_16x16x32_bf16 v[20:23], a[224:227], v[164:167], v[20:23]
    ds_read_b64_tr_b16 a[224:225], v210 offset:50688
    ds_read_b64_tr_b16 a[226:227], v210 offset:50944
    v_mfma_f32_16x16x32_bf16 v[36:39], a[228:231], v[156:159], v[36:39]
    v_exp_f32 v202, v102
    v_mfma_f32_16x16x32_bf16 v[40:43], a[228:231], v[160:163], v[40:43]
    v_exp_f32 v203, v103
    v_add_f32 v199, v206, v207
    v_mfma_f32_16x16x32_bf16 v[44:47], a[228:231], v[164:167], v[44:47]
    ds_read_b64_tr_b16 a[228:229], v210 offset:50720
    ds_read_b64_tr_b16 a[230:231], v210 offset:50976
    v_cvt_pk_bf16_f32 v148, v206, v207
    v_mfma_f32_16x16x32_bf16 v[60:63], a[232:235], v[156:159], v[60:63]
    v_exp_f32 v204, v104
    v_mfma_f32_16x16x32_bf16 v[64:67], a[232:235], v[160:163], v[64:67]
    v_exp_f32 v205, v105
    v_mfma_f32_16x16x32_bf16 v[68:71], a[232:235], v[164:167], v[68:71]
    ds_read_b64_tr_b16 a[232:233], v210 offset:50752
    ds_read_b64_tr_b16 a[234:235], v210 offset:51008
    v_add_f32 v199, v199, v202
    s_add_u32 m0, s41, 86080
    v_mfma_f32_16x16x32_bf16 v[84:87], a[236:239], v[156:159], v[84:87]
    buffer_load_dwordx4 v212, s[20:23], s31 offen offset:512 nt lds
    v_mfma_f32_16x16x32_bf16 v[88:91], a[236:239], v[160:163], v[88:91]
    v_add_f32 v199, v199, v203
    v_cvt_pk_bf16_f32 v149, v202, v203
    v_mfma_f32_16x16x32_bf16 v[92:95], a[236:239], v[164:167], v[92:95]
    ds_read_b64_tr_b16 a[236:237], v210 offset:50784
    ds_read_b64_tr_b16 a[238:239], v210 offset:51040
    v_mfma_f32_16x16x32_bf16 a[12:15], a[240:243], v[156:159], a[12:15]
    v_exp_f32 v206, v106
    v_mfma_f32_16x16x32_bf16 a[16:19], a[240:243], v[160:163], a[16:19]
    v_exp_f32 v207, v107
    v_add_f32 v200, v204, v205
    v_mfma_f32_16x16x32_bf16 a[20:23], a[240:243], v[164:167], a[20:23]
    ds_read_b64_tr_b16 a[240:241], v211 offset:50816
    ds_read_b64_tr_b16 a[242:243], v211 offset:51072
    v_mfma_f32_16x16x32_bf16 a[36:39], a[244:247], v[156:159], a[36:39]
    v_cvt_pk_bf16_f32 v152, v204, v205
    v_exp_f32 v202, v108
    v_mfma_f32_16x16x32_bf16 a[40:43], a[244:247], v[160:163], a[40:43]
    v_exp_f32 v203, v109
    v_mfma_f32_16x16x32_bf16 a[44:47], a[244:247], v[164:167], a[44:47]
    ds_read_b64_tr_b16 a[244:245], v211 offset:50848
    ds_read_b64_tr_b16 a[246:247], v211 offset:51104
    v_mfma_f32_16x16x32_bf16 a[60:63], a[248:251], v[156:159], a[60:63]
    v_add_f32 v200, v200, v206
    v_add_f32 v200, v200, v207
    v_cvt_pk_bf16_f32 v153, v206, v207
    v_mfma_f32_16x16x32_bf16 a[64:67], a[248:251], v[160:163], a[64:67]
    v_exp_f32 v204, v110
    v_mfma_f32_16x16x32_bf16 a[68:71], a[248:251], v[164:167], a[68:71]
    ds_read_b64_tr_b16 a[248:249], v211 offset:50880
    ds_read_b64_tr_b16 a[250:251], v211 offset:51136
    v_mfma_f32_16x16x32_bf16 a[84:87], a[252:255], v[156:159], a[84:87]
    v_exp_f32 v205, v111
    v_add_f32 v198, v198, v202
    v_mfma_f32_16x16x32_bf16 a[88:91], a[252:255], v[160:163], a[88:91]
    v_add_f32 v198, v198, v203
    v_cvt_pk_bf16_f32 v146, v202, v203
    v_mfma_f32_16x16x32_bf16 a[92:95], a[252:255], v[164:167], a[92:95]
    ds_read_b64_tr_b16 a[252:253], v211 offset:50912
    ds_read_b64_tr_b16 a[254:255], v211 offset:51168
    s_add_u32 m0, s41, 19296
    v_mfma_f32_16x16x32_bf16 v[120:123], a[192:195], a[108:111], v[180:183]
    buffer_load_dwordx4 v212, s[16:19], s31 offen offset:768 nt lds
    v_mfma_f32_16x16x32_bf16 v[120:123], a[196:199], a[132:135], v[120:123]
    v_exp_f32 v206, v112
    v_mfma_f32_16x16x32_bf16 v[120:123], a[200:203], a[156:159], v[120:123]
    v_exp_f32 v207, v113
    v_add_f32 v198, v198, v204
    v_mfma_f32_16x16x32_bf16 v[120:123], a[204:207], a[180:183], v[120:123]
    v_add_f32 v198, v198, v205
    v_cvt_pk_bf16_f32 v147, v204, v205
    v_mfma_f32_16x16x32_bf16 v[124:127], a[192:195], a[112:115], v[184:187]
    v_exp_f32 v202, v114
    v_mfma_f32_16x16x32_bf16 v[124:127], a[196:199], a[136:139], v[124:127]
    v_exp_f32 v203, v115
    v_add_f32 v199, v199, v206
    v_mfma_f32_16x16x32_bf16 v[124:127], a[200:203], a[160:163], v[124:127]
    v_add_f32 v199, v199, v207
    v_cvt_pk_bf16_f32 v150, v206, v207
    v_mfma_f32_16x16x32_bf16 v[124:127], a[204:207], a[184:187], v[124:127]
    v_exp_f32 v204, v116
    v_mfma_f32_16x16x32_bf16 v[128:131], a[192:195], a[116:119], v[188:191]
    v_exp_f32 v205, v117
    v_add_f32 v199, v199, v202
    v_mfma_f32_16x16x32_bf16 v[128:131], a[196:199], a[140:143], v[128:131]
    v_add_f32 v199, v199, v203
    v_cvt_pk_bf16_f32 v151, v202, v203
    v_mfma_f32_16x16x32_bf16 v[128:131], a[200:203], a[164:167], v[128:131]
    v_exp_f32 v206, v118
    v_mfma_f32_16x16x32_bf16 v[128:131], a[204:207], a[188:191], v[128:131]
    v_exp_f32 v207, v119
    v_add_f32 v200, v200, v204
    v_add_f32 v200, v200, v205
    s_add_u32 m0, s41, 86880
    v_mfma_f32_16x16x32_bf16 v[132:135], a[208:211], a[108:111], v[180:183]
    buffer_load_dwordx4 v212, s[20:23], s31 offen offset:768 nt lds
    v_mfma_f32_16x16x32_bf16 v[132:135], a[212:215], a[132:135], v[132:135]
    v_cvt_pk_bf16_f32 v154, v204, v205
    v_add_f32 v201, v198, v199
    v_mfma_f32_16x16x32_bf16 v[132:135], a[216:219], a[156:159], v[132:135]
    v_add_f32 v200, v200, v206
    v_add_f32 v200, v200, v207
    v_mfma_f32_16x16x32_bf16 v[132:135], a[220:223], a[180:183], v[132:135]
    v_add_f32 v201, v201, v200
    v_cmp_lt_f32 vcc, s36, v201
    v_mfma_f32_16x16x32_bf16 v[136:139], a[208:211], a[112:115], v[184:187]
    v_cvt_pk_bf16_f32 v155, v206, v207
    v_exp_f32 v202, v120
    v_mfma_f32_16x16x32_bf16 v[136:139], a[212:215], a[136:139], v[136:139]
    v_exp_f32 v203, v121
    s_mov_b32 m0, 162816
    v_mfma_f32_16x16x32_bf16 v[136:139], a[216:219], a[160:163], v[136:139]
    buffer_load_dwordx4 v252, s[92:95], s37 offen lds
    s_add_u32 s39, s39, 1
    s_cmp_eq_u32 s39, 5
    s_cselect_b32 s3, 40448, s46
    s_cselect_b32 s39, 0, s39
    s_add_u32 s37, s37, s3
    v_mfma_f32_16x16x32_bf16 v[136:139], a[220:223], a[184:187], v[136:139]
    v_exp_f32 v204, v122
    v_mfma_f32_16x16x32_bf16 v[140:143], a[208:211], a[116:119], v[188:191]
    v_exp_f32 v205, v123
    v_mfma_f32_16x16x32_bf16 v[140:143], a[212:215], a[140:143], v[140:143]
    v_add_f32 v222, v202, v203
    v_cvt_pk_bf16_f32 v156, v202, v203
    v_mfma_f32_16x16x32_bf16 v[140:143], a[216:219], a[164:167], v[140:143]
    v_exp_f32 v206, v124
    v_mfma_f32_16x16x32_bf16 v[140:143], a[220:223], a[188:191], v[140:143]
    v_exp_f32 v207, v125
    v_add_f32 v222, v222, v204
    v_add_f32 v222, v222, v205
    v_cvt_pk_bf16_f32 v157, v204, v205
    v_exp_f32 v202, v126
    s_cbranch_vccnz L_stub_13
    L_ret_14:
    s_add_u32 s31, s31, 16384
    s_waitcnt vmcnt(3) lgkmcnt(0)
    s_barrier
    s_add_u32 m0, s41, 33792
    v_mfma_f32_16x16x32_bf16 v[0:3], a[224:227], v[144:147], v[0:3]
    buffer_load_dwordx4 v212, s[16:19], s31 offen nt lds
    v_mfma_f32_16x16x32_bf16 v[4:7], a[224:227], v[148:151], v[4:7]
    v_add_f32 v192, v192, v198
    v_add_f32 v193, v193, v199
    v_mfma_f32_16x16x32_bf16 v[8:11], a[224:227], v[152:155], v[8:11]
    ds_read_b128 a[192:195], v209 offset:0
    v_add_f32 v194, v194, v200
    v_mfma_f32_16x16x32_bf16 v[24:27], a[228:231], v[144:147], v[24:27]
    v_exp_f32 v203, v127
    v_add_f32 v223, v206, v207
    v_mfma_f32_16x16x32_bf16 v[28:31], a[228:231], v[148:151], v[28:31]
    v_cvt_pk_bf16_f32 v160, v206, v207
    v_exp_f32 v204, v128
    v_mfma_f32_16x16x32_bf16 v[32:35], a[228:231], v[152:155], v[32:35]
    ds_read_b128 a[196:199], v209 offset:64
    v_mfma_f32_16x16x32_bf16 v[48:51], a[232:235], v[144:147], v[48:51]
    v_exp_f32 v205, v129
    v_add_f32 v223, v223, v202
    v_mfma_f32_16x16x32_bf16 v[52:55], a[232:235], v[148:151], v[52:55]
    v_add_f32 v223, v223, v203
    v_cvt_pk_bf16_f32 v161, v202, v203
    v_mfma_f32_16x16x32_bf16 v[56:59], a[232:235], v[152:155], v[56:59]
    ds_read_b128 a[200:203], v209 offset:128
    v_exp_f32 v206, v130
    s_add_u32 m0, s41, 101376
    v_mfma_f32_16x16x32_bf16 v[72:75], a[236:239], v[144:147], v[72:75]
    buffer_load_dwordx4 v212, s[20:23], s31 offen nt lds
    v_mfma_f32_16x16x32_bf16 v[76:79], a[236:239], v[148:151], v[76:79]
    v_exp_f32 v207, v131
    v_mfma_f32_16x16x32_bf16 v[80:83], a[236:239], v[152:155], v[80:83]
    ds_read_b128 a[204:207], v209 offset:192
    v_add_f32 v224, v204, v205
    v_mfma_f32_16x16x32_bf16 a[0:3], a[240:243], v[144:147], a[0:3]
    v_cvt_pk_bf16_f32 v164, v204, v205
    v_exp_f32 v202, v132
    v_mfma_f32_16x16x32_bf16 a[4:7], a[240:243], v[148:151], a[4:7]
    v_exp_f32 v203, v133
    v_mfma_f32_16x16x32_bf16 a[8:11], a[240:243], v[152:155], a[8:11]
    ds_read_b128 a[208:211], v209 offset:256
    v_add_f32 v224, v224, v206
    v_mfma_f32_16x16x32_bf16 a[24:27], a[244:247], v[144:147], a[24:27]
    v_add_f32 v224, v224, v207
    v_cvt_pk_bf16_f32 v165, v206, v207
    v_mfma_f32_16x16x32_bf16 a[28:31], a[244:247], v[148:151], a[28:31]
    v_exp_f32 v204, v134
    v_mfma_f32_16x16x32_bf16 a[32:35], a[244:247], v[152:155], a[32:35]
    ds_read_b128 a[212:215], v209 offset:320
    v_exp_f32 v205, v135
    v_mfma_f32_16x16x32_bf16 a[48:51], a[248:251], v[144:147], a[48:51]
    v_add_f32 v222, v222, v202
    v_add_f32 v222, v222, v203
    v_cvt_pk_bf16_f32 v158, v202, v203
    v_mfma_f32_16x16x32_bf16 a[52:55], a[248:251], v[148:151], a[52:55]
    v_exp_f32 v206, v136
    v_mfma_f32_16x16x32_bf16 a[56:59], a[248:251], v[152:155], a[56:59]
    ds_read_b128 a[216:219], v209 offset:384
    v_exp_f32 v207, v137
    s_add_u32 m0, s41, 34592
    v_mfma_f32_16x16x32_bf16 a[72:75], a[252:255], v[144:147], a[72:75]
    buffer_load_dwordx4 v212, s[16:19], s31 offen offset:256 nt lds
    v_mfma_f32_16x16x32_bf16 a[76:79], a[252:255], v[148:151], a[76:79]
    v_add_f32 v222, v222, v204
    v_add_f32 v222, v222, v205
    v_mfma_f32_16x16x32_bf16 a[80:83], a[252:255], v[152:155], a[80:83]
    ds_read_b128 a[220:223], v209 offset:448
    v_cvt_pk_bf16_f32 v159, v204, v205
    s_waitcnt lgkmcnt(7)
    v_mfma_f32_16x16x32_bf16 v[96:99], a[192:195], a[96:99], v[168:171]
    v_exp_f32 v202, v138
    s_waitcnt lgkmcnt(6)
    v_mfma_f32_16x16x32_bf16 v[96:99], a[196:199], a[120:123], v[96:99]
    v_exp_f32 v203, v139
    s_waitcnt lgkmcnt(5)
    v_mfma_f32_16x16x32_bf16 v[96:99], a[200:203], a[144:147], v[96:99]
    v_add_f32 v223, v223, v206
    v_add_f32 v223, v223, v207
    s_waitcnt lgkmcnt(4)
    v_mfma_f32_16x16x32_bf16 v[96:99], a[204:207], a[168:171], v[96:99]
    v_cvt_pk_bf16_f32 v162, v206, v207
    v_mfma_f32_16x16x32_bf16 v[100:103], a[192:195], a[100:103], v[172:175]
    v_exp_f32 v204, v140
    v_mfma_f32_16x16x32_bf16 v[100:103], a[196:199], a[124:127], v[100:103]
    v_exp_f32 v205, v141
    v_mfma_f32_16x16x32_bf16 v[100:103], a[200:203], a[148:151], v[100:103]
    v_add_f32 v223, v223, v202
    v_add_f32 v223, v223, v203
    v_mfma_f32_16x16x32_bf16 v[100:103], a[204:207], a[172:175], v[100:103]
    v_cvt_pk_bf16_f32 v163, v202, v203
    v_exp_f32 v206, v142
    v_mfma_f32_16x16x32_bf16 v[104:107], a[192:195], a[104:107], v[176:179]
    v_exp_f32 v207, v143
    s_add_u32 m0, s41, 102176
    v_mfma_f32_16x16x32_bf16 v[104:107], a[196:199], a[128:131], v[104:107]
    buffer_load_dwordx4 v212, s[20:23], s31 offen offset:256 nt lds
    v_mfma_f32_16x16x32_bf16 v[104:107], a[200:203], a[152:155], v[104:107]
    v_add_f32 v224, v224, v204
    v_add_f32 v224, v224, v205
    v_mfma_f32_16x16x32_bf16 v[104:107], a[204:207], a[176:179], v[104:107]
    v_cvt_pk_bf16_f32 v166, v204, v205
    v_add_f32 v208, v222, v223
    s_waitcnt lgkmcnt(3)
    v_mfma_f32_16x16x32_bf16 v[108:111], a[208:211], a[96:99], v[168:171]
    v_add_f32 v224, v224, v206
    v_add_f32 v224, v224, v207
    s_waitcnt lgkmcnt(2)
    v_mfma_f32_16x16x32_bf16 v[108:111], a[212:215], a[120:123], v[108:111]
    v_add_f32 v208, v208, v224
    v_cmp_lt_f32 vcc, s36, v208
    s_waitcnt lgkmcnt(1)
    v_mfma_f32_16x16x32_bf16 v[108:111], a[216:219], a[144:147], v[108:111]
    v_cvt_pk_bf16_f32 v167, v206, v207
    s_waitcnt lgkmcnt(0)
    v_mfma_f32_16x16x32_bf16 v[108:111], a[220:223], a[168:171], v[108:111]
    v_exp_f32 v202, v96
    v_mfma_f32_16x16x32_bf16 v[112:115], a[208:211], a[100:103], v[172:175]
    v_exp_f32 v203, v97
    v_mfma_f32_16x16x32_bf16 v[112:115], a[212:215], a[124:127], v[112:115]
    v_exp_f32 v204, v98
    v_mfma_f32_16x16x32_bf16 v[112:115], a[216:219], a[148:151], v[112:115]
    v_exp_f32 v205, v99
    v_mfma_f32_16x16x32_bf16 v[112:115], a[220:223], a[172:175], v[112:115]
    v_add_f32 v198, v202, v203
    v_cvt_pk_bf16_f32 v144, v202, v203
    v_mfma_f32_16x16x32_bf16 v[116:119], a[208:211], a[104:107], v[176:179]
    v_exp_f32 v206, v100
    s_add_u32 m0, s41, 35392
    v_mfma_f32_16x16x32_bf16 v[116:119], a[212:215], a[128:131], v[116:119]
    buffer_load_dwordx4 v212, s[16:19], s31 offen offset:512 nt lds
    v_mfma_f32_16x16x32_bf16 v[116:119], a[216:219], a[152:155], v[116:119]
    v_exp_f32 v207, v101
    v_mfma_f32_16x16x32_bf16 v[116:119], a[220:223], a[176:179], v[116:119]
    v_add_f32 v198, v198, v204
    v_add_f32 v198, v198, v205
    s_cbranch_vccnz L_stub_15
    L_ret_16:
    v_mfma_f32_16x16x32_bf16 v[12:15], a[224:227], v[156:159], v[12:15]
    v_add_f32 v195, v195, v222
    v_add_f32 v196, v196, v223
    v_mfma_f32_16x16x32_bf16 v[16:19], a[224:227], v[160:163], v[16:19]
    v_add_f32 v197, v197, v224
    v_cvt_pk_bf16_f32 v145, v204, v205
    v_mfma_f32_16x16x32_bf16 v[20:23], a[224:227], v[164:167], v[20:23]
    ds_read_b64_tr_b16 a[224:225], v210 offset:0
    ds_read_b64_tr_b16 a[226:227], v210 offset:256
    v_mfma_f32_16x16x32_bf16 v[36:39], a[228:231], v[156:159], v[36:39]
    v_exp_f32 v202, v102
    v_mfma_f32_16x16x32_bf16 v[40:43], a[228:231], v[160:163], v[40:43]
    v_exp_f32 v203, v103
    v_add_f32 v199, v206, v207
    v_mfma_f32_16x16x32_bf16 v[44:47], a[228:231], v[164:167], v[44:47]
    ds_read_b64_tr_b16 a[228:229], v210 offset:32
    ds_read_b64_tr_b16 a[230:231], v210 offset:288
    v_cvt_pk_bf16_f32 v148, v206, v207
    v_mfma_f32_16x16x32_bf16 v[60:63], a[232:235], v[156:159], v[60:63]
    v_exp_f32 v204, v104
    v_mfma_f32_16x16x32_bf16 v[64:67], a[232:235], v[160:163], v[64:67]
    v_exp_f32 v205, v105
    v_mfma_f32_16x16x32_bf16 v[68:71], a[232:235], v[164:167], v[68:71]
    ds_read_b64_tr_b16 a[232:233], v210 offset:64
    ds_read_b64_tr_b16 a[234:235], v210 offset:320
    v_add_f32 v199, v199, v202
    s_add_u32 m0, s41, 102976
    v_mfma_f32_16x16x32_bf16 v[84:87], a[236:239], v[156:159], v[84:87]
    buffer_load_dwordx4 v212, s[20:23], s31 offen offset:512 nt lds
    v_mfma_f32_16x16x32_bf16 v[88:91], a[236:239], v[160:163], v[88:91]
    v_add_f32 v199, v199, v203
    v_cvt_pk_bf16_f32 v149, v202, v203
    v_mfma_f32_16x16x32_bf16 v[92:95], a[236:239], v[164:167], v[92:95]
    ds_read_b64_tr_b16 a[236:237], v210 offset:96
    ds_read_b64_tr_b16 a[238:239], v210 offset:352
    v_mfma_f32_16x16x32_bf16 a[12:15], a[240:243], v[156:159], a[12:15]
    v_exp_f32 v206, v106
    v_mfma_f32_16x16x32_bf16 a[16:19], a[240:243], v[160:163], a[16:19]
    v_exp_f32 v207, v107
    v_add_f32 v200, v204, v205
    v_mfma_f32_16x16x32_bf16 a[20:23], a[240:243], v[164:167], a[20:23]
    ds_read_b64_tr_b16 a[240:241], v211 offset:128
    ds_read_b64_tr_b16 a[242:243], v211 offset:384
    v_mfma_f32_16x16x32_bf16 a[36:39], a[244:247], v[156:159], a[36:39]
    v_cvt_pk_bf16_f32 v152, v204, v205
    v_exp_f32 v202, v108
    v_mfma_f32_16x16x32_bf16 a[40:43], a[244:247], v[160:163], a[40:43]
    v_exp_f32 v203, v109
    v_mfma_f32_16x16x32_bf16 a[44:47], a[244:247], v[164:167], a[44:47]
    ds_read_b64_tr_b16 a[244:245], v211 offset:160
    ds_read_b64_tr_b16 a[246:247], v211 offset:416
    v_mfma_f32_16x16x32_bf16 a[60:63], a[248:251], v[156:159], a[60:63]
    v_add_f32 v200, v200, v206
    v_add_f32 v200, v200, v207
    v_cvt_pk_bf16_f32 v153, v206, v207
    v_mfma_f32_16x16x32_bf16 a[64:67], a[248:251], v[160:163], a[64:67]
    v_exp_f32 v204, v110
    v_mfma_f32_16x16x32_bf16 a[68:71], a[248:251], v[164:167], a[68:71]
    ds_read_b64_tr_b16 a[248:249], v211 offset:192
    ds_read_b64_tr_b16 a[250:251], v211 offset:448
    v_mfma_f32_16x16x32_bf16 a[84:87], a[252:255], v[156:159], a[84:87]
    v_exp_f32 v205, v111
    v_add_f32 v198, v198, v202
    v_mfma_f32_16x16x32_bf16 a[88:91], a[252:255], v[160:163], a[88:91]
    v_add_f32 v198, v198, v203
    v_cvt_pk_bf16_f32 v146, v202, v203
    v_mfma_f32_16x16x32_bf16 a[92:95], a[252:255], v[164:167], a[92:95]
    ds_read_b64_tr_b16 a[252:253], v211 offset:224
    ds_read_b64_tr_b16 a[254:255], v211 offset:480
    s_add_u32 m0, s41, 36192
    v_mfma_f32_16x16x32_bf16 v[120:123], a[192:195], a[108:111], v[180:183]
    buffer_load_dwordx4 v212, s[16:19], s31 offen offset:768 nt lds
    v_mfma_f32_16x16x32_bf16 v[120:123], a[196:199], a[132:135], v[120:123]
    v_exp_f32 v206, v112
    v_mfma_f32_16x16x32_bf16 v[120:123], a[200:203], a[156:159], v[120:123]
    v_exp_f32 v207, v113
    v_add_f32 v198, v198, v204
    v_mfma_f32_16x16x32_bf16 v[120:123], a[204:207], a[180:183], v[120:123]
    v_add_f32 v198, v198, v205
    v_cvt_pk_bf16_f32 v147, v204, v205
    v_mfma_f32_16x16x32_bf16 v[124:127], a[192:195], a[112:115], v[184:187]
    v_exp_f32 v202, v114
    v_mfma_f32_16x16x32_bf16 v[124:127], a[196:199], a[136:139], v[124:127]
    v_exp_f32 v203, v115
    v_add_f32 v199, v199, v206
    v_mfma_f32_16x16x32_bf16 v[124:127], a[200:203], a[160:163], v[124:127]
    v_add_f32 v199, v199, v207
    v_cvt_pk_bf16_f32 v150, v206, v207
    v_mfma_f32_16x16x32_bf16 v[124:127], a[204:207], a[184:187], v[124:127]
    v_exp_f32 v204, v116
    v_mfma_f32_16x16x32_bf16 v[128:131], a[192:195], a[116:119], v[188:191]
    v_exp_f32 v205, v117
    v_add_f32 v199, v199, v202
    v_mfma_f32_16x16x32_bf16 v[128:131], a[196:199], a[140:143], v[128:131]
    v_add_f32 v199, v199, v203
    v_cvt_pk_bf16_f32 v151, v202, v203
    v_mfma_f32_16x16x32_bf16 v[128:131], a[200:203], a[164:167], v[128:131]
    v_exp_f32 v206, v118
    v_mfma_f32_16x16x32_bf16 v[128:131], a[204:207], a[188:191], v[128:131]
    v_exp_f32 v207, v119
    v_add_f32 v200, v200, v204
    v_add_f32 v200, v200, v205
    s_add_u32 m0, s41, 103776
    v_mfma_f32_16x16x32_bf16 v[132:135], a[208:211], a[108:111], v[180:183]
    buffer_load_dwordx4 v212, s[20:23], s31 offen offset:768 nt lds
    v_mfma_f32_16x16x32_bf16 v[132:135], a[212:215], a[132:135], v[132:135]
    v_cvt_pk_bf16_f32 v154, v204, v205
    v_add_f32 v201, v198, v199
    v_mfma_f32_16x16x32_bf16 v[132:135], a[216:219], a[156:159], v[132:135]
    v_add_f32 v200, v200, v206
    v_add_f32 v200, v200, v207
    v_mfma_f32_16x16x32_bf16 v[132:135], a[220:223], a[180:183], v[132:135]
    v_add_f32 v201, v201, v200
    v_cmp_lt_f32 vcc, s36, v201
    v_mfma_f32_16x16x32_bf16 v[136:139], a[208:211], a[112:115], v[184:187]
    v_cvt_pk_bf16_f32 v155, v206, v207
    v_exp_f32 v202, v120
    v_mfma_f32_16x16x32_bf16 v[136:139], a[212:215], a[136:139], v[136:139]
    v_exp_f32 v203, v121
    s_mov_b32 m0, 162816
    v_mfma_f32_16x16x32_bf16 v[136:139], a[216:219], a[160:163], v[136:139]
    buffer_load_dwordx4 v252, s[92:95], s37 offen lds
    s_add_u32 s39, s39, 1
    s_cmp_eq_u32 s39, 5
    s_cselect_b32 s3, 40448, s46
    s_cselect_b32 s39, 0, s39
    s_add_u32 s37, s37, s3
    v_mfma_f32_16x16x32_bf16 v[136:139], a[220:223], a[184:187], v[136:139]
    v_exp_f32 v204, v122
    v_mfma_f32_16x16x32_bf16 v[140:143], a[208:211], a[116:119], v[188:191]
    v_exp_f32 v205, v123
    v_mfma_f32_16x16x32_bf16 v[140:143], a[212:215], a[140:143], v[140:143]
    v_add_f32 v222, v202, v203
    v_cvt_pk_bf16_f32 v156, v202, v203
    v_mfma_f32_16x16x32_bf16 v[140:143], a[216:219], a[164:167], v[140:143]
    v_exp_f32 v206, v124
    v_mfma_f32_16x16x32_bf16 v[140:143], a[220:223], a[188:191], v[140:143]
    v_exp_f32 v207, v125
    v_add_f32 v222, v222, v204
    v_add_f32 v222, v222, v205
    v_cvt_pk_bf16_f32 v157, v204, v205
    v_exp_f32 v202, v126
    s_cbranch_vccnz L_stub_17
    L_ret_18:
    s_add_u32 s31, s31, 16384
    s_waitcnt vmcnt(3) lgkmcnt(0)
    s_barrier
    s_add_u32 m0, s41, 50688
    v_mfma_f32_16x16x32_bf16 v[0:3], a[224:227], v[144:147], v[0:3]
    buffer_load_dwordx4 v212, s[16:19], s31 offen nt lds
    v_mfma_f32_16x16x32_bf16 v[4:7], a[224:227], v[148:151], v[4:7]
    v_add_f32 v192, v192, v198
    v_add_f32 v193, v193, v199
    v_mfma_f32_16x16x32_bf16 v[8:11], a[224:227], v[152:155], v[8:11]
    ds_read_b128 a[192:195], v209 offset:16896
    v_add_f32 v194, v194, v200
    v_mfma_f32_16x16x32_bf16 v[24:27], a[228:231], v[144:147], v[24:27]
    v_exp_f32 v203, v127
    v_add_f32 v223, v206, v207
    v_mfma_f32_16x16x32_bf16 v[28:31], a[228:231], v[148:151], v[28:31]
    v_cvt_pk_bf16_f32 v160, v206, v207
    v_exp_f32 v204, v128
    v_mfma_f32_16x16x32_bf16 v[32:35], a[228:231], v[152:155], v[32:35]
    ds_read_b128 a[196:199], v209 offset:16960
    v_mfma_f32_16x16x32_bf16 v[48:51], a[232:235], v[144:147], v[48:51]
    v_exp_f32 v205, v129
    v_add_f32 v223, v223, v202
    v_mfma_f32_16x16x32_bf16 v[52:55], a[232:235], v[148:151], v[52:55]
    v_add_f32 v223, v223, v203
    v_cvt_pk_bf16_f32 v161, v202, v203
    v_mfma_f32_16x16x32_bf16 v[56:59], a[232:235], v[152:155], v[56:59]
    ds_read_b128 a[200:203], v209 offset:17024
    v_exp_f32 v206, v130
    s_add_u32 m0, s41, 118272
    v_mfma_f32_16x16x32_bf16 v[72:75], a[236:239], v[144:147], v[72:75]
    buffer_load_dwordx4 v212, s[20:23], s31 offen nt lds
    v_mfma_f32_16x16x32_bf16 v[76:79], a[236:239], v[148:151], v[76:79]
    v_exp_f32 v207, v131
    v_mfma_f32_16x16x32_bf16 v[80:83], a[236:239], v[152:155], v[80:83]
    ds_read_b128 a[204:207], v209 offset:17088
    v_add_f32 v224, v204, v205
    v_mfma_f32_16x16x32_bf16 a[0:3], a[240:243], v[144:147], a[0:3]
    v_cvt_pk_bf16_f32 v164, v204, v205
    v_exp_f32 v202, v132
    v_mfma_f32_16x16x32_bf16 a[4:7], a[240:243], v[148:151], a[4:7]
    v_exp_f32 v203, v133
    v_mfma_f32_16x16x32_bf16 a[8:11], a[240:243], v[152:155], a[8:11]
    ds_read_b128 a[208:211], v209 offset:17152
    v_add_f32 v224, v224, v206
    v_mfma_f32_16x16x32_bf16 a[24:27], a[244:247], v[144:147], a[24:27]
    v_add_f32 v224, v224, v207
    v_cvt_pk_bf16_f32 v165, v206, v207
    v_mfma_f32_16x16x32_bf16 a[28:31], a[244:247], v[148:151], a[28:31]
    v_exp_f32 v204, v134
    v_mfma_f32_16x16x32_bf16 a[32:35], a[244:247], v[152:155], a[32:35]
    ds_read_b128 a[212:215], v209 offset:17216
    v_exp_f32 v205, v135
    v_mfma_f32_16x16x32_bf16 a[48:51], a[248:251], v[144:147], a[48:51]
    v_add_f32 v222, v222, v202
    v_add_f32 v222, v222, v203
    v_cvt_pk_bf16_f32 v158, v202, v203
    v_mfma_f32_16x16x32_bf16 a[52:55], a[248:251], v[148:151], a[52:55]
    v_exp_f32 v206, v136
    v_mfma_f32_16x16x32_bf16 a[56:59], a[248:251], v[152:155], a[56:59]
    ds_read_b128 a[216:219], v209 offset:17280
    v_exp_f32 v207, v137
    s_add_u32 m0, s41, 51488
    v_mfma_f32_16x16x32_bf16 a[72:75], a[252:255], v[144:147], a[72:75]
    buffer_load_dwordx4 v212, s[16:19], s31 offen offset:256 nt lds
    v_mfma_f32_16x16x32_bf16 a[76:79], a[252:255], v[148:151], a[76:79]
    v_add_f32 v222, v222, v204
    v_add_f32 v222, v222, v205
    v_mfma_f32_16x16x32_bf16 a[80:83], a[252:255], v[152:155], a[80:83]
    ds_read_b128 a[220:223], v209 offset:17344
    v_cvt_pk_bf16_f32 v159, v204, v205
    s_waitcnt lgkmcnt(7)
    v_mfma_f32_16x16x32_bf16 v[96:99], a[192:195], a[96:99], v[168:171]
    v_exp_f32 v202, v138
    s_waitcnt lgkmcnt(6)
    v_mfma_f32_16x16x32_bf16 v[96:99], a[196:199], a[120:123], v[96:99]
    v_exp_f32 v203, v139
    s_waitcnt lgkmcnt(5)
    v_mfma_f32_16x16x32_bf16 v[96:99], a[200:203], a[144:147], v[96:99]
    v_add_f32 v223, v223, v206
    v_add_f32 v223, v223, v207
    s_waitcnt lgkmcnt(4)
    v_mfma_f32_16x16x32_bf16 v[96:99], a[204:207], a[168:171], v[96:99]
    v_cvt_pk_bf16_f32 v162, v206, v207
    v_mfma_f32_16x16x32_bf16 v[100:103], a[192:195], a[100:103], v[172:175]
    v_exp_f32 v204, v140
    v_mfma_f32_16x16x32_bf16 v[100:103], a[196:199], a[124:127], v[100:103]
    v_exp_f32 v205, v141
    v_mfma_f32_16x16x32_bf16 v[100:103], a[200:203], a[148:151], v[100:103]
    v_add_f32 v223, v223, v202
    v_add_f32 v223, v223, v203
    v_mfma_f32_16x16x32_bf16 v[100:103], a[204:207], a[172:175], v[100:103]
    v_cvt_pk_bf16_f32 v163, v202, v203
    v_exp_f32 v206, v142
    v_mfma_f32_16x16x32_bf16 v[104:107], a[192:195], a[104:107], v[176:179]
    v_exp_f32 v207, v143
    s_add_u32 m0, s41, 119072
    v_mfma_f32_16x16x32_bf16 v[104:107], a[196:199], a[128:131], v[104:107]
    buffer_load_dwordx4 v212, s[20:23], s31 offen offset:256 nt lds
    v_mfma_f32_16x16x32_bf16 v[104:107], a[200:203], a[152:155], v[104:107]
    v_add_f32 v224, v224, v204
    v_add_f32 v224, v224, v205
    v_mfma_f32_16x16x32_bf16 v[104:107], a[204:207], a[176:179], v[104:107]
    v_cvt_pk_bf16_f32 v166, v204, v205
    v_add_f32 v208, v222, v223
    s_waitcnt lgkmcnt(3)
    v_mfma_f32_16x16x32_bf16 v[108:111], a[208:211], a[96:99], v[168:171]
    v_add_f32 v224, v224, v206
    v_add_f32 v224, v224, v207
    s_waitcnt lgkmcnt(2)
    v_mfma_f32_16x16x32_bf16 v[108:111], a[212:215], a[120:123], v[108:111]
    v_add_f32 v208, v208, v224
    v_cmp_lt_f32 vcc, s36, v208
    s_waitcnt lgkmcnt(1)
    v_mfma_f32_16x16x32_bf16 v[108:111], a[216:219], a[144:147], v[108:111]
    v_cvt_pk_bf16_f32 v167, v206, v207
    s_waitcnt lgkmcnt(0)
    v_mfma_f32_16x16x32_bf16 v[108:111], a[220:223], a[168:171], v[108:111]
    v_exp_f32 v202, v96
    v_mfma_f32_16x16x32_bf16 v[112:115], a[208:211], a[100:103], v[172:175]
    v_exp_f32 v203, v97
    v_mfma_f32_16x16x32_bf16 v[112:115], a[212:215], a[124:127], v[112:115]
    v_exp_f32 v204, v98
    v_mfma_f32_16x16x32_bf16 v[112:115], a[216:219], a[148:151], v[112:115]
    v_exp_f32 v205, v99
    v_mfma_f32_16x16x32_bf16 v[112:115], a[220:223], a[172:175], v[112:115]
    v_add_f32 v198, v202, v203
    v_cvt_pk_bf16_f32 v144, v202, v203
    v_mfma_f32_16x16x32_bf16 v[116:119], a[208:211], a[104:107], v[176:179]
    v_exp_f32 v206, v100
    s_add_u32 m0, s41, 52288
    v_mfma_f32_16x16x32_bf16 v[116:119], a[212:215], a[128:131], v[116:119]
    buffer_load_dwordx4 v212, s[16:19], s31 offen offset:512 nt lds
    v_mfma_f32_16x16x32_bf16 v[116:119], a[216:219], a[152:155], v[116:119]
    v_exp_f32 v207, v101
    v_mfma_f32_16x16x32_bf16 v[116:119], a[220:223], a[176:179], v[116:119]
    v_add_f32 v198, v198, v204
    v_add_f32 v198, v198, v205
    s_cbranch_vccnz L_stub_19
    L_ret_20:
    v_mfma_f32_16x16x32_bf16 v[12:15], a[224:227], v[156:159], v[12:15]
    v_add_f32 v195, v195, v222
    v_add_f32 v196, v196, v223
    v_mfma_f32_16x16x32_bf16 v[16:19], a[224:227], v[160:163], v[16:19]
    v_add_f32 v197, v197, v224
    v_cvt_pk_bf16_f32 v145, v204, v205
    v_mfma_f32_16x16x32_bf16 v[20:23], a[224:227], v[164:167], v[20:23]
    ds_read_b64_tr_b16 a[224:225], v210 offset:16896
    ds_read_b64_tr_b16 a[226:227], v210 offset:17152
    v_mfma_f32_16x16x32_bf16 v[36:39], a[228:231], v[156:159], v[36:39]
    v_exp_f32 v202, v102
    v_mfma_f32_16x16x32_bf16 v[40:43], a[228:231], v[160:163], v[40:43]
    v_exp_f32 v203, v103
    v_add_f32 v199, v206, v207
    v_mfma_f32_16x16x32_bf16 v[44:47], a[228:231], v[164:167], v[44:47]
    ds_read_b64_tr_b16 a[228:229], v210 offset:16928
    ds_read_b64_tr_b16 a[230:231], v210 offset:17184
    v_cvt_pk_bf16_f32 v148, v206, v207
    v_mfma_f32_16x16x32_bf16 v[60:63], a[232:235], v[156:159], v[60:63]
    v_exp_f32 v204, v104
    v_mfma_f32_16x16x32_bf16 v[64:67], a[232:235], v[160:163], v[64:67]
    v_exp_f32 v205, v105
    v_mfma_f32_16x16x32_bf16 v[68:71], a[232:235], v[164:167], v[68:71]
    ds_read_b64_tr_b16 a[232:233], v210 offset:16960
    ds_read_b64_tr_b16 a[234:235], v210 offset:17216
    v_add_f32 v199, v199, v202
    s_add_u32 m0, s41, 119872
    v_mfma_f32_16x16x32_bf16 v[84:87], a[236:239], v[156:159], v[84:87]
    buffer_load_dwordx4 v212, s[20:23], s31 offen offset:512 nt lds
    v_mfma_f32_16x16x32_bf16 v[88:91], a[236:239], v[160:163], v[88:91]
    v_add_f32 v199, v199, v203
    v_cvt_pk_bf16_f32 v149, v202, v203
    v_mfma_f32_16x16x32_bf16 v[92:95], a[236:239], v[164:167], v[92:95]
    ds_read_b64_tr_b16 a[236:237], v210 offset:16992
    ds_read_b64_tr_b16 a[238:239], v210 offset:17248
    v_mfma_f32_16x16x32_bf16 a[12:15], a[240:243], v[156:159], a[12:15]
    v_exp_f32 v206, v106
    v_mfma_f32_16x16x32_bf16 a[16:19], a[240:243], v[160:163], a[16:19]
    v_exp_f32 v207, v107
    v_add_f32 v200, v204, v205
    v_mfma_f32_16x16x32_bf16 a[20:23], a[240:243], v[164:167], a[20:23]
    ds_read_b64_tr_b16 a[240:241], v211 offset:17024
    ds_read_b64_tr_b16 a[242:243], v211 offset:17280
    v_mfma_f32_16x16x32_bf16 a[36:39], a[244:247], v[156:159], a[36:39]
    v_cvt_pk_bf16_f32 v152, v204, v205
    v_exp_f32 v202, v108
    v_mfma_f32_16x16x32_bf16 a[40:43], a[244:247], v[160:163], a[40:43]
    v_exp_f32 v203, v109
    v_mfma_f32_16x16x32_bf16 a[44:47], a[244:247], v[164:167], a[44:47]
    ds_read_b64_tr_b16 a[244:245], v211 offset:17056
    ds_read_b64_tr_b16 a[246:247], v211 offset:17312
    v_mfma_f32_16x16x32_bf16 a[60:63], a[248:251], v[156:159], a[60:63]
    v_add_f32 v200, v200, v206
    v_add_f32 v200, v200, v207
    v_cvt_pk_bf16_f32 v153, v206, v207
    v_mfma_f32_16x16x32_bf16 a[64:67], a[248:251], v[160:163], a[64:67]
    v_exp_f32 v204, v110
    v_mfma_f32_16x16x32_bf16 a[68:71], a[248:251], v[164:167], a[68:71]
    ds_read_b64_tr_b16 a[248:249], v211 offset:17088
    ds_read_b64_tr_b16 a[250:251], v211 offset:17344
    v_mfma_f32_16x16x32_bf16 a[84:87], a[252:255], v[156:159], a[84:87]
    v_exp_f32 v205, v111
    v_add_f32 v198, v198, v202
    v_mfma_f32_16x16x32_bf16 a[88:91], a[252:255], v[160:163], a[88:91]
    v_add_f32 v198, v198, v203
    v_cvt_pk_bf16_f32 v146, v202, v203
    v_mfma_f32_16x16x32_bf16 a[92:95], a[252:255], v[164:167], a[92:95]
    ds_read_b64_tr_b16 a[252:253], v211 offset:17120
    ds_read_b64_tr_b16 a[254:255], v211 offset:17376
    s_add_u32 m0, s41, 53088
    v_mfma_f32_16x16x32_bf16 v[120:123], a[192:195], a[108:111], v[180:183]
    buffer_load_dwordx4 v212, s[16:19], s31 offen offset:768 nt lds
    v_mfma_f32_16x16x32_bf16 v[120:123], a[196:199], a[132:135], v[120:123]
    v_exp_f32 v206, v112
    v_mfma_f32_16x16x32_bf16 v[120:123], a[200:203], a[156:159], v[120:123]
    v_exp_f32 v207, v113
    v_add_f32 v198, v198, v204
    v_mfma_f32_16x16x32_bf16 v[120:123], a[204:207], a[180:183], v[120:123]
    v_add_f32 v198, v198, v205
    v_cvt_pk_bf16_f32 v147, v204, v205
    v_mfma_f32_16x16x32_bf16 v[124:127], a[192:195], a[112:115], v[184:187]
    v_exp_f32 v202, v114
    v_mfma_f32_16x16x32_bf16 v[124:127], a[196:199], a[136:139], v[124:127]
    v_exp_f32 v203, v115
    v_add_f32 v199, v199, v206
    v_mfma_f32_16x16x32_bf16 v[124:127], a[200:203], a[160:163], v[124:127]
    v_add_f32 v199, v199, v207
    v_cvt_pk_bf16_f32 v150, v206, v207
    v_mfma_f32_16x16x32_bf16 v[124:127], a[204:207], a[184:187], v[124:127]
    v_exp_f32 v204, v116
    v_mfma_f32_16x16x32_bf16 v[128:131], a[192:195], a[116:119], v[188:191]
    v_exp_f32 v205, v117
    v_add_f32 v199, v199, v202
    v_mfma_f32_16x16x32_bf16 v[128:131], a[196:199], a[140:143], v[128:131]
    v_add_f32 v199, v199, v203
    v_cvt_pk_bf16_f32 v151, v202, v203
    v_mfma_f32_16x16x32_bf16 v[128:131], a[200:203], a[164:167], v[128:131]
    v_exp_f32 v206, v118
    v_mfma_f32_16x16x32_bf16 v[128:131], a[204:207], a[188:191], v[128:131]
    v_exp_f32 v207, v119
    v_add_f32 v200, v200, v204
    v_add_f32 v200, v200, v205
    s_add_u32 m0, s41, 120672
    v_mfma_f32_16x16x32_bf16 v[132:135], a[208:211], a[108:111], v[180:183]
    buffer_load_dwordx4 v212, s[20:23], s31 offen offset:768 nt lds
    v_mfma_f32_16x16x32_bf16 v[132:135], a[212:215], a[132:135], v[132:135]
    v_cvt_pk_bf16_f32 v154, v204, v205
    v_add_f32 v201, v198, v199
    v_mfma_f32_16x16x32_bf16 v[132:135], a[216:219], a[156:159], v[132:135]
    v_add_f32 v200, v200, v206
    v_add_f32 v200, v200, v207
    v_mfma_f32_16x16x32_bf16 v[132:135], a[220:223], a[180:183], v[132:135]
    v_add_f32 v201, v201, v200
    v_cmp_lt_f32 vcc, s36, v201
    v_mfma_f32_16x16x32_bf16 v[136:139], a[208:211], a[112:115], v[184:187]
    v_cvt_pk_bf16_f32 v155, v206, v207
    v_exp_f32 v202, v120
    v_mfma_f32_16x16x32_bf16 v[136:139], a[212:215], a[136:139], v[136:139]
    v_exp_f32 v203, v121
    s_mov_b32 m0, 162816
    v_mfma_f32_16x16x32_bf16 v[136:139], a[216:219], a[160:163], v[136:139]
    buffer_load_dwordx4 v252, s[92:95], s37 offen lds
    s_add_u32 s39, s39, 1
    s_cmp_eq_u32 s39, 5
    s_cselect_b32 s3, 40448, s46
    s_cselect_b32 s39, 0, s39
    s_add_u32 s37, s37, s3
    v_mfma_f32_16x16x32_bf16 v[136:139], a[220:223], a[184:187], v[136:139]
    v_exp_f32 v204, v122
    v_mfma_f32_16x16x32_bf16 v[140:143], a[208:211], a[116:119], v[188:191]
    v_exp_f32 v205, v123
    v_mfma_f32_16x16x32_bf16 v[140:143], a[212:215], a[140:143], v[140:143]
    v_add_f32 v222, v202, v203
    v_cvt_pk_bf16_f32 v156, v202, v203
    v_mfma_f32_16x16x32_bf16 v[140:143], a[216:219], a[164:167], v[140:143]
    v_exp_f32 v206, v124
    v_mfma_f32_16x16x32_bf16 v[140:143], a[220:223], a[188:191], v[140:143]
    v_exp_f32 v207, v125
    v_add_f32 v222, v222, v204
    v_add_f32 v222, v222, v205
    v_cvt_pk_bf16_f32 v157, v204, v205
    v_exp_f32 v202, v126
    s_add_u32 s47, s47, 1
    s_cmp_lt_u32 s47, 7
    s_cbranch_scc1 L1_loop
    s_cbranch_vccnz L_stub_21
    L_ret_22:
    s_add_u32 s31, s31, 16384
    s_waitcnt vmcnt(3) lgkmcnt(0)
    s_barrier
    v_mfma_f32_16x16x32_bf16 v[0:3], a[224:227], v[144:147], v[0:3]
    v_add_f32 v192, v192, v198
    v_add_f32 v193, v193, v199
    v_mfma_f32_16x16x32_bf16 v[4:7], a[224:227], v[148:151], v[4:7]
    v_add_f32 v194, v194, v200
    v_exp_f32 v203, v127
    v_mfma_f32_16x16x32_bf16 v[8:11], a[224:227], v[152:155], v[8:11]
    ds_read_b128 a[192:195], v209 offset:33792
    v_add_f32 v223, v206, v207
    v_mfma_f32_16x16x32_bf16 v[24:27], a[228:231], v[144:147], v[24:27]
    v_cvt_pk_bf16_f32 v160, v206, v207
    v_exp_f32 v204, v128
    v_mfma_f32_16x16x32_bf16 v[28:31], a[228:231], v[148:151], v[28:31]
    v_exp_f32 v205, v129
    v_mfma_f32_16x16x32_bf16 v[32:35], a[228:231], v[152:155], v[32:35]
    ds_read_b128 a[196:199], v209 offset:33856
    v_add_f32 v223, v223, v202
    v_mfma_f32_16x16x32_bf16 v[48:51], a[232:235], v[144:147], v[48:51]
    v_add_f32 v223, v223, v203
    v_cvt_pk_bf16_f32 v161, v202, v203
    v_mfma_f32_16x16x32_bf16 v[52:55], a[232:235], v[148:151], v[52:55]
    v_exp_f32 v206, v130
    v_mfma_f32_16x16x32_bf16 v[56:59], a[232:235], v[152:155], v[56:59]
    ds_read_b128 a[200:203], v209 offset:33920
    v_exp_f32 v207, v131
    v_add_f32 v224, v204, v205
    v_mfma_f32_16x16x32_bf16 v[72:75], a[236:239], v[144:147], v[72:75]
    v_cvt_pk_bf16_f32 v164, v204, v205
    v_exp_f32 v202, v132
    v_mfma_f32_16x16x32_bf16 v[76:79], a[236:239], v[148:151], v[76:79]
    v_exp_f32 v203, v133
    v_mfma_f32_16x16x32_bf16 v[80:83], a[236:239], v[152:155], v[80:83]
    ds_read_b128 a[204:207], v209 offset:33984
    v_add_f32 v224, v224, v206
    v_mfma_f32_16x16x32_bf16 a[0:3], a[240:243], v[144:147], a[0:3]
    v_add_f32 v224, v224, v207
    v_cvt_pk_bf16_f32 v165, v206, v207
    v_mfma_f32_16x16x32_bf16 a[4:7], a[240:243], v[148:151], a[4:7]
    v_exp_f32 v204, v134
    v_mfma_f32_16x16x32_bf16 a[8:11], a[240:243], v[152:155], a[8:11]
    ds_read_b128 a[208:211], v209 offset:34048
    v_exp_f32 v205, v135
    v_mfma_f32_16x16x32_bf16 a[24:27], a[244:247], v[144:147], a[24:27]
    v_add_f32 v222, v222, v202
    v_add_f32 v222, v222, v203
    v_mfma_f32_16x16x32_bf16 a[28:31], a[244:247], v[148:151], a[28:31]
    v_cvt_pk_bf16_f32 v158, v202, v203
    v_exp_f32 v206, v136
    v_mfma_f32_16x16x32_bf16 a[32:35], a[244:247], v[152:155], a[32:35]
    ds_read_b128 a[212:215], v209 offset:34112
    v_exp_f32 v207, v137
    v_mfma_f32_16x16x32_bf16 a[48:51], a[248:251], v[144:147], a[48:51]
    v_add_f32 v222, v222, v204
    v_add_f32 v222, v222, v205
    v_mfma_f32_16x16x32_bf16 a[52:55], a[248:251], v[148:151], a[52:55]
    v_cvt_pk_bf16_f32 v159, v204, v205
    v_exp_f32 v202, v138
    v_mfma_f32_16x16x32_bf16 a[56:59], a[248:251], v[152:155], a[56:59]
    ds_read_b128 a[216:219], v209 offset:34176
    v_mfma_f32_16x16x32_bf16 a[72:75], a[252:255], v[144:147], a[72:75]
    v_exp_f32 v203, v139
    v_add_f32 v223, v223, v206
    v_mfma_f32_16x16x32_bf16 a[76:79], a[252:255], v[148:151], a[76:79]
    v_add_f32 v223, v223, v207
    v_cvt_pk_bf16_f32 v162, v206, v207
    v_mfma_f32_16x16x32_bf16 a[80:83], a[252:255], v[152:155], a[80:83]
    ds_read_b128 a[220:223], v209 offset:34240
    v_exp_f32 v204, v140
    s_waitcnt lgkmcnt(7)
    v_mfma_f32_16x16x32_bf16 v[96:99], a[192:195], a[96:99], v[168:171]
    v_exp_f32 v205, v141
    s_waitcnt lgkmcnt(6)
    v_mfma_f32_16x16x32_bf16 v[96:99], a[196:199], a[120:123], v[96:99]
    v_add_f32 v223, v223, v202
    v_add_f32 v223, v223, v203
    s_waitcnt lgkmcnt(5)
    v_mfma_f32_16x16x32_bf16 v[96:99], a[200:203], a[144:147], v[96:99]
    v_cvt_pk_bf16_f32 v163, v202, v203
    s_waitcnt lgkmcnt(4)
    v_mfma_f32_16x16x32_bf16 v[96:99], a[204:207], a[168:171], v[96:99]
    v_exp_f32 v206, v142
    v_mfma_f32_16x16x32_bf16 v[100:103], a[192:195], a[100:103], v[172:175]
    v_exp_f32 v207, v143
    v_mfma_f32_16x16x32_bf16 v[100:103], a[196:199], a[124:127], v[100:103]
    v_add_f32 v224, v224, v204
    v_add_f32 v224, v224, v205
    v_mfma_f32_16x16x32_bf16 v[100:103], a[200:203], a[148:151], v[100:103]
    v_cvt_pk_bf16_f32 v166, v204, v205
    v_add_f32 v208, v222, v223
    v_mfma_f32_16x16x32_bf16 v[100:103], a[204:207], a[172:175], v[100:103]
    v_add_f32 v224, v224, v206
    v_add_f32 v224, v224, v207
    v_mfma_f32_16x16x32_bf16 v[104:107], a[192:195], a[104:107], v[176:179]
    v_add_f32 v208, v208, v224
    v_cmp_lt_f32 vcc, s36, v208
    v_mfma_f32_16x16x32_bf16 v[104:107], a[196:199], a[128:131], v[104:107]
    v_cvt_pk_bf16_f32 v167, v206, v207
    v_exp_f32 v202, v96
    v_mfma_f32_16x16x32_bf16 v[104:107], a[200:203], a[152:155], v[104:107]
    v_exp_f32 v203, v97
    v_mfma_f32_16x16x32_bf16 v[104:107], a[204:207], a[176:179], v[104:107]
    v_exp_f32 v204, v98
    s_waitcnt lgkmcnt(3)
    v_mfma_f32_16x16x32_bf16 v[108:111], a[208:211], a[96:99], v[168:171]
    v_exp_f32 v205, v99
    s_waitcnt lgkmcnt(2)
    v_mfma_f32_16x16x32_bf16 v[108:111], a[212:215], a[120:123], v[108:111]
    v_add_f32 v198, v202, v203
    v_cvt_pk_bf16_f32 v144, v202, v203
    s_waitcnt lgkmcnt(1)
    v_mfma_f32_16x16x32_bf16 v[108:111], a[216:219], a[144:147], v[108:111]
    v_exp_f32 v206, v100
    s_waitcnt lgkmcnt(0)
    v_mfma_f32_16x16x32_bf16 v[108:111], a[220:223], a[168:171], v[108:111]
    v_exp_f32 v207, v101
    v_mfma_f32_16x16x32_bf16 v[112:115], a[208:211], a[100:103], v[172:175]
    v_add_f32 v198, v198, v204
    v_add_f32 v198, v198, v205
    v_mfma_f32_16x16x32_bf16 v[112:115], a[212:215], a[124:127], v[112:115]
    v_cvt_pk_bf16_f32 v145, v204, v205
    v_mfma_f32_16x16x32_bf16 v[112:115], a[216:219], a[148:151], v[112:115]
    v_exp_f32 v202, v102
    v_mfma_f32_16x16x32_bf16 v[112:115], a[220:223], a[172:175], v[112:115]
    v_exp_f32 v203, v103
    v_add_f32 v199, v206, v207
    v_mfma_f32_16x16x32_bf16 v[116:119], a[208:211], a[104:107], v[176:179]
    v_cvt_pk_bf16_f32 v148, v206, v207
    v_exp_f32 v204, v104
    v_mfma_f32_16x16x32_bf16 v[116:119], a[212:215], a[128:131], v[116:119]
    v_exp_f32 v205, v105
    v_mfma_f32_16x16x32_bf16 v[116:119], a[216:219], a[152:155], v[116:119]
    v_add_f32 v199, v199, v202
    v_add_f32 v199, v199, v203
    v_mfma_f32_16x16x32_bf16 v[116:119], a[220:223], a[176:179], v[116:119]
    v_cvt_pk_bf16_f32 v149, v202, v203
    v_exp_f32 v206, v106
    s_cbranch_vccnz L_stub_23
    L_ret_24:
    v_mfma_f32_16x16x32_bf16 v[12:15], a[224:227], v[156:159], v[12:15]
    v_add_f32 v195, v195, v222
    v_add_f32 v196, v196, v223
    v_mfma_f32_16x16x32_bf16 v[16:19], a[224:227], v[160:163], v[16:19]
    v_add_f32 v197, v197, v224
    v_mfma_f32_16x16x32_bf16 v[20:23], a[224:227], v[164:167], v[20:23]
    ds_read_b64_tr_b16 a[224:225], v210 offset:33792
    ds_read_b64_tr_b16 a[226:227], v210 offset:34048
    v_mfma_f32_16x16x32_bf16 v[36:39], a[228:231], v[156:159], v[36:39]
    v_exp_f32 v207, v107
    v_add_f32 v200, v204, v205
    v_mfma_f32_16x16x32_bf16 v[40:43], a[228:231], v[160:163], v[40:43]
    v_cvt_pk_bf16_f32 v152, v204, v205
    v_exp_f32 v202, v108
    v_mfma_f32_16x16x32_bf16 v[44:47], a[228:231], v[164:167], v[44:47]
    ds_read_b64_tr_b16 a[228:229], v210 offset:33824
    ds_read_b64_tr_b16 a[230:231], v210 offset:34080
    v_mfma_f32_16x16x32_bf16 v[60:63], a[232:235], v[156:159], v[60:63]
    v_exp_f32 v203, v109
    v_mfma_f32_16x16x32_bf16 v[64:67], a[232:235], v[160:163], v[64:67]
    v_add_f32 v200, v200, v206
    v_add_f32 v200, v200, v207
    v_mfma_f32_16x16x32_bf16 v[68:71], a[232:235], v[164:167], v[68:71]
    ds_read_b64_tr_b16 a[232:233], v210 offset:33856
    ds_read_b64_tr_b16 a[234:235], v210 offset:34112
    v_cvt_pk_bf16_f32 v153, v206, v207
    v_mfma_f32_16x16x32_bf16 v[84:87], a[236:239], v[156:159], v[84:87]
    v_exp_f32 v204, v110
    v_mfma_f32_16x16x32_bf16 v[88:91], a[236:239], v[160:163], v[88:91]
    v_exp_f32 v205, v111
    v_add_f32 v198, v198, v202
    v_mfma_f32_16x16x32_bf16 v[92:95], a[236:239], v[164:167], v[92:95]
    ds_read_b64_tr_b16 a[236:237], v210 offset:33888
    ds_read_b64_tr_b16 a[238:239], v210 offset:34144
    v_mfma_f32_16x16x32_bf16 a[12:15], a[240:243], v[156:159], a[12:15]
    v_add_f32 v198, v198, v203
    v_cvt_pk_bf16_f32 v146, v202, v203
    v_mfma_f32_16x16x32_bf16 a[16:19], a[240:243], v[160:163], a[16:19]
    v_exp_f32 v206, v112
    v_mfma_f32_16x16x32_bf16 a[20:23], a[240:243], v[164:167], a[20:23]
    ds_read_b64_tr_b16 a[240:241], v211 offset:33920
    ds_read_b64_tr_b16 a[242:243], v211 offset:34176
    v_mfma_f32_16x16x32_bf16 a[36:39], a[244:247], v[156:159], a[36:39]
    v_exp_f32 v207, v113
    v_add_f32 v198, v198, v204
    v_add_f32 v198, v198, v205
    v_mfma_f32_16x16x32_bf16 a[40:43], a[244:247], v[160:163], a[40:43]
    v_cvt_pk_bf16_f32 v147, v204, v205
    v_exp_f32 v202, v114
    v_mfma_f32_16x16x32_bf16 a[44:47], a[244:247], v[164:167], a[44:47]
    ds_read_b64_tr_b16 a[244:245], v211 offset:33952
    ds_read_b64_tr_b16 a[246:247], v211 offset:34208
    v_mfma_f32_16x16x32_bf16 a[60:63], a[248:251], v[156:159], a[60:63]
    v_exp_f32 v203, v115
    v_mfma_f32_16x16x32_bf16 a[64:67], a[248:251], v[160:163], a[64:67]
    v_add_f32 v199, v199, v206
    v_add_f32 v199, v199, v207
    v_mfma_f32_16x16x32_bf16 a[68:71], a[248:251], v[164:167], a[68:71]
    ds_read_b64_tr_b16 a[248:249], v211 offset:33984
    ds_read_b64_tr_b16 a[250:251], v211 offset:34240
    v_cvt_pk_bf16_f32 v150, v206, v207
    v_mfma_f32_16x16x32_bf16 a[84:87], a[252:255], v[156:159], a[84:87]
    v_exp_f32 v204, v116
    v_mfma_f32_16x16x32_bf16 a[88:91], a[252:255], v[160:163], a[88:91]
    v_exp_f32 v205, v117
    v_mfma_f32_16x16x32_bf16 a[92:95], a[252:255], v[164:167], a[92:95]
    ds_read_b64_tr_b16 a[252:253], v211 offset:34016
    ds_read_b64_tr_b16 a[254:255], v211 offset:34272
    v_add_f32 v199, v199, v202
    v_mfma_f32_16x16x32_bf16 v[120:123], a[192:195], a[108:111], v[180:183]
    v_add_f32 v199, v199, v203
    v_cvt_pk_bf16_f32 v151, v202, v203
    v_mfma_f32_16x16x32_bf16 v[120:123], a[196:199], a[132:135], v[120:123]
    v_exp_f32 v206, v118
    v_mfma_f32_16x16x32_bf16 v[120:123], a[200:203], a[156:159], v[120:123]
    v_exp_f32 v207, v119
    v_add_f32 v200, v200, v204
    v_mfma_f32_16x16x32_bf16 v[120:123], a[204:207], a[180:183], v[120:123]
    v_add_f32 v200, v200, v205
    v_cvt_pk_bf16_f32 v154, v204, v205
    v_mfma_f32_16x16x32_bf16 v[124:127], a[192:195], a[112:115], v[184:187]
    v_add_f32 v201, v198, v199
    v_add_f32 v200, v200, v206
    v_add_f32 v200, v200, v207
    v_mfma_f32_16x16x32_bf16 v[124:127], a[196:199], a[136:139], v[124:127]
    v_add_f32 v201, v201, v200
    v_cmp_lt_f32 vcc, s36, v201
    v_mfma_f32_16x16x32_bf16 v[124:127], a[200:203], a[160:163], v[124:127]
    v_cvt_pk_bf16_f32 v155, v206, v207
    v_exp_f32 v202, v120
    v_mfma_f32_16x16x32_bf16 v[124:127], a[204:207], a[184:187], v[124:127]
    v_exp_f32 v203, v121
    v_mfma_f32_16x16x32_bf16 v[128:131], a[192:195], a[116:119], v[188:191]
    v_exp_f32 v204, v122
    v_mfma_f32_16x16x32_bf16 v[128:131], a[196:199], a[140:143], v[128:131]
    v_exp_f32 v205, v123
    v_add_f32 v222, v202, v203
    v_mfma_f32_16x16x32_bf16 v[128:131], a[200:203], a[164:167], v[128:131]
    v_cvt_pk_bf16_f32 v156, v202, v203
    v_exp_f32 v206, v124
    v_mfma_f32_16x16x32_bf16 v[128:131], a[204:207], a[188:191], v[128:131]
    v_exp_f32 v207, v125
    v_mfma_f32_16x16x32_bf16 v[132:135], a[208:211], a[108:111], v[180:183]
    v_add_f32 v222, v222, v204
    v_add_f32 v222, v222, v205
    v_mfma_f32_16x16x32_bf16 v[132:135], a[212:215], a[132:135], v[132:135]
    v_cvt_pk_bf16_f32 v157, v204, v205
    v_exp_f32 v202, v126
    v_mfma_f32_16x16x32_bf16 v[132:135], a[216:219], a[156:159], v[132:135]
    v_mfma_f32_16x16x32_bf16 v[132:135], a[220:223], a[180:183], v[132:135]
    v_mfma_f32_16x16x32_bf16 v[136:139], a[208:211], a[112:115], v[184:187]
    v_mfma_f32_16x16x32_bf16 v[136:139], a[212:215], a[136:139], v[136:139]
    v_mfma_f32_16x16x32_bf16 v[136:139], a[216:219], a[160:163], v[136:139]
    v_mfma_f32_16x16x32_bf16 v[136:139], a[220:223], a[184:187], v[136:139]
    v_mfma_f32_16x16x32_bf16 v[140:143], a[208:211], a[116:119], v[188:191]
    v_mfma_f32_16x16x32_bf16 v[140:143], a[212:215], a[140:143], v[140:143]
    v_mfma_f32_16x16x32_bf16 v[140:143], a[216:219], a[164:167], v[140:143]
    v_mfma_f32_16x16x32_bf16 v[140:143], a[220:223], a[188:191], v[140:143]
    s_cbranch_vccnz L_stub_25
    L_ret_26:
    s_add_u32 s31, s31, 16384
    s_waitcnt vmcnt(0) lgkmcnt(0)
    s_barrier
    v_mfma_f32_16x16x32_bf16 v[0:3], a[224:227], v[144:147], v[0:3]
    v_add_f32 v192, v192, v198
    v_add_f32 v193, v193, v199
    v_mfma_f32_16x16x32_bf16 v[4:7], a[224:227], v[148:151], v[4:7]
    v_add_f32 v194, v194, v200
    v_exp_f32 v203, v127
    v_mfma_f32_16x16x32_bf16 v[8:11], a[224:227], v[152:155], v[8:11]
    ds_read_b128 a[192:195], v209 offset:50688
    v_add_f32 v223, v206, v207
    v_mfma_f32_16x16x32_bf16 v[24:27], a[228:231], v[144:147], v[24:27]
    v_cvt_pk_bf16_f32 v160, v206, v207
    v_exp_f32 v204, v128
    v_mfma_f32_16x16x32_bf16 v[28:31], a[228:231], v[148:151], v[28:31]
    v_exp_f32 v205, v129
    v_mfma_f32_16x16x32_bf16 v[32:35], a[228:231], v[152:155], v[32:35]
    ds_read_b128 a[196:199], v209 offset:50752
    v_add_f32 v223, v223, v202
    v_mfma_f32_16x16x32_bf16 v[48:51], a[232:235], v[144:147], v[48:51]
    v_add_f32 v223, v223, v203
    v_cvt_pk_bf16_f32 v161, v202, v203
    v_mfma_f32_16x16x32_bf16 v[52:55], a[232:235], v[148:151], v[52:55]
    v_exp_f32 v206, v130
    v_mfma_f32_16x16x32_bf16 v[56:59], a[232:235], v[152:155], v[56:59]
    ds_read_b128 a[200:203], v209 offset:50816
    v_exp_f32 v207, v131
    v_add_f32 v224, v204, v205
    v_mfma_f32_16x16x32_bf16 v[72:75], a[236:239], v[144:147], v[72:75]
    v_cvt_pk_bf16_f32 v164, v204, v205
    v_exp_f32 v202, v132
    v_mfma_f32_16x16x32_bf16 v[76:79], a[236:239], v[148:151], v[76:79]
    v_exp_f32 v203, v133
    v_mfma_f32_16x16x32_bf16 v[80:83], a[236:239], v[152:155], v[80:83]
    ds_read_b128 a[204:207], v209 offset:50880
    v_add_f32 v224, v224, v206
    v_mfma_f32_16x16x32_bf16 a[0:3], a[240:243], v[144:147], a[0:3]
    v_add_f32 v224, v224, v207
    v_cvt_pk_bf16_f32 v165, v206, v207
    v_mfma_f32_16x16x32_bf16 a[4:7], a[240:243], v[148:151], a[4:7]
    v_exp_f32 v204, v134
    v_mfma_f32_16x16x32_bf16 a[8:11], a[240:243], v[152:155], a[8:11]
    ds_read_b128 a[208:211], v209 offset:50944
    v_exp_f32 v205, v135
    v_mfma_f32_16x16x32_bf16 a[24:27], a[244:247], v[144:147], a[24:27]
    v_add_f32 v222, v222, v202
    v_add_f32 v222, v222, v203
    v_mfma_f32_16x16x32_bf16 a[28:31], a[244:247], v[148:151], a[28:31]
    v_cvt_pk_bf16_f32 v158, v202, v203
    v_exp_f32 v206, v136
    v_mfma_f32_16x16x32_bf16 a[32:35], a[244:247], v[152:155], a[32:35]
    ds_read_b128 a[212:215], v209 offset:51008
    v_exp_f32 v207, v137
    v_mfma_f32_16x16x32_bf16 a[48:51], a[248:251], v[144:147], a[48:51]
    v_add_f32 v222, v222, v204
    v_add_f32 v222, v222, v205
    v_mfma_f32_16x16x32_bf16 a[52:55], a[248:251], v[148:151], a[52:55]
    v_cvt_pk_bf16_f32 v159, v204, v205
    v_exp_f32 v202, v138
    v_mfma_f32_16x16x32_bf16 a[56:59], a[248:251], v[152:155], a[56:59]
    ds_read_b128 a[216:219], v209 offset:51072
    v_mfma_f32_16x16x32_bf16 a[72:75], a[252:255], v[144:147], a[72:75]
    v_exp_f32 v203, v139
    v_add_f32 v223, v223, v206
    v_mfma_f32_16x16x32_bf16 a[76:79], a[252:255], v[148:151], a[76:79]
    v_add_f32 v223, v223, v207
    v_cvt_pk_bf16_f32 v162, v206, v207
    v_mfma_f32_16x16x32_bf16 a[80:83], a[252:255], v[152:155], a[80:83]
    ds_read_b128 a[220:223], v209 offset:51136
    v_exp_f32 v204, v140
    s_waitcnt lgkmcnt(7)
    v_mfma_f32_16x16x32_bf16 v[96:99], a[192:195], a[96:99], v[168:171]
    v_exp_f32 v205, v141
    s_waitcnt lgkmcnt(6)
    v_mfma_f32_16x16x32_bf16 v[96:99], a[196:199], a[120:123], v[96:99]
    v_add_f32 v223, v223, v202
    v_add_f32 v223, v223, v203
    s_waitcnt lgkmcnt(5)
    v_mfma_f32_16x16x32_bf16 v[96:99], a[200:203], a[144:147], v[96:99]
    v_cvt_pk_bf16_f32 v163, v202, v203
    s_waitcnt lgkmcnt(4)
    v_mfma_f32_16x16x32_bf16 v[96:99], a[204:207], a[168:171], v[96:99]
    v_exp_f32 v206, v142
    v_mfma_f32_16x16x32_bf16 v[100:103], a[192:195], a[100:103], v[172:175]
    v_exp_f32 v207, v143
    v_mfma_f32_16x16x32_bf16 v[100:103], a[196:199], a[124:127], v[100:103]
    v_add_f32 v224, v224, v204
    v_add_f32 v224, v224, v205
    v_mfma_f32_16x16x32_bf16 v[100:103], a[200:203], a[148:151], v[100:103]
    v_cvt_pk_bf16_f32 v166, v204, v205
    v_add_f32 v208, v222, v223
    v_mfma_f32_16x16x32_bf16 v[100:103], a[204:207], a[172:175], v[100:103]
    v_add_f32 v224, v224, v206
    v_add_f32 v224, v224, v207
    v_mfma_f32_16x16x32_bf16 v[104:107], a[192:195], a[104:107], v[176:179]
    v_add_f32 v208, v208, v224
    v_cmp_lt_f32 vcc, s36, v208
    v_mfma_f32_16x16x32_bf16 v[104:107], a[196:199], a[128:131], v[104:107]
    v_cvt_pk_bf16_f32 v167, v206, v207
    v_exp_f32 v202, v96
    v_mfma_f32_16x16x32_bf16 v[104:107], a[200:203], a[152:155], v[104:107]
    v_exp_f32 v203, v97
    v_mfma_f32_16x16x32_bf16 v[104:107], a[204:207], a[176:179], v[104:107]
    v_exp_f32 v204, v98
    s_waitcnt lgkmcnt(3)
    v_mfma_f32_16x16x32_bf16 v[108:111], a[208:211], a[96:99], v[168:171]
    v_exp_f32 v205, v99
    s_waitcnt lgkmcnt(2)
    v_mfma_f32_16x16x32_bf16 v[108:111], a[212:215], a[120:123], v[108:111]
    v_add_f32 v198, v202, v203
    v_cvt_pk_bf16_f32 v144, v202, v203
    s_waitcnt lgkmcnt(1)
    v_mfma_f32_16x16x32_bf16 v[108:111], a[216:219], a[144:147], v[108:111]
    v_exp_f32 v206, v100
    s_waitcnt lgkmcnt(0)
    v_mfma_f32_16x16x32_bf16 v[108:111], a[220:223], a[168:171], v[108:111]
    v_exp_f32 v207, v101
    v_mfma_f32_16x16x32_bf16 v[112:115], a[208:211], a[100:103], v[172:175]
    v_add_f32 v198, v198, v204
    v_add_f32 v198, v198, v205
    v_mfma_f32_16x16x32_bf16 v[112:115], a[212:215], a[124:127], v[112:115]
    v_cvt_pk_bf16_f32 v145, v204, v205
    v_mfma_f32_16x16x32_bf16 v[112:115], a[216:219], a[148:151], v[112:115]
    v_exp_f32 v202, v102
    v_mfma_f32_16x16x32_bf16 v[112:115], a[220:223], a[172:175], v[112:115]
    v_exp_f32 v203, v103
    v_add_f32 v199, v206, v207
    v_mfma_f32_16x16x32_bf16 v[116:119], a[208:211], a[104:107], v[176:179]
    v_cvt_pk_bf16_f32 v148, v206, v207
    v_exp_f32 v204, v104
    v_mfma_f32_16x16x32_bf16 v[116:119], a[212:215], a[128:131], v[116:119]
    v_exp_f32 v205, v105
    v_mfma_f32_16x16x32_bf16 v[116:119], a[216:219], a[152:155], v[116:119]
    v_add_f32 v199, v199, v202
    v_add_f32 v199, v199, v203
    v_mfma_f32_16x16x32_bf16 v[116:119], a[220:223], a[176:179], v[116:119]
    v_cvt_pk_bf16_f32 v149, v202, v203
    v_exp_f32 v206, v106
    s_cbranch_vccnz L_stub_27
    L_ret_28:
    v_mfma_f32_16x16x32_bf16 v[12:15], a[224:227], v[156:159], v[12:15]
    v_add_f32 v195, v195, v222
    v_add_f32 v196, v196, v223
    v_mfma_f32_16x16x32_bf16 v[16:19], a[224:227], v[160:163], v[16:19]
    v_add_f32 v197, v197, v224
    v_mfma_f32_16x16x32_bf16 v[20:23], a[224:227], v[164:167], v[20:23]
    ds_read_b64_tr_b16 a[224:225], v210 offset:50688
    ds_read_b64_tr_b16 a[226:227], v210 offset:50944
    v_mfma_f32_16x16x32_bf16 v[36:39], a[228:231], v[156:159], v[36:39]
    v_exp_f32 v207, v107
    v_add_f32 v200, v204, v205
    v_mfma_f32_16x16x32_bf16 v[40:43], a[228:231], v[160:163], v[40:43]
    v_cvt_pk_bf16_f32 v152, v204, v205
    v_exp_f32 v202, v108
    v_mfma_f32_16x16x32_bf16 v[44:47], a[228:231], v[164:167], v[44:47]
    ds_read_b64_tr_b16 a[228:229], v210 offset:50720
    ds_read_b64_tr_b16 a[230:231], v210 offset:50976
    v_mfma_f32_16x16x32_bf16 v[60:63], a[232:235], v[156:159], v[60:63]
    v_exp_f32 v203, v109
    v_mfma_f32_16x16x32_bf16 v[64:67], a[232:235], v[160:163], v[64:67]
    v_add_f32 v200, v200, v206
    v_add_f32 v200, v200, v207
    v_mfma_f32_16x16x32_bf16 v[68:71], a[232:235], v[164:167], v[68:71]
    ds_read_b64_tr_b16 a[232:233], v210 offset:50752
    ds_read_b64_tr_b16 a[234:235], v210 offset:51008
    v_cvt_pk_bf16_f32 v153, v206, v207
    v_mfma_f32_16x16x32_bf16 v[84:87], a[236:239], v[156:159], v[84:87]
    v_exp_f32 v204, v110
    v_mfma_f32_16x16x32_bf16 v[88:91], a[236:239], v[160:163], v[88:91]
    v_exp_f32 v205, v111
    v_add_f32 v198, v198, v202
    v_mfma_f32_16x16x32_bf16 v[92:95], a[236:239], v[164:167], v[92:95]
    ds_read_b64_tr_b16 a[236:237], v210 offset:50784
    ds_read_b64_tr_b16 a[238:239], v210 offset:51040
    v_mfma_f32_16x16x32_bf16 a[12:15], a[240:243], v[156:159], a[12:15]
    v_add_f32 v198, v198, v203
    v_cvt_pk_bf16_f32 v146, v202, v203
    v_mfma_f32_16x16x32_bf16 a[16:19], a[240:243], v[160:163], a[16:19]
    v_exp_f32 v206, v112
    v_mfma_f32_16x16x32_bf16 a[20:23], a[240:243], v[164:167], a[20:23]
    ds_read_b64_tr_b16 a[240:241], v211 offset:50816
    ds_read_b64_tr_b16 a[242:243], v211 offset:51072
    v_mfma_f32_16x16x32_bf16 a[36:39], a[244:247], v[156:159], a[36:39]
    v_exp_f32 v207, v113
    v_add_f32 v198, v198, v204
    v_add_f32 v198, v198, v205
    v_mfma_f32_16x16x32_bf16 a[40:43], a[244:247], v[160:163], a[40:43]
    v_cvt_pk_bf16_f32 v147, v204, v205
    v_exp_f32 v202, v114
    v_mfma_f32_16x16x32_bf16 a[44:47], a[244:247], v[164:167], a[44:47]
    ds_read_b64_tr_b16 a[244:245], v211 offset:50848
    ds_read_b64_tr_b16 a[246:247], v211 offset:51104
    v_mfma_f32_16x16x32_bf16 a[60:63], a[248:251], v[156:159], a[60:63]
    v_exp_f32 v203, v115
    v_mfma_f32_16x16x32_bf16 a[64:67], a[248:251], v[160:163], a[64:67]
    v_add_f32 v199, v199, v206
    v_add_f32 v199, v199, v207
    v_mfma_f32_16x16x32_bf16 a[68:71], a[248:251], v[164:167], a[68:71]
    ds_read_b64_tr_b16 a[248:249], v211 offset:50880
    ds_read_b64_tr_b16 a[250:251], v211 offset:51136
    v_cvt_pk_bf16_f32 v150, v206, v207
    v_mfma_f32_16x16x32_bf16 a[84:87], a[252:255], v[156:159], a[84:87]
    v_exp_f32 v204, v116
    v_mfma_f32_16x16x32_bf16 a[88:91], a[252:255], v[160:163], a[88:91]
    v_exp_f32 v205, v117
    v_mfma_f32_16x16x32_bf16 a[92:95], a[252:255], v[164:167], a[92:95]
    ds_read_b64_tr_b16 a[252:253], v211 offset:50912
    ds_read_b64_tr_b16 a[254:255], v211 offset:51168
    v_add_f32 v199, v199, v202
    v_mfma_f32_16x16x32_bf16 v[120:123], a[192:195], a[108:111], v[180:183]
    v_add_f32 v199, v199, v203
    v_cvt_pk_bf16_f32 v151, v202, v203
    v_mfma_f32_16x16x32_bf16 v[120:123], a[196:199], a[132:135], v[120:123]
    v_exp_f32 v206, v118
    v_mfma_f32_16x16x32_bf16 v[120:123], a[200:203], a[156:159], v[120:123]
    v_exp_f32 v207, v119
    v_add_f32 v200, v200, v204
    v_mfma_f32_16x16x32_bf16 v[120:123], a[204:207], a[180:183], v[120:123]
    v_add_f32 v200, v200, v205
    v_cvt_pk_bf16_f32 v154, v204, v205
    v_mfma_f32_16x16x32_bf16 v[124:127], a[192:195], a[112:115], v[184:187]
    v_add_f32 v201, v198, v199
    v_add_f32 v200, v200, v206
    v_add_f32 v200, v200, v207
    v_mfma_f32_16x16x32_bf16 v[124:127], a[196:199], a[136:139], v[124:127]
    v_add_f32 v201, v201, v200
    v_cmp_lt_f32 vcc, s36, v201
    v_mfma_f32_16x16x32_bf16 v[124:127], a[200:203], a[160:163], v[124:127]
    v_cvt_pk_bf16_f32 v155, v206, v207
    v_exp_f32 v202, v120
    v_mfma_f32_16x16x32_bf16 v[124:127], a[204:207], a[184:187], v[124:127]
    v_exp_f32 v203, v121
    v_mfma_f32_16x16x32_bf16 v[128:131], a[192:195], a[116:119], v[188:191]
    v_exp_f32 v204, v122
    v_mfma_f32_16x16x32_bf16 v[128:131], a[196:199], a[140:143], v[128:131]
    v_exp_f32 v205, v123
    v_add_f32 v222, v202, v203
    v_mfma_f32_16x16x32_bf16 v[128:131], a[200:203], a[164:167], v[128:131]
    v_cvt_pk_bf16_f32 v156, v202, v203
    v_exp_f32 v206, v124
    v_mfma_f32_16x16x32_bf16 v[128:131], a[204:207], a[188:191], v[128:131]
    v_exp_f32 v207, v125
    v_mfma_f32_16x16x32_bf16 v[132:135], a[208:211], a[108:111], v[180:183]
    v_add_f32 v222, v222, v204
    v_add_f32 v222, v222, v205
    v_mfma_f32_16x16x32_bf16 v[132:135], a[212:215], a[132:135], v[132:135]
    v_cvt_pk_bf16_f32 v157, v204, v205
    v_exp_f32 v202, v126
    v_mfma_f32_16x16x32_bf16 v[132:135], a[216:219], a[156:159], v[132:135]
    v_mfma_f32_16x16x32_bf16 v[132:135], a[220:223], a[180:183], v[132:135]
    v_mfma_f32_16x16x32_bf16 v[136:139], a[208:211], a[112:115], v[184:187]
    v_mfma_f32_16x16x32_bf16 v[136:139], a[212:215], a[136:139], v[136:139]
    v_mfma_f32_16x16x32_bf16 v[136:139], a[216:219], a[160:163], v[136:139]
    v_mfma_f32_16x16x32_bf16 v[136:139], a[220:223], a[184:187], v[136:139]
    v_mfma_f32_16x16x32_bf16 v[140:143], a[208:211], a[116:119], v[188:191]
    v_mfma_f32_16x16x32_bf16 v[140:143], a[212:215], a[140:143], v[140:143]
    v_mfma_f32_16x16x32_bf16 v[140:143], a[216:219], a[164:167], v[140:143]
    v_mfma_f32_16x16x32_bf16 v[140:143], a[220:223], a[188:191], v[140:143]
    s_cbranch_vccnz L_stub_29
    L_ret_30:
    s_waitcnt lgkmcnt(6)
    v_mfma_f32_16x16x32_bf16 a[0:3], a[240:243], v[144:147], a[0:3]
    v_add_f32 v192, v192, v198
    v_add_f32 v193, v193, v199
    v_add_f32 v194, v194, v200
    v_mfma_f32_16x16x32_bf16 a[4:7], a[240:243], v[148:151], a[4:7]
    v_exp_f32 v203, v127
    v_add_f32 v223, v206, v207
    v_cvt_pk_bf16_f32 v160, v206, v207
    v_mfma_f32_16x16x32_bf16 a[8:11], a[240:243], v[152:155], a[8:11]
    v_exp_f32 v204, v128
    v_exp_f32 v205, v129
    s_waitcnt lgkmcnt(4)
    v_mfma_f32_16x16x32_bf16 a[24:27], a[244:247], v[144:147], a[24:27]
    v_add_f32 v223, v223, v202
    v_add_f32 v223, v223, v203
    v_cvt_pk_bf16_f32 v161, v202, v203
    v_mfma_f32_16x16x32_bf16 a[28:31], a[244:247], v[148:151], a[28:31]
    v_exp_f32 v206, v130
    v_exp_f32 v207, v131
    v_mfma_f32_16x16x32_bf16 a[32:35], a[244:247], v[152:155], a[32:35]
    v_add_f32 v224, v204, v205
    v_cvt_pk_bf16_f32 v164, v204, v205
    v_exp_f32 v202, v132
    s_waitcnt lgkmcnt(2)
    v_mfma_f32_16x16x32_bf16 a[48:51], a[248:251], v[144:147], a[48:51]
    v_exp_f32 v203, v133
    v_add_f32 v224, v224, v206
    v_add_f32 v224, v224, v207
    v_mfma_f32_16x16x32_bf16 a[52:55], a[248:251], v[148:151], a[52:55]
    v_cvt_pk_bf16_f32 v165, v206, v207
    v_exp_f32 v204, v134
    v_mfma_f32_16x16x32_bf16 a[56:59], a[248:251], v[152:155], a[56:59]
    v_exp_f32 v205, v135
    v_add_f32 v222, v222, v202
    v_add_f32 v222, v222, v203
    s_waitcnt lgkmcnt(0)
    v_mfma_f32_16x16x32_bf16 a[72:75], a[252:255], v[144:147], a[72:75]
    v_cvt_pk_bf16_f32 v158, v202, v203
    v_exp_f32 v206, v136
    v_mfma_f32_16x16x32_bf16 a[76:79], a[252:255], v[148:151], a[76:79]
    v_exp_f32 v207, v137
    v_add_f32 v222, v222, v204
    v_add_f32 v222, v222, v205
    v_mfma_f32_16x16x32_bf16 a[80:83], a[252:255], v[152:155], a[80:83]
    v_cvt_pk_bf16_f32 v159, v204, v205
    v_exp_f32 v202, v138
    v_mfma_f32_16x16x32_bf16 v[0:3], a[224:227], v[144:147], v[0:3]
    v_exp_f32 v203, v139
    v_add_f32 v223, v223, v206
    v_add_f32 v223, v223, v207
    v_mfma_f32_16x16x32_bf16 v[4:7], a[224:227], v[148:151], v[4:7]
    v_cvt_pk_bf16_f32 v162, v206, v207
    v_exp_f32 v204, v140
    v_mfma_f32_16x16x32_bf16 v[8:11], a[224:227], v[152:155], v[8:11]
    v_exp_f32 v205, v141
    v_add_f32 v223, v223, v202
    v_add_f32 v223, v223, v203
    v_mfma_f32_16x16x32_bf16 v[24:27], a[228:231], v[144:147], v[24:27]
    v_cvt_pk_bf16_f32 v163, v202, v203
    v_exp_f32 v206, v142
    v_mfma_f32_16x16x32_bf16 v[28:31], a[228:231], v[148:151], v[28:31]
    v_exp_f32 v207, v143
    v_add_f32 v224, v224, v204
    v_add_f32 v224, v224, v205
    v_mfma_f32_16x16x32_bf16 v[32:35], a[228:231], v[152:155], v[32:35]
    v_cvt_pk_bf16_f32 v166, v204, v205
    v_add_f32 v208, v222, v223
    v_add_f32 v224, v224, v206
    v_add_f32 v224, v224, v207
    v_mfma_f32_16x16x32_bf16 v[48:51], a[232:235], v[144:147], v[48:51]
    v_add_f32 v208, v208, v224
    v_cmp_lt_f32 vcc, s36, v208
    v_cvt_pk_bf16_f32 v167, v206, v207
    v_lshlrev_b32 v214, 4, v253
    v_mfma_f32_16x16x32_bf16 v[52:55], a[232:235], v[148:151], v[52:55]
    s_mul_i32 s45, s52, 67584
    s_mul_i32 s3, s53, 24576
    s_add_u32 s3, s3, s45
    v_add_u32 v215, s3, v214
    v_mfma_f32_16x16x32_bf16 v[56:59], a[232:235], v[152:155], v[56:59]
    s_lshl_b32 s3, s32, 10
    s_add_u32 s3, s3, 159744
    v_and_b32 v216, 15, v253
    v_lshlrev_b32 v216, 2, v216
    v_mfma_f32_16x16x32_bf16 v[72:75], a[236:239], v[144:147], v[72:75]
    v_add_u32 v216, s3, v216
    v_xor_b32 v217, 0x400, v216
    s_xor_b32 s46, s53, 1
    s_mul_i32 s3, s46, 24576
    v_mfma_f32_16x16x32_bf16 v[76:79], a[236:239], v[148:151], v[76:79]
    s_add_u32 s41, s3, s45
    v_add_u32 v218, s41, v214
    s_mul_i32 s3, s33, 12
    s_mul_i32 s45, s52, 6
    v_mfma_f32_16x16x32_bf16 v[80:83], a[236:239], v[152:155], v[80:83]
    s_add_u32 s3, s3, s45
    s_lshl_b32 s3, s3, 7
    s_lshl_b32 s45, s34, 2
    s_add_u32 s3, s3, s45
    s_lshl_b32 s45, s53, 1
    s_add_u32 s3, s3, s45
    s_lshl_b32 s3, s3, 10
    v_add_u32 v214, s3, v214
    s_mov_b32 s24, s12
    s_mov_b32 s25, s13
    s_mov_b32 s26, 12582912
    s_mov_b32 s27, 0x20000
    s_and_b32 s45, s2, 7
    s_lshr_b32 s38, s2, 3
    s_mul_i32 s42, s38, 52
    s_lshr_b32 s42, s42, 8
    s_mul_i32 s43, s42, 5
    s_sub_u32 s43, s38, s43
    s_add_u32 s44, s42, s43
    s_mul_i32 s44, s44, 0
    s_and_b32 s44, s44, 31
    s_mov_b32 s48, s44
    s_and_b32 s3, s45, 1
    s_mul_i32 s3, s3, 12
    s_add_u32 s42, s42, s3
    s_bfe_u32 s3, s45, 0x10001
    s_mul_i32 s3, s3, 6
    s_add_u32 s42, s42, s3
    s_lshr_b32 s3, s45, 2
    s_mul_i32 s3, s3, 5
    s_add_u32 s43, s43, s3
    s_mul_i32 s50, s42, 86
    s_lshr_b32 s50, s50, 8
    s_mov_b32 s96, s58
    s_mov_b32 s97, s59
    s_mov_b32 s98, 1966080
    s_mov_b32 s99, 0x20000
    s_mul_i32 s49, s32, 40960
    s_lshl_b32 s3, s43, 7
    s_add_u32 s49, s49, s3
    s_mul_i32 s51, s32, 12288
    s_add_u32 s51, s51, 104448
    s_cmp_eq_u32 s32, 0
    s_cselect_b32 s51, 49152, s51
    v_lshrrev_b32 v250, 3, v253
    v_mul_u32_u24 v250, 1280, v250
    v_bfe_u32 v251, v253, 4, 2
    v_lshlrev_b32 v251, 1, v251
    v_xor_b32 v251, v251, v253
    v_and_b32 v251, 7, v251
    v_lshl_add_u32 v250, v251, 4, v250
    s_cbranch_vccnz L_stub_31
    L_ret_32:
    v_add_f32 v195, v195, v222
    v_add_f32 v196, v196, v223
    v_add_f32 v197, v197, v224
    s_waitcnt lgkmcnt(0)
    v_mfma_f32_16x16x32_bf16 a[12:15], a[240:243], v[156:159], a[12:15]
    v_mov_b32 v202, v192
    v_mov_b32 v203, v193
    v_mov_b32 v204, v194
    v_mov_b32 v205, v195
    v_mov_b32 v206, v196
    v_mov_b32 v207, v197
    v_mfma_f32_16x16x32_bf16 a[16:19], a[240:243], v[160:163], a[16:19]
    v_permlane16_swap_b32 v202, v192
    v_permlane16_swap_b32 v203, v193
    v_permlane16_swap_b32 v204, v194
    v_permlane16_swap_b32 v205, v195
    v_permlane16_swap_b32 v206, v196
    v_permlane16_swap_b32 v207, v197
    v_mfma_f32_16x16x32_bf16 a[20:23], a[240:243], v[164:167], a[20:23]
    v_add_f32 v192, v192, v202
    v_add_f32 v193, v193, v203
    v_add_f32 v194, v194, v204
    v_add_f32 v195, v195, v205
    v_add_f32 v196, v196, v206
    v_add_f32 v197, v197, v207
    v_mfma_f32_16x16x32_bf16 a[36:39], a[244:247], v[156:159], a[36:39]
    v_mov_b32 v202, v192
    v_mov_b32 v203, v193
    v_mov_b32 v204, v194
    v_mov_b32 v205, v195
    v_mov_b32 v206, v196
    v_mov_b32 v207, v197
    v_mfma_f32_16x16x32_bf16 a[40:43], a[244:247], v[160:163], a[40:43]
    v_permlane32_swap_b32 v202, v192
    v_permlane32_swap_b32 v203, v193
    v_permlane32_swap_b32 v204, v194
    v_permlane32_swap_b32 v205, v195
    v_permlane32_swap_b32 v206, v196
    v_permlane32_swap_b32 v207, v197
    v_mfma_f32_16x16x32_bf16 a[44:47], a[244:247], v[164:167], a[44:47]
    v_add_f32 v192, v192, v202
    v_add_f32 v193, v193, v203
    v_add_f32 v194, v194, v204
    v_add_f32 v195, v195, v205
    v_add_f32 v196, v196, v206
    v_add_f32 v197, v197, v207
    v_mfma_f32_16x16x32_bf16 a[60:63], a[248:251], v[156:159], a[60:63]
    ds_write_b32 v216, v168 offset:0
    ds_write_b32 v216, v192 offset:384
    ds_write_b32 v216, v172 offset:64
    ds_write_b32 v216, v193 offset:448
    ds_write_b32 v216, v176 offset:128
    ds_write_b32 v216, v194 offset:512
    v_mfma_f32_16x16x32_bf16 a[64:67], a[248:251], v[160:163], a[64:67]
    ds_write_b32 v216, v180 offset:192
    ds_write_b32 v216, v195 offset:576
    ds_write_b32 v216, v184 offset:256
    ds_write_b32 v216, v196 offset:640
    ds_write_b32 v216, v188 offset:320
    ds_write_b32 v216, v197 offset:704
    v_mfma_f32_16x16x32_bf16 a[68:71], a[248:251], v[164:167], a[68:71]
    s_waitcnt lgkmcnt(0)
    s_barrier
    ds_read_b32 v224, v217 offset:0
    ds_read_b32 v230, v217 offset:384
    ds_read_b32 v225, v217 offset:64
    ds_read_b32 v231, v217 offset:448
    v_mfma_f32_16x16x32_bf16 a[84:87], a[252:255], v[156:159], a[84:87]
    ds_read_b32 v226, v217 offset:128
    ds_read_b32 v232, v217 offset:512
    ds_read_b32 v227, v217 offset:192
    ds_read_b32 v233, v217 offset:576
    ds_read_b32 v228, v217 offset:256
    ds_read_b32 v234, v217 offset:640
    v_mfma_f32_16x16x32_bf16 a[88:91], a[252:255], v[160:163], a[88:91]
    ds_read_b32 v229, v217 offset:320
    ds_read_b32 v235, v217 offset:704
    ds_write_b128 v215, a[0:3] offset:0
    ds_write_b128 v215, a[4:7] offset:1024
    ds_write_b128 v215, a[8:11] offset:2048
    ds_write_b128 v215, a[24:27] offset:6144
    v_mfma_f32_16x16x32_bf16 a[92:95], a[252:255], v[164:167], a[92:95]
    ds_write_b128 v215, a[28:31] offset:7168
    ds_write_b128 v215, a[32:35] offset:8192
    ds_write_b128 v215, a[48:51] offset:12288
    ds_write_b128 v215, a[52:55] offset:13312
    ds_write_b128 v215, a[56:59] offset:14336
    ds_write_b128 v215, a[72:75] offset:18432
    v_mfma_f32_16x16x32_bf16 v[12:15], a[224:227], v[156:159], v[12:15]
    ds_write_b128 v215, a[76:79] offset:19456
    ds_write_b128 v215, a[80:83] offset:20480
    s_waitcnt lgkmcnt(12)
    v_min_f32 v202, v168, v224
    v_min_f32 v203, v172, v225
    v_min_f32 v204, v176, v226
    v_mfma_f32_16x16x32_bf16 v[16:19], a[224:227], v[160:163], v[16:19]
    v_min_f32 v205, v180, v227
    v_min_f32 v206, v184, v228
    v_min_f32 v207, v188, v229
    v_sub_f32 v236, v202, v168
    v_sub_f32 v237, v203, v172
    v_sub_f32 v238, v204, v176
    v_mfma_f32_16x16x32_bf16 v[20:23], a[224:227], v[164:167], v[20:23]
    v_sub_f32 v239, v205, v180
    v_sub_f32 v240, v206, v184
    v_sub_f32 v241, v207, v188
    v_sub_f32 v244, v202, v224
    v_sub_f32 v245, v203, v225
    v_sub_f32 v246, v204, v226
    v_mfma_f32_16x16x32_bf16 v[36:39], a[228:231], v[156:159], v[36:39]
    v_sub_f32 v247, v205, v227
    v_sub_f32 v248, v206, v228
    v_sub_f32 v249, v207, v229
    v_exp_f32 v236, v236
    v_exp_f32 v237, v237
    v_exp_f32 v238, v238
    v_mfma_f32_16x16x32_bf16 v[40:43], a[228:231], v[160:163], v[40:43]
    v_exp_f32 v239, v239
    v_exp_f32 v240, v240
    v_exp_f32 v241, v241
    v_exp_f32 v244, v244
    v_exp_f32 v245, v245
    v_exp_f32 v246, v246
    v_mfma_f32_16x16x32_bf16 v[44:47], a[228:231], v[164:167], v[44:47]
    v_exp_f32 v247, v247
    v_exp_f32 v248, v248
    v_exp_f32 v249, v249
    v_mul_f32 v202, v192, v236
    v_mul_f32 v203, v193, v237
    v_mul_f32 v204, v194, v238
    v_mfma_f32_16x16x32_bf16 v[60:63], a[232:235], v[156:159], v[60:63]
    v_mul_f32 v205, v195, v239
    v_mul_f32 v206, v196, v240
    v_mul_f32 v207, v197, v241
    v_fma_f32 v202, v230, v244, v202
    v_fma_f32 v203, v231, v245, v203
    v_fma_f32 v204, v232, v246, v204
    v_mfma_f32_16x16x32_bf16 v[64:67], a[232:235], v[160:163], v[64:67]
    v_fma_f32 v205, v233, v247, v205
    v_fma_f32 v206, v234, v248, v206
    v_fma_f32 v207, v235, v249, v207
    v_rcp_f32 v202, v202
    v_rcp_f32 v203, v203
    v_rcp_f32 v204, v204
    v_mfma_f32_16x16x32_bf16 v[68:71], a[232:235], v[164:167], v[68:71]
    v_rcp_f32 v205, v205
    v_rcp_f32 v206, v206
    v_rcp_f32 v207, v207
    v_mul_f32 v236, v236, v202
    v_mul_f32 v237, v237, v203
    v_mul_f32 v238, v238, v204
    v_mfma_f32_16x16x32_bf16 v[84:87], a[236:239], v[156:159], v[84:87]
    v_mul_f32 v239, v239, v205
    v_mul_f32 v240, v240, v206
    v_mul_f32 v241, v241, v207
    v_mul_f32 v244, v244, v202
    v_mul_f32 v245, v245, v203
    v_mul_f32 v246, v246, v204
    v_mfma_f32_16x16x32_bf16 v[88:91], a[236:239], v[160:163], v[88:91]
    v_mul_f32 v247, v247, v205
    v_mul_f32 v248, v248, v206
    v_mul_f32 v249, v249, v207
    ds_write_b128 v215, a[12:15] offset:3072
    ds_write_b128 v215, a[16:19] offset:4096
    ds_write_b128 v215, a[20:23] offset:5120
    v_mfma_f32_16x16x32_bf16 v[92:95], a[236:239], v[164:167], v[92:95]
    ds_write_b128 v215, a[36:39] offset:9216
    ds_write_b128 v215, a[40:43] offset:10240
    ds_write_b128 v215, a[44:47] offset:11264
    ds_write_b128 v215, a[60:63] offset:15360
    ds_write_b128 v215, a[64:67] offset:16384
    ds_write_b128 v215, a[68:71] offset:17408
    ds_write_b128 v215, a[84:87] offset:21504
    ds_write_b128 v215, a[88:91] offset:22528
    ds_write_b128 v215, a[92:95] offset:23552
    v_pk_mul_f32 v[0:1], v[0:1], v[236:237] op_sel:[0,0] op_sel_hi:[1,0]
    v_pk_mul_f32 v[2:3], v[2:3], v[236:237] op_sel:[0,0] op_sel_hi:[1,0]
    v_pk_mul_f32 v[24:25], v[24:25], v[236:237] op_sel:[0,0] op_sel_hi:[1,0]
    v_pk_mul_f32 v[26:27], v[26:27], v[236:237] op_sel:[0,0] op_sel_hi:[1,0]
    v_pk_mul_f32 v[48:49], v[48:49], v[236:237] op_sel:[0,0] op_sel_hi:[1,0]
    v_pk_mul_f32 v[50:51], v[50:51], v[236:237] op_sel:[0,0] op_sel_hi:[1,0]
    v_pk_mul_f32 v[72:73], v[72:73], v[236:237] op_sel:[0,0] op_sel_hi:[1,0]
    v_pk_mul_f32 v[74:75], v[74:75], v[236:237] op_sel:[0,0] op_sel_hi:[1,0]
    v_pk_mul_f32 v[4:5], v[4:5], v[236:237] op_sel:[0,1] op_sel_hi:[1,1]
    v_pk_mul_f32 v[6:7], v[6:7], v[236:237] op_sel:[0,1] op_sel_hi:[1,1]
    v_pk_mul_f32 v[28:29], v[28:29], v[236:237] op_sel:[0,1] op_sel_hi:[1,1]
    v_pk_mul_f32 v[30:31], v[30:31], v[236:237] op_sel:[0,1] op_sel_hi:[1,1]
    v_pk_mul_f32 v[52:53], v[52:53], v[236:237] op_sel:[0,1] op_sel_hi:[1,1]
    v_pk_mul_f32 v[54:55], v[54:55], v[236:237] op_sel:[0,1] op_sel_hi:[1,1]
    v_pk_mul_f32 v[76:77], v[76:77], v[236:237] op_sel:[0,1] op_sel_hi:[1,1]
    v_pk_mul_f32 v[78:79], v[78:79], v[236:237] op_sel:[0,1] op_sel_hi:[1,1]
    v_pk_mul_f32 v[8:9], v[8:9], v[238:239] op_sel:[0,0] op_sel_hi:[1,0]
    v_pk_mul_f32 v[10:11], v[10:11], v[238:239] op_sel:[0,0] op_sel_hi:[1,0]
    v_pk_mul_f32 v[32:33], v[32:33], v[238:239] op_sel:[0,0] op_sel_hi:[1,0]
    v_pk_mul_f32 v[34:35], v[34:35], v[238:239] op_sel:[0,0] op_sel_hi:[1,0]
    v_pk_mul_f32 v[56:57], v[56:57], v[238:239] op_sel:[0,0] op_sel_hi:[1,0]
    v_pk_mul_f32 v[58:59], v[58:59], v[238:239] op_sel:[0,0] op_sel_hi:[1,0]
    v_pk_mul_f32 v[80:81], v[80:81], v[238:239] op_sel:[0,0] op_sel_hi:[1,0]
    v_pk_mul_f32 v[82:83], v[82:83], v[238:239] op_sel:[0,0] op_sel_hi:[1,0]
    v_pk_mul_f32 v[12:13], v[12:13], v[238:239] op_sel:[0,1] op_sel_hi:[1,1]
    v_pk_mul_f32 v[14:15], v[14:15], v[238:239] op_sel:[0,1] op_sel_hi:[1,1]
    v_pk_mul_f32 v[36:37], v[36:37], v[238:239] op_sel:[0,1] op_sel_hi:[1,1]
    v_pk_mul_f32 v[38:39], v[38:39], v[238:239] op_sel:[0,1] op_sel_hi:[1,1]
    v_pk_mul_f32 v[60:61], v[60:61], v[238:239] op_sel:[0,1] op_sel_hi:[1,1]
    v_pk_mul_f32 v[62:63], v[62:63], v[238:239] op_sel:[0,1] op_sel_hi:[1,1]
    v_pk_mul_f32 v[84:85], v[84:85], v[238:239] op_sel:[0,1] op_sel_hi:[1,1]
    v_pk_mul_f32 v[86:87], v[86:87], v[238:239] op_sel:[0,1] op_sel_hi:[1,1]
    v_pk_mul_f32 v[16:17], v[16:17], v[240:241] op_sel:[0,0] op_sel_hi:[1,0]
    v_pk_mul_f32 v[18:19], v[18:19], v[240:241] op_sel:[0,0] op_sel_hi:[1,0]
    v_pk_mul_f32 v[40:41], v[40:41], v[240:241] op_sel:[0,0] op_sel_hi:[1,0]
    v_pk_mul_f32 v[42:43], v[42:43], v[240:241] op_sel:[0,0] op_sel_hi:[1,0]
    v_pk_mul_f32 v[64:65], v[64:65], v[240:241] op_sel:[0,0] op_sel_hi:[1,0]
    v_pk_mul_f32 v[66:67], v[66:67], v[240:241] op_sel:[0,0] op_sel_hi:[1,0]
    v_pk_mul_f32 v[88:89], v[88:89], v[240:241] op_sel:[0,0] op_sel_hi:[1,0]
    v_pk_mul_f32 v[90:91], v[90:91], v[240:241] op_sel:[0,0] op_sel_hi:[1,0]
    v_pk_mul_f32 v[20:21], v[20:21], v[240:241] op_sel:[0,1] op_sel_hi:[1,1]
    v_pk_mul_f32 v[22:23], v[22:23], v[240:241] op_sel:[0,1] op_sel_hi:[1,1]
    v_pk_mul_f32 v[44:45], v[44:45], v[240:241] op_sel:[0,1] op_sel_hi:[1,1]
    v_pk_mul_f32 v[46:47], v[46:47], v[240:241] op_sel:[0,1] op_sel_hi:[1,1]
    v_pk_mul_f32 v[68:69], v[68:69], v[240:241] op_sel:[0,1] op_sel_hi:[1,1]
    v_pk_mul_f32 v[70:71], v[70:71], v[240:241] op_sel:[0,1] op_sel_hi:[1,1]
    v_pk_mul_f32 v[92:93], v[92:93], v[240:241] op_sel:[0,1] op_sel_hi:[1,1]
    v_pk_mul_f32 v[94:95], v[94:95], v[240:241] op_sel:[0,1] op_sel_hi:[1,1]
    s_waitcnt lgkmcnt(0)
    s_barrier
    ds_read_b128 v[96:99], v218 offset:0
    ds_read_b128 v[120:123], v218 offset:6144
    ds_read_b128 v[100:103], v218 offset:1024
    ds_read_b128 v[124:127], v218 offset:7168
    ds_read_b128 v[104:107], v218 offset:2048
    ds_read_b128 v[128:131], v218 offset:8192
    ds_read_b128 v[108:111], v218 offset:3072
    ds_read_b128 v[132:135], v218 offset:9216
    ds_read_b128 v[112:115], v218 offset:4096
    ds_read_b128 v[136:139], v218 offset:10240
    ds_read_b128 v[116:119], v218 offset:5120
    ds_read_b128 v[140:143], v218 offset:11264
    ds_read_b128 v[144:147], v218 offset:12288
    ds_read_b128 v[168:171], v218 offset:18432
    ds_read_b128 v[148:151], v218 offset:13312
    ds_read_b128 v[172:175], v218 offset:19456
    ds_read_b128 v[152:155], v218 offset:14336
    ds_read_b128 v[176:179], v218 offset:20480
    ds_read_b128 v[156:159], v218 offset:15360
    ds_read_b128 v[180:183], v218 offset:21504
    ds_read_b128 v[160:163], v218 offset:16384
    ds_read_b128 v[184:187], v218 offset:22528
    ds_read_b128 v[164:167], v218 offset:17408
    ds_read_b128 v[188:191], v218 offset:23552
    s_cmp_ge_u32 s38, 30
    s_cbranch_scc1 L1_noearly
    s_add_u32 s3, s49, 0
    s_add_u32 m0, s51, 0
    s_nop 0
    buffer_load_dwordx4 v250, s[92:95], s3 offen lds
    s_add_u32 m0, m0, 1024
    s_add_u32 s3, s3, 10240
    buffer_load_dwordx4 v250, s[92:95], s3 offen lds
    s_add_u32 m0, m0, 1024
    s_add_u32 s3, s3, 10240
    buffer_load_dwordx4 v250, s[92:95], s3 offen lds
    s_add_u32 m0, m0, 1024
    s_add_u32 s3, s3, 10240
    buffer_load_dwordx4 v250, s[92:95], s3 offen lds
    s_add_u32 s3, s49, 163840
    s_add_u32 m0, s51, 4096
    s_nop 0
    buffer_load_dwordx4 v250, s[92:95], s3 offen lds
    s_add_u32 m0, m0, 1024
    s_add_u32 s3, s3, 10240
    buffer_load_dwordx4 v250, s[92:95], s3 offen lds
    s_add_u32 m0, m0, 1024
    s_add_u32 s3, s3, 10240
    buffer_load_dwordx4 v250, s[92:95], s3 offen lds
    s_add_u32 m0, m0, 1024
    s_add_u32 s3, s3, 10240
    buffer_load_dwordx4 v250, s[92:95], s3 offen lds
    s_add_u32 s3, s49, 327680
    s_add_u32 m0, s51, 8192
    s_nop 0
    buffer_load_dwordx4 v250, s[92:95], s3 offen lds
    s_add_u32 m0, m0, 1024
    s_add_u32 s3, s3, 10240
    buffer_load_dwordx4 v250, s[92:95], s3 offen lds
    s_add_u32 m0, m0, 1024
    s_add_u32 s3, s3, 10240
    buffer_load_dwordx4 v250, s[92:95], s3 offen lds
    s_add_u32 m0, m0, 1024
    s_add_u32 s3, s3, 10240
    buffer_load_dwordx4 v250, s[92:95], s3 offen lds
    L1_noearly:
    s_waitcnt lgkmcnt(15)
    v_pk_fma_f32 v[0:1], v[96:97], v[244:245], v[0:1] op_sel:[0,0,0] op_sel_hi:[1,0,1]
    v_pk_fma_f32 v[2:3], v[98:99], v[244:245], v[2:3] op_sel:[0,0,0] op_sel_hi:[1,0,1]
    v_pk_fma_f32 v[24:25], v[120:121], v[244:245], v[24:25] op_sel:[0,0,0] op_sel_hi:[1,0,1]
    v_pk_fma_f32 v[26:27], v[122:123], v[244:245], v[26:27] op_sel:[0,0,0] op_sel_hi:[1,0,1]
    v_cvt_pk_bf16_f32 v96, v0, v1
    v_cvt_pk_bf16_f32 v97, v2, v3
    v_cvt_pk_bf16_f32 v98, v24, v25
    v_cvt_pk_bf16_f32 v99, v26, v27
    s_mov_b32 s3, 0
    buffer_store_dwordx4 v[96:99], v214, s[24:27], s3 offen offset:0 sc1
    s_waitcnt lgkmcnt(15)
    v_pk_fma_f32 v[4:5], v[100:101], v[244:245], v[4:5] op_sel:[0,1,0] op_sel_hi:[1,1,1]
    v_pk_fma_f32 v[6:7], v[102:103], v[244:245], v[6:7] op_sel:[0,1,0] op_sel_hi:[1,1,1]
    v_pk_fma_f32 v[28:29], v[124:125], v[244:245], v[28:29] op_sel:[0,1,0] op_sel_hi:[1,1,1]
    v_pk_fma_f32 v[30:31], v[126:127], v[244:245], v[30:31] op_sel:[0,1,0] op_sel_hi:[1,1,1]
    v_cvt_pk_bf16_f32 v100, v4, v5
    v_cvt_pk_bf16_f32 v101, v6, v7
    v_cvt_pk_bf16_f32 v102, v28, v29
    v_cvt_pk_bf16_f32 v103, v30, v31
    s_mov_b32 s3, 131072
    buffer_store_dwordx4 v[100:103], v214, s[24:27], s3 offen offset:0 sc1
    s_waitcnt lgkmcnt(15)
    v_pk_fma_f32 v[8:9], v[104:105], v[246:247], v[8:9] op_sel:[0,0,0] op_sel_hi:[1,0,1]
    v_pk_fma_f32 v[10:11], v[106:107], v[246:247], v[10:11] op_sel:[0,0,0] op_sel_hi:[1,0,1]
    v_pk_fma_f32 v[32:33], v[128:129], v[246:247], v[32:33] op_sel:[0,0,0] op_sel_hi:[1,0,1]
    v_pk_fma_f32 v[34:35], v[130:131], v[246:247], v[34:35] op_sel:[0,0,0] op_sel_hi:[1,0,1]
    v_cvt_pk_bf16_f32 v104, v8, v9
    v_cvt_pk_bf16_f32 v105, v10, v11
    v_cvt_pk_bf16_f32 v106, v32, v33
    v_cvt_pk_bf16_f32 v107, v34, v35
    s_mov_b32 s3, 262144
    buffer_store_dwordx4 v[104:107], v214, s[24:27], s3 offen offset:0 sc1
    s_waitcnt lgkmcnt(15)
    v_pk_fma_f32 v[12:13], v[108:109], v[246:247], v[12:13] op_sel:[0,1,0] op_sel_hi:[1,1,1]
    v_pk_fma_f32 v[14:15], v[110:111], v[246:247], v[14:15] op_sel:[0,1,0] op_sel_hi:[1,1,1]
    v_pk_fma_f32 v[36:37], v[132:133], v[246:247], v[36:37] op_sel:[0,1,0] op_sel_hi:[1,1,1]
    v_pk_fma_f32 v[38:39], v[134:135], v[246:247], v[38:39] op_sel:[0,1,0] op_sel_hi:[1,1,1]
    v_cvt_pk_bf16_f32 v108, v12, v13
    v_cvt_pk_bf16_f32 v109, v14, v15
    v_cvt_pk_bf16_f32 v110, v36, v37
    v_cvt_pk_bf16_f32 v111, v38, v39
    s_mov_b32 s3, 393216
    buffer_store_dwordx4 v[108:111], v214, s[24:27], s3 offen offset:0 sc1
    s_waitcnt lgkmcnt(14)
    v_pk_fma_f32 v[16:17], v[112:113], v[248:249], v[16:17] op_sel:[0,0,0] op_sel_hi:[1,0,1]
    v_pk_fma_f32 v[18:19], v[114:115], v[248:249], v[18:19] op_sel:[0,0,0] op_sel_hi:[1,0,1]
    v_pk_fma_f32 v[40:41], v[136:137], v[248:249], v[40:41] op_sel:[0,0,0] op_sel_hi:[1,0,1]
    v_pk_fma_f32 v[42:43], v[138:139], v[248:249], v[42:43] op_sel:[0,0,0] op_sel_hi:[1,0,1]
    v_cvt_pk_bf16_f32 v112, v16, v17
    v_cvt_pk_bf16_f32 v113, v18, v19
    v_cvt_pk_bf16_f32 v114, v40, v41
    v_cvt_pk_bf16_f32 v115, v42, v43
    s_mov_b32 s3, 524288
    buffer_store_dwordx4 v[112:115], v214, s[24:27], s3 offen offset:0 sc1
    s_waitcnt lgkmcnt(12)
    v_pk_fma_f32 v[20:21], v[116:117], v[248:249], v[20:21] op_sel:[0,1,0] op_sel_hi:[1,1,1]
    v_pk_fma_f32 v[22:23], v[118:119], v[248:249], v[22:23] op_sel:[0,1,0] op_sel_hi:[1,1,1]
    v_pk_fma_f32 v[44:45], v[140:141], v[248:249], v[44:45] op_sel:[0,1,0] op_sel_hi:[1,1,1]
    v_pk_fma_f32 v[46:47], v[142:143], v[248:249], v[46:47] op_sel:[0,1,0] op_sel_hi:[1,1,1]
    v_cvt_pk_bf16_f32 v116, v20, v21
    v_cvt_pk_bf16_f32 v117, v22, v23
    v_cvt_pk_bf16_f32 v118, v44, v45
    v_cvt_pk_bf16_f32 v119, v46, v47
    s_mov_b32 s3, 655360
    buffer_store_dwordx4 v[116:119], v214, s[24:27], s3 offen offset:0 sc1
    s_waitcnt lgkmcnt(10)
    v_pk_fma_f32 v[48:49], v[144:145], v[244:245], v[48:49] op_sel:[0,0,0] op_sel_hi:[1,0,1]
    v_pk_fma_f32 v[50:51], v[146:147], v[244:245], v[50:51] op_sel:[0,0,0] op_sel_hi:[1,0,1]
    v_pk_fma_f32 v[72:73], v[168:169], v[244:245], v[72:73] op_sel:[0,0,0] op_sel_hi:[1,0,1]
    v_pk_fma_f32 v[74:75], v[170:171], v[244:245], v[74:75] op_sel:[0,0,0] op_sel_hi:[1,0,1]
    v_cvt_pk_bf16_f32 v144, v48, v49
    v_cvt_pk_bf16_f32 v145, v50, v51
    v_cvt_pk_bf16_f32 v146, v72, v73
    v_cvt_pk_bf16_f32 v147, v74, v75
    s_mov_b32 s3, 0
    buffer_store_dwordx4 v[144:147], v214, s[24:27], s3 offen offset:1024 sc1
    s_waitcnt lgkmcnt(8)
    v_pk_fma_f32 v[52:53], v[148:149], v[244:245], v[52:53] op_sel:[0,1,0] op_sel_hi:[1,1,1]
    v_pk_fma_f32 v[54:55], v[150:151], v[244:245], v[54:55] op_sel:[0,1,0] op_sel_hi:[1,1,1]
    v_pk_fma_f32 v[76:77], v[172:173], v[244:245], v[76:77] op_sel:[0,1,0] op_sel_hi:[1,1,1]
    v_pk_fma_f32 v[78:79], v[174:175], v[244:245], v[78:79] op_sel:[0,1,0] op_sel_hi:[1,1,1]
    v_cvt_pk_bf16_f32 v148, v52, v53
    v_cvt_pk_bf16_f32 v149, v54, v55
    v_cvt_pk_bf16_f32 v150, v76, v77
    v_cvt_pk_bf16_f32 v151, v78, v79
    s_mov_b32 s3, 131072
    buffer_store_dwordx4 v[148:151], v214, s[24:27], s3 offen offset:1024 sc1
    s_waitcnt lgkmcnt(6)
    v_pk_fma_f32 v[56:57], v[152:153], v[246:247], v[56:57] op_sel:[0,0,0] op_sel_hi:[1,0,1]
    v_pk_fma_f32 v[58:59], v[154:155], v[246:247], v[58:59] op_sel:[0,0,0] op_sel_hi:[1,0,1]
    v_pk_fma_f32 v[80:81], v[176:177], v[246:247], v[80:81] op_sel:[0,0,0] op_sel_hi:[1,0,1]
    v_pk_fma_f32 v[82:83], v[178:179], v[246:247], v[82:83] op_sel:[0,0,0] op_sel_hi:[1,0,1]
    v_cvt_pk_bf16_f32 v152, v56, v57
    v_cvt_pk_bf16_f32 v153, v58, v59
    v_cvt_pk_bf16_f32 v154, v80, v81
    v_cvt_pk_bf16_f32 v155, v82, v83
    s_mov_b32 s3, 262144
    buffer_store_dwordx4 v[152:155], v214, s[24:27], s3 offen offset:1024 sc1
    s_waitcnt lgkmcnt(4)
    v_pk_fma_f32 v[60:61], v[156:157], v[246:247], v[60:61] op_sel:[0,1,0] op_sel_hi:[1,1,1]
    v_pk_fma_f32 v[62:63], v[158:159], v[246:247], v[62:63] op_sel:[0,1,0] op_sel_hi:[1,1,1]
    v_pk_fma_f32 v[84:85], v[180:181], v[246:247], v[84:85] op_sel:[0,1,0] op_sel_hi:[1,1,1]
    v_pk_fma_f32 v[86:87], v[182:183], v[246:247], v[86:87] op_sel:[0,1,0] op_sel_hi:[1,1,1]
    v_cvt_pk_bf16_f32 v156, v60, v61
    v_cvt_pk_bf16_f32 v157, v62, v63
    v_cvt_pk_bf16_f32 v158, v84, v85
    v_cvt_pk_bf16_f32 v159, v86, v87
    s_mov_b32 s3, 393216
    buffer_store_dwordx4 v[156:159], v214, s[24:27], s3 offen offset:1024 sc1
    s_waitcnt lgkmcnt(2)
    v_pk_fma_f32 v[64:65], v[160:161], v[248:249], v[64:65] op_sel:[0,0,0] op_sel_hi:[1,0,1]
    v_pk_fma_f32 v[66:67], v[162:163], v[248:249], v[66:67] op_sel:[0,0,0] op_sel_hi:[1,0,1]
    v_pk_fma_f32 v[88:89], v[184:185], v[248:249], v[88:89] op_sel:[0,0,0] op_sel_hi:[1,0,1]
    v_pk_fma_f32 v[90:91], v[186:187], v[248:249], v[90:91] op_sel:[0,0,0] op_sel_hi:[1,0,1]
    v_cvt_pk_bf16_f32 v160, v64, v65
    v_cvt_pk_bf16_f32 v161, v66, v67
    v_cvt_pk_bf16_f32 v162, v88, v89
    v_cvt_pk_bf16_f32 v163, v90, v91
    s_mov_b32 s3, 524288
    buffer_store_dwordx4 v[160:163], v214, s[24:27], s3 offen offset:1024 sc1
    s_waitcnt lgkmcnt(0)
    v_pk_fma_f32 v[68:69], v[164:165], v[248:249], v[68:69] op_sel:[0,1,0] op_sel_hi:[1,1,1]
    v_pk_fma_f32 v[70:71], v[166:167], v[248:249], v[70:71] op_sel:[0,1,0] op_sel_hi:[1,1,1]
    v_pk_fma_f32 v[92:93], v[188:189], v[248:249], v[92:93] op_sel:[0,1,0] op_sel_hi:[1,1,1]
    v_pk_fma_f32 v[94:95], v[190:191], v[248:249], v[94:95] op_sel:[0,1,0] op_sel_hi:[1,1,1]
    v_cvt_pk_bf16_f32 v164, v68, v69
    v_cvt_pk_bf16_f32 v165, v70, v71
    v_cvt_pk_bf16_f32 v166, v92, v93
    v_cvt_pk_bf16_f32 v167, v94, v95
    s_mov_b32 s3, 655360
    buffer_store_dwordx4 v[164:167], v214, s[24:27], s3 offen offset:1024 sc1
    s_cmp_ge_u32 s38, 30
    s_cbranch_scc1 L1_notile
    s_add_u32 s3, s49, 491520
    s_add_u32 m0, s41, 0
    s_nop 0
    buffer_load_dwordx4 v250, s[92:95], s3 offen lds
    s_add_u32 m0, m0, 1024
    s_add_u32 s3, s3, 10240
    buffer_load_dwordx4 v250, s[92:95], s3 offen lds
    s_add_u32 m0, m0, 1024
    s_add_u32 s3, s3, 10240
    buffer_load_dwordx4 v250, s[92:95], s3 offen lds
    s_add_u32 m0, m0, 1024
    s_add_u32 s3, s3, 10240
    buffer_load_dwordx4 v250, s[92:95], s3 offen lds
    s_add_u32 s3, s49, 655360
    s_add_u32 m0, s41, 4096
    s_nop 0
    buffer_load_dwordx4 v250, s[92:95], s3 offen lds
    s_add_u32 m0, m0, 1024
    s_add_u32 s3, s3, 10240
    buffer_load_dwordx4 v250, s[92:95], s3 offen lds
    s_add_u32 m0, m0, 1024
    s_add_u32 s3, s3, 10240
    buffer_load_dwordx4 v250, s[92:95], s3 offen lds
    s_add_u32 m0, m0, 1024
    s_add_u32 s3, s3, 10240
    buffer_load_dwordx4 v250, s[92:95], s3 offen lds
    s_add_u32 s3, s49, 819200
    s_add_u32 m0, s41, 8192
    s_nop 0
    buffer_load_dwordx4 v250, s[92:95], s3 offen lds
    s_add_u32 m0, m0, 1024
    s_add_u32 s3, s3, 10240
    buffer_load_dwordx4 v250, s[92:95], s3 offen lds
    s_add_u32 m0, m0, 1024
    s_add_u32 s3, s3, 10240
    buffer_load_dwordx4 v250, s[92:95], s3 offen lds
    s_add_u32 m0, m0, 1024
    s_add_u32 s3, s3, 10240
    buffer_load_dwordx4 v250, s[92:95], s3 offen lds
    s_add_u32 s3, s49, 983040
    s_add_u32 m0, s41, 12288
    s_nop 0
    buffer_load_dwordx4 v250, s[92:95], s3 offen lds
    s_add_u32 m0, m0, 1024
    s_add_u32 s3, s3, 10240
    buffer_load_dwordx4 v250, s[92:95], s3 offen lds
    s_add_u32 m0, m0, 1024
    s_add_u32 s3, s3, 10240
    buffer_load_dwordx4 v250, s[92:95], s3 offen lds
    s_add_u32 m0, m0, 1024
    s_add_u32 s3, s3, 10240
    buffer_load_dwordx4 v250, s[92:95], s3 offen lds
    s_add_u32 s3, s49, 1146880
    s_add_u32 m0, s41, 16384
    s_nop 0
    buffer_load_dwordx4 v250, s[92:95], s3 offen lds
    s_add_u32 m0, m0, 1024
    s_add_u32 s3, s3, 10240
    buffer_load_dwordx4 v250, s[92:95], s3 offen lds
    s_add_u32 m0, m0, 1024
    s_add_u32 s3, s3, 10240
    buffer_load_dwordx4 v250, s[92:95], s3 offen lds
    s_add_u32 m0, m0, 1024
    s_add_u32 s3, s3, 10240
    buffer_load_dwordx4 v250, s[92:95], s3 offen lds
    s_add_u32 s3, s49, 1310720
    s_add_u32 m0, s41, 20480
    s_nop 0
    buffer_load_dwordx4 v250, s[92:95], s3 offen lds
    s_add_u32 m0, m0, 1024
    s_add_u32 s3, s3, 10240
    buffer_load_dwordx4 v250, s[92:95], s3 offen lds
    s_add_u32 m0, m0, 1024
    s_add_u32 s3, s3, 10240
    buffer_load_dwordx4 v250, s[92:95], s3 offen lds
    s_add_u32 m0, m0, 1024
    s_add_u32 s3, s3, 10240
    buffer_load_dwordx4 v250, s[92:95], s3 offen lds
    v_lshrrev_b32 v251, 2, v253
    v_lshlrev_b32 v227, 7, v251
    v_bfe_u32 v251, v251, 1, 2
    v_lshl_or_b32 v227, v251, 5, v227
    v_and_b32 v251, 3, v253
    v_lshl_or_b32 v227, v251, 3, v227
    v_xor_b32 v224, 32, v227
    v_xor_b32 v225, 64, v227
    v_xor_b32 v226, 96, v227
    v_add_u32 v228, s41, v227
    v_add_u32 v229, s41, v224
    v_add_u32 v230, s41, v225
    v_add_u32 v231, s41, v226
    v_add_u32 v232, s51, v227
    v_add_u32 v233, s51, v224
    v_add_u32 v234, s51, v225
    v_add_u32 v235, s51, v226
    s_lshl_b32 s3, s42, 19
    s_lshl_b32 s45, s32, 10
    s_add_u32 s3, s3, s45
    v_lshlrev_b32 v251, 4, v253
    v_add_u32 v224, s3, v251
    v_add_u32 v225, 0x20000, v224
    v_add_u32 v226, 0x40000, v224
    v_add_u32 v227, 0x60000, v224
    s_waitcnt vmcnt(44)
    ds_read_b64_tr_b16 a[0:1], v232 offset:0
    ds_read_b64_tr_b16 a[2:3], v232 offset:2048
    ds_read_b64_tr_b16 a[4:5], v233 offset:0
    ds_read_b64_tr_b16 a[6:7], v233 offset:2048
    ds_read_b64_tr_b16 a[8:9], v234 offset:0
    ds_read_b64_tr_b16 a[10:11], v234 offset:2048
    ds_read_b64_tr_b16 a[12:13], v235 offset:0
    ds_read_b64_tr_b16 a[14:15], v235 offset:2048
    s_waitcnt vmcnt(40)
    ds_read_b64_tr_b16 a[16:17], v232 offset:4096
    ds_read_b64_tr_b16 a[18:19], v232 offset:6144
    ds_read_b64_tr_b16 a[20:21], v233 offset:4096
    ds_read_b64_tr_b16 a[22:23], v233 offset:6144
    ds_read_b64_tr_b16 a[24:25], v234 offset:4096
    ds_read_b64_tr_b16 a[26:27], v234 offset:6144
    ds_read_b64_tr_b16 a[28:29], v235 offset:4096
    ds_read_b64_tr_b16 a[30:31], v235 offset:6144
    s_waitcnt lgkmcnt(8)
    s_add_u32 s3, s49, 1474560
    s_add_u32 m0, s51, 0
    s_nop 0
    buffer_load_dwordx4 v250, s[92:95], s3 offen lds
    s_add_u32 m0, m0, 1024
    s_add_u32 s3, s3, 10240
    buffer_load_dwordx4 v250, s[92:95], s3 offen lds
    s_add_u32 m0, m0, 1024
    s_add_u32 s3, s3, 10240
    buffer_load_dwordx4 v250, s[92:95], s3 offen lds
    s_add_u32 m0, m0, 1024
    s_add_u32 s3, s3, 10240
    buffer_load_dwordx4 v250, s[92:95], s3 offen lds
    s_waitcnt vmcnt(40)
    ds_read_b64_tr_b16 a[32:33], v232 offset:8192
    ds_read_b64_tr_b16 a[34:35], v232 offset:10240
    ds_read_b64_tr_b16 a[36:37], v233 offset:8192
    ds_read_b64_tr_b16 a[38:39], v233 offset:10240
    ds_read_b64_tr_b16 a[40:41], v234 offset:8192
    ds_read_b64_tr_b16 a[42:43], v234 offset:10240
    ds_read_b64_tr_b16 a[44:45], v235 offset:8192
    ds_read_b64_tr_b16 a[46:47], v235 offset:10240
    s_waitcnt lgkmcnt(8)
    s_add_u32 s3, s49, 1638400
    s_add_u32 m0, s51, 4096
    s_nop 0
    buffer_load_dwordx4 v250, s[92:95], s3 offen lds
    s_add_u32 m0, m0, 1024
    s_add_u32 s3, s3, 10240
    buffer_load_dwordx4 v250, s[92:95], s3 offen lds
    s_add_u32 m0, m0, 1024
    s_add_u32 s3, s3, 10240
    buffer_load_dwordx4 v250, s[92:95], s3 offen lds
    s_add_u32 m0, m0, 1024
    s_add_u32 s3, s3, 10240
    buffer_load_dwordx4 v250, s[92:95], s3 offen lds
    s_waitcnt vmcnt(0)
    s_barrier
    s_cmp_lg_u32 s32, 0
    s_cbranch_scc1 L_nosig_33
    s_lshl_b32 s3, s33, 5
    v_mov_b32 v254, s3
    v_mov_b32 v255, 1
    s_mov_b64 exec, 1
    global_atomic_add v254, v255, s[28:29] sc1
    s_mov_b64 exec, -1
    L_nosig_33:
    ds_read_b64_tr_b16 a[48:49], v228 offset:0
    ds_read_b64_tr_b16 a[50:51], v228 offset:2048
    ds_read_b64_tr_b16 a[52:53], v229 offset:0
    ds_read_b64_tr_b16 a[54:55], v229 offset:2048
    ds_read_b64_tr_b16 a[56:57], v230 offset:0
    ds_read_b64_tr_b16 a[58:59], v230 offset:2048
    ds_read_b64_tr_b16 a[60:61], v231 offset:0
    ds_read_b64_tr_b16 a[62:63], v231 offset:2048
    s_waitcnt lgkmcnt(8)
    s_add_u32 s3, s49, 1802240
    s_add_u32 m0, s51, 8192
    s_nop 0
    buffer_load_dwordx4 v250, s[92:95], s3 offen lds
    s_add_u32 m0, m0, 1024
    s_add_u32 s3, s3, 10240
    buffer_load_dwordx4 v250, s[92:95], s3 offen lds
    s_add_u32 m0, m0, 1024
    s_add_u32 s3, s3, 10240
    buffer_load_dwordx4 v250, s[92:95], s3 offen lds
    s_add_u32 m0, m0, 1024
    s_add_u32 s3, s3, 10240
    buffer_load_dwordx4 v250, s[92:95], s3 offen lds
    ds_read_b64_tr_b16 a[64:65], v228 offset:4096
    ds_read_b64_tr_b16 a[66:67], v228 offset:6144
    ds_read_b64_tr_b16 a[68:69], v229 offset:4096
    ds_read_b64_tr_b16 a[70:71], v229 offset:6144
    ds_read_b64_tr_b16 a[72:73], v230 offset:4096
    ds_read_b64_tr_b16 a[74:75], v230 offset:6144
    ds_read_b64_tr_b16 a[76:77], v231 offset:4096
    ds_read_b64_tr_b16 a[78:79], v231 offset:6144
    s_waitcnt lgkmcnt(8)
    s_add_u32 s3, s49, 1966080
    s_add_u32 m0, s41, 0
    s_nop 0
    buffer_load_dwordx4 v250, s[92:95], s3 offen lds
    s_add_u32 m0, m0, 1024
    s_add_u32 s3, s3, 10240
    buffer_load_dwordx4 v250, s[92:95], s3 offen lds
    s_add_u32 m0, m0, 1024
    s_add_u32 s3, s3, 10240
    buffer_load_dwordx4 v250, s[92:95], s3 offen lds
    s_add_u32 m0, m0, 1024
    s_add_u32 s3, s3, 10240
    buffer_load_dwordx4 v250, s[92:95], s3 offen lds
    ds_read_b64_tr_b16 a[80:81], v228 offset:8192
    ds_read_b64_tr_b16 a[82:83], v228 offset:10240
    ds_read_b64_tr_b16 a[84:85], v229 offset:8192
    ds_read_b64_tr_b16 a[86:87], v229 offset:10240
    ds_read_b64_tr_b16 a[88:89], v230 offset:8192
    ds_read_b64_tr_b16 a[90:91], v230 offset:10240
    ds_read_b64_tr_b16 a[92:93], v231 offset:8192
    ds_read_b64_tr_b16 a[94:95], v231 offset:10240
    s_waitcnt lgkmcnt(8)
    s_add_u32 s3, s49, 2129920
    s_add_u32 m0, s41, 4096
    s_nop 0
    buffer_load_dwordx4 v250, s[92:95], s3 offen lds
    s_add_u32 m0, m0, 1024
    s_add_u32 s3, s3, 10240
    buffer_load_dwordx4 v250, s[92:95], s3 offen lds
    s_add_u32 m0, m0, 1024
    s_add_u32 s3, s3, 10240
    buffer_load_dwordx4 v250, s[92:95], s3 offen lds
    s_add_u32 m0, m0, 1024
    s_add_u32 s3, s3, 10240
    buffer_load_dwordx4 v250, s[92:95], s3 offen lds
    ds_read_b64_tr_b16 a[96:97], v228 offset:12288
    ds_read_b64_tr_b16 a[98:99], v228 offset:14336
    ds_read_b64_tr_b16 a[100:101], v229 offset:12288
    ds_read_b64_tr_b16 a[102:103], v229 offset:14336
    ds_read_b64_tr_b16 a[104:105], v230 offset:12288
    ds_read_b64_tr_b16 a[106:107], v230 offset:14336
    ds_read_b64_tr_b16 a[108:109], v231 offset:12288
    ds_read_b64_tr_b16 a[110:111], v231 offset:14336
    s_waitcnt lgkmcnt(8)
    s_add_u32 s3, s49, 2293760
    s_add_u32 m0, s41, 8192
    s_nop 0
    buffer_load_dwordx4 v250, s[92:95], s3 offen lds
    s_add_u32 m0, m0, 1024
    s_add_u32 s3, s3, 10240
    buffer_load_dwordx4 v250, s[92:95], s3 offen lds
    s_add_u32 m0, m0, 1024
    s_add_u32 s3, s3, 10240
    buffer_load_dwordx4 v250, s[92:95], s3 offen lds
    s_add_u32 m0, m0, 1024
    s_add_u32 s3, s3, 10240
    buffer_load_dwordx4 v250, s[92:95], s3 offen lds
    ds_read_b64_tr_b16 a[112:113], v228 offset:16384
    ds_read_b64_tr_b16 a[114:115], v228 offset:18432
    ds_read_b64_tr_b16 a[116:117], v229 offset:16384
    ds_read_b64_tr_b16 a[118:119], v229 offset:18432
    ds_read_b64_tr_b16 a[120:121], v230 offset:16384
    ds_read_b64_tr_b16 a[122:123], v230 offset:18432
    ds_read_b64_tr_b16 a[124:125], v231 offset:16384
    ds_read_b64_tr_b16 a[126:127], v231 offset:18432
    s_waitcnt lgkmcnt(8)
    s_add_u32 s3, s49, 2457600
    s_add_u32 m0, s41, 12288
    s_nop 0
    buffer_load_dwordx4 v250, s[92:95], s3 offen lds
    s_add_u32 m0, m0, 1024
    s_add_u32 s3, s3, 10240
    buffer_load_dwordx4 v250, s[92:95], s3 offen lds
    s_add_u32 m0, m0, 1024
    s_add_u32 s3, s3, 10240
    buffer_load_dwordx4 v250, s[92:95], s3 offen lds
    s_add_u32 m0, m0, 1024
    s_add_u32 s3, s3, 10240
    buffer_load_dwordx4 v250, s[92:95], s3 offen lds
    ds_read_b64_tr_b16 a[128:129], v228 offset:20480
    ds_read_b64_tr_b16 a[130:131], v228 offset:22528
    ds_read_b64_tr_b16 a[132:133], v229 offset:20480
    ds_read_b64_tr_b16 a[134:135], v229 offset:22528
    ds_read_b64_tr_b16 a[136:137], v230 offset:20480
    ds_read_b64_tr_b16 a[138:139], v230 offset:22528
    ds_read_b64_tr_b16 a[140:141], v231 offset:20480
    ds_read_b64_tr_b16 a[142:143], v231 offset:22528
    s_waitcnt lgkmcnt(8)
    s_add_u32 s3, s49, 2621440
    s_add_u32 m0, s41, 16384
    s_nop 0
    buffer_load_dwordx4 v250, s[92:95], s3 offen lds
    s_add_u32 m0, m0, 1024
    s_add_u32 s3, s3, 10240
    buffer_load_dwordx4 v250, s[92:95], s3 offen lds
    s_add_u32 m0, m0, 1024
    s_add_u32 s3, s3, 10240
    buffer_load_dwordx4 v250, s[92:95], s3 offen lds
    s_add_u32 m0, m0, 1024
    s_add_u32 s3, s3, 10240
    buffer_load_dwordx4 v250, s[92:95], s3 offen lds
    ds_read_b64_tr_b16 a[144:145], v232 offset:0
    ds_read_b64_tr_b16 a[146:147], v232 offset:2048
    ds_read_b64_tr_b16 a[148:149], v233 offset:0
    ds_read_b64_tr_b16 a[150:151], v233 offset:2048
    ds_read_b64_tr_b16 a[152:153], v234 offset:0
    ds_read_b64_tr_b16 a[154:155], v234 offset:2048
    ds_read_b64_tr_b16 a[156:157], v235 offset:0
    ds_read_b64_tr_b16 a[158:159], v235 offset:2048
    s_waitcnt lgkmcnt(8)
    s_add_u32 s3, s49, 2785280
    s_add_u32 m0, s41, 20480
    s_nop 0
    buffer_load_dwordx4 v250, s[92:95], s3 offen lds
    s_add_u32 m0, m0, 1024
    s_add_u32 s3, s3, 10240
    buffer_load_dwordx4 v250, s[92:95], s3 offen lds
    s_add_u32 m0, m0, 1024
    s_add_u32 s3, s3, 10240
    buffer_load_dwordx4 v250, s[92:95], s3 offen lds
    s_add_u32 m0, m0, 1024
    s_add_u32 s3, s3, 10240
    buffer_load_dwordx4 v250, s[92:95], s3 offen lds
    ds_read_b64_tr_b16 a[160:161], v232 offset:4096
    ds_read_b64_tr_b16 a[162:163], v232 offset:6144
    ds_read_b64_tr_b16 a[164:165], v233 offset:4096
    ds_read_b64_tr_b16 a[166:167], v233 offset:6144
    ds_read_b64_tr_b16 a[168:169], v234 offset:4096
    ds_read_b64_tr_b16 a[170:171], v234 offset:6144
    ds_read_b64_tr_b16 a[172:173], v235 offset:4096
    ds_read_b64_tr_b16 a[174:175], v235 offset:6144
    s_waitcnt lgkmcnt(8)
    s_add_u32 s3, s49, 2949120
    s_add_u32 m0, s51, 0
    s_nop 0
    buffer_load_dwordx4 v250, s[92:95], s3 offen lds
    s_add_u32 m0, m0, 1024
    s_add_u32 s3, s3, 10240
    buffer_load_dwordx4 v250, s[92:95], s3 offen lds
    s_add_u32 m0, m0, 1024
    s_add_u32 s3, s3, 10240
    buffer_load_dwordx4 v250, s[92:95], s3 offen lds
    s_add_u32 m0, m0, 1024
    s_add_u32 s3, s3, 10240
    buffer_load_dwordx4 v250, s[92:95], s3 offen lds
    s_waitcnt vmcnt(28)
    ds_read_b64_tr_b16 a[176:177], v232 offset:8192
    ds_read_b64_tr_b16 a[178:179], v232 offset:10240
    ds_read_b64_tr_b16 a[180:181], v233 offset:8192
    ds_read_b64_tr_b16 a[182:183], v233 offset:10240
    ds_read_b64_tr_b16 a[184:185], v234 offset:8192
    ds_read_b64_tr_b16 a[186:187], v234 offset:10240
    ds_read_b64_tr_b16 a[188:189], v235 offset:8192
    ds_read_b64_tr_b16 a[190:191], v235 offset:10240
    s_waitcnt lgkmcnt(8)
    s_add_u32 s3, s49, 3112960
    s_add_u32 m0, s51, 4096
    s_nop 0
    buffer_load_dwordx4 v250, s[92:95], s3 offen lds
    s_add_u32 m0, m0, 1024
    s_add_u32 s3, s3, 10240
    buffer_load_dwordx4 v250, s[92:95], s3 offen lds
    s_add_u32 m0, m0, 1024
    s_add_u32 s3, s3, 10240
    buffer_load_dwordx4 v250, s[92:95], s3 offen lds
    s_add_u32 m0, m0, 1024
    s_add_u32 s3, s3, 10240
    buffer_load_dwordx4 v250, s[92:95], s3 offen lds
    s_waitcnt vmcnt(28)
    ds_read_b64_tr_b16 a[192:193], v228 offset:0
    ds_read_b64_tr_b16 a[194:195], v228 offset:2048
    ds_read_b64_tr_b16 a[196:197], v229 offset:0
    ds_read_b64_tr_b16 a[198:199], v229 offset:2048
    ds_read_b64_tr_b16 a[200:201], v230 offset:0
    ds_read_b64_tr_b16 a[202:203], v230 offset:2048
    ds_read_b64_tr_b16 a[204:205], v231 offset:0
    ds_read_b64_tr_b16 a[206:207], v231 offset:2048
    s_waitcnt lgkmcnt(8)
    s_add_u32 s3, s49, 3276800
    s_add_u32 m0, s51, 8192
    s_nop 0
    buffer_load_dwordx4 v250, s[92:95], s3 offen lds
    s_add_u32 m0, m0, 1024
    s_add_u32 s3, s3, 10240
    buffer_load_dwordx4 v250, s[92:95], s3 offen lds
    s_add_u32 m0, m0, 1024
    s_add_u32 s3, s3, 10240
    buffer_load_dwordx4 v250, s[92:95], s3 offen lds
    s_add_u32 m0, m0, 1024
    s_add_u32 s3, s3, 10240
    buffer_load_dwordx4 v250, s[92:95], s3 offen lds
    s_waitcnt vmcnt(28)
    ds_read_b64_tr_b16 a[208:209], v228 offset:4096
    ds_read_b64_tr_b16 a[210:211], v228 offset:6144
    ds_read_b64_tr_b16 a[212:213], v229 offset:4096
    ds_read_b64_tr_b16 a[214:215], v229 offset:6144
    ds_read_b64_tr_b16 a[216:217], v230 offset:4096
    ds_read_b64_tr_b16 a[218:219], v230 offset:6144
    ds_read_b64_tr_b16 a[220:221], v231 offset:4096
    ds_read_b64_tr_b16 a[222:223], v231 offset:6144
    s_waitcnt lgkmcnt(8)
    s_add_u32 s3, s49, 3440640
    s_add_u32 m0, s41, 0
    s_nop 0
    buffer_load_dwordx4 v250, s[92:95], s3 offen lds
    s_add_u32 m0, m0, 1024
    s_add_u32 s3, s3, 10240
    buffer_load_dwordx4 v250, s[92:95], s3 offen lds
    s_add_u32 m0, m0, 1024
    s_add_u32 s3, s3, 10240
    buffer_load_dwordx4 v250, s[92:95], s3 offen lds
    s_add_u32 m0, m0, 1024
    s_add_u32 s3, s3, 10240
    buffer_load_dwordx4 v250, s[92:95], s3 offen lds
    s_waitcnt vmcnt(28)
    ds_read_b64_tr_b16 a[224:225], v228 offset:8192
    ds_read_b64_tr_b16 a[226:227], v228 offset:10240
    ds_read_b64_tr_b16 a[228:229], v229 offset:8192
    ds_read_b64_tr_b16 a[230:231], v229 offset:10240
    ds_read_b64_tr_b16 a[232:233], v230 offset:8192
    ds_read_b64_tr_b16 a[234:235], v230 offset:10240
    ds_read_b64_tr_b16 a[236:237], v231 offset:8192
    ds_read_b64_tr_b16 a[238:239], v231 offset:10240
    s_waitcnt lgkmcnt(8)
    s_add_u32 s3, s49, 3604480
    s_add_u32 m0, s41, 4096
    s_nop 0
    buffer_load_dwordx4 v250, s[92:95], s3 offen lds
    s_add_u32 m0, m0, 1024
    s_add_u32 s3, s3, 10240
    buffer_load_dwordx4 v250, s[92:95], s3 offen lds
    s_add_u32 m0, m0, 1024
    s_add_u32 s3, s3, 10240
    buffer_load_dwordx4 v250, s[92:95], s3 offen lds
    s_add_u32 m0, m0, 1024
    s_add_u32 s3, s3, 10240
    buffer_load_dwordx4 v250, s[92:95], s3 offen lds
    s_waitcnt vmcnt(28)
    ds_read_b64_tr_b16 a[240:241], v228 offset:12288
    ds_read_b64_tr_b16 a[242:243], v228 offset:14336
    ds_read_b64_tr_b16 a[244:245], v229 offset:12288
    ds_read_b64_tr_b16 a[246:247], v229 offset:14336
    ds_read_b64_tr_b16 a[248:249], v230 offset:12288
    ds_read_b64_tr_b16 a[250:251], v230 offset:14336
    ds_read_b64_tr_b16 a[252:253], v231 offset:12288
    ds_read_b64_tr_b16 a[254:255], v231 offset:14336
    s_waitcnt lgkmcnt(8)
    s_add_u32 s3, s49, 3768320
    s_add_u32 m0, s41, 8192
    s_nop 0
    buffer_load_dwordx4 v250, s[92:95], s3 offen lds
    s_add_u32 m0, m0, 1024
    s_add_u32 s3, s3, 10240
    buffer_load_dwordx4 v250, s[92:95], s3 offen lds
    s_add_u32 m0, m0, 1024
    s_add_u32 s3, s3, 10240
    buffer_load_dwordx4 v250, s[92:95], s3 offen lds
    s_add_u32 m0, m0, 1024
    s_add_u32 s3, s3, 10240
    buffer_load_dwordx4 v250, s[92:95], s3 offen lds
    s_waitcnt vmcnt(28)
    ds_read_b64_tr_b16 v[160:161], v228 offset:16384
    ds_read_b64_tr_b16 v[162:163], v228 offset:18432
    ds_read_b64_tr_b16 v[164:165], v229 offset:16384
    ds_read_b64_tr_b16 v[166:167], v229 offset:18432
    ds_read_b64_tr_b16 v[168:169], v230 offset:16384
    ds_read_b64_tr_b16 v[170:171], v230 offset:18432
    ds_read_b64_tr_b16 v[172:173], v231 offset:16384
    ds_read_b64_tr_b16 v[174:175], v231 offset:18432
    s_waitcnt lgkmcnt(8)
    s_add_u32 s3, s49, 3932160
    s_add_u32 m0, s41, 12288
    s_nop 0
    buffer_load_dwordx4 v250, s[92:95], s3 offen lds
    s_add_u32 m0, m0, 1024
    s_add_u32 s3, s3, 10240
    buffer_load_dwordx4 v250, s[92:95], s3 offen lds
    s_add_u32 m0, m0, 1024
    s_add_u32 s3, s3, 10240
    buffer_load_dwordx4 v250, s[92:95], s3 offen lds
    s_add_u32 m0, m0, 1024
    s_add_u32 s3, s3, 10240
    buffer_load_dwordx4 v250, s[92:95], s3 offen lds
    s_cmp_lg_u32 s32, 0
    s_cbranch_scc1 L_nopoll_34
    s_lshl_b32 s3, s50, 5
    s_mov_b32 s47, 0
    v_mov_b32 v254, s3
    L_poll_35:
    global_load_dword v255, v254, s[28:29] sc1
    s_add_u32 s47, s47, 1
    s_waitcnt vmcnt(0)
    v_cmp_ne_u32 vcc, 32, v255
    s_cmp_gt_u32 s47, 0x40000
    s_cbranch_scc1 L_nopoll_34
    s_cbranch_vccz L_nopoll_34
    s_sleep 1
    s_branch L_poll_35
    L_nopoll_34:
    s_barrier
    s_mov_b32 s46, 0
    buffer_load_dwordx4 v[64:67], v224, s[24:27], s46 offen sc1
    buffer_load_dwordx4 v[68:71], v225, s[24:27], s46 offen sc1
    buffer_load_dwordx4 v[72:75], v226, s[24:27], s46 offen sc1
    buffer_load_dwordx4 v[76:79], v227, s[24:27], s46 offen sc1
    s_mov_b32 s46, 4096
    buffer_load_dwordx4 v[80:83], v224, s[24:27], s46 offen sc1
    buffer_load_dwordx4 v[84:87], v225, s[24:27], s46 offen sc1
    buffer_load_dwordx4 v[88:91], v226, s[24:27], s46 offen sc1
    buffer_load_dwordx4 v[92:95], v227, s[24:27], s46 offen sc1
    s_mov_b32 s46, 8192
    buffer_load_dwordx4 v[96:99], v224, s[24:27], s46 offen sc1
    buffer_load_dwordx4 v[100:103], v225, s[24:27], s46 offen sc1
    buffer_load_dwordx4 v[104:107], v226, s[24:27], s46 offen sc1
    buffer_load_dwordx4 v[108:111], v227, s[24:27], s46 offen sc1
    s_mov_b32 s46, 12288
    buffer_load_dwordx4 v[112:115], v224, s[24:27], s46 offen sc1
    buffer_load_dwordx4 v[116:119], v225, s[24:27], s46 offen sc1
    buffer_load_dwordx4 v[120:123], v226, s[24:27], s46 offen sc1
    buffer_load_dwordx4 v[124:127], v227, s[24:27], s46 offen sc1
    s_mov_b32 s46, 16384
    buffer_load_dwordx4 v[128:131], v224, s[24:27], s46 offen sc1
    buffer_load_dwordx4 v[132:135], v225, s[24:27], s46 offen sc1
    buffer_load_dwordx4 v[136:139], v226, s[24:27], s46 offen sc1
    buffer_load_dwordx4 v[140:143], v227, s[24:27], s46 offen sc1
    s_mov_b32 s46, 20480
    buffer_load_dwordx4 v[144:147], v224, s[24:27], s46 offen sc1
    buffer_load_dwordx4 v[148:151], v225, s[24:27], s46 offen sc1
    buffer_load_dwordx4 v[152:155], v226, s[24:27], s46 offen sc1
    buffer_load_dwordx4 v[156:159], v227, s[24:27], s46 offen sc1
    s_waitcnt vmcnt(52)
    ds_read_b64_tr_b16 v[176:177], v228 offset:20480
    ds_read_b64_tr_b16 v[178:179], v228 offset:22528
    ds_read_b64_tr_b16 v[180:181], v229 offset:20480
    ds_read_b64_tr_b16 v[182:183], v229 offset:22528
    ds_read_b64_tr_b16 v[184:185], v230 offset:20480
    ds_read_b64_tr_b16 v[186:187], v230 offset:22528
    ds_read_b64_tr_b16 v[188:189], v231 offset:20480
    ds_read_b64_tr_b16 v[190:191], v231 offset:22528
    s_waitcnt lgkmcnt(8)
    s_add_u32 s3, s49, 4096000
    s_add_u32 m0, s41, 16384
    s_nop 0
    buffer_load_dwordx4 v250, s[92:95], s3 offen lds
    s_add_u32 m0, m0, 1024
    s_add_u32 s3, s3, 10240
    buffer_load_dwordx4 v250, s[92:95], s3 offen lds
    s_add_u32 m0, m0, 1024
    s_add_u32 s3, s3, 10240
    buffer_load_dwordx4 v250, s[92:95], s3 offen lds
    s_add_u32 m0, m0, 1024
    s_add_u32 s3, s3, 10240
    buffer_load_dwordx4 v250, s[92:95], s3 offen lds
    s_waitcnt vmcnt(52)
    ds_read_b64_tr_b16 v[192:193], v232 offset:0
    ds_read_b64_tr_b16 v[194:195], v232 offset:2048
    ds_read_b64_tr_b16 v[196:197], v233 offset:0
    ds_read_b64_tr_b16 v[198:199], v233 offset:2048
    ds_read_b64_tr_b16 v[200:201], v234 offset:0
    ds_read_b64_tr_b16 v[202:203], v234 offset:2048
    ds_read_b64_tr_b16 v[204:205], v235 offset:0
    ds_read_b64_tr_b16 v[206:207], v235 offset:2048
    s_waitcnt lgkmcnt(8)
    s_add_u32 s3, s49, 4259840
    s_add_u32 m0, s41, 20480
    s_nop 0
    buffer_load_dwordx4 v250, s[92:95], s3 offen lds
    s_add_u32 m0, m0, 1024
    s_add_u32 s3, s3, 10240
    buffer_load_dwordx4 v250, s[92:95], s3 offen lds
    s_add_u32 m0, m0, 1024
    s_add_u32 s3, s3, 10240
    buffer_load_dwordx4 v250, s[92:95], s3 offen lds
    s_add_u32 m0, m0, 1024
    s_add_u32 s3, s3, 10240
    buffer_load_dwordx4 v250, s[92:95], s3 offen lds
    s_waitcnt vmcnt(52)
    ds_read_b64_tr_b16 v[208:209], v232 offset:4096
    ds_read_b64_tr_b16 v[210:211], v232 offset:6144
    ds_read_b64_tr_b16 v[212:213], v233 offset:4096
    ds_read_b64_tr_b16 v[214:215], v233 offset:6144
    ds_read_b64_tr_b16 v[216:217], v234 offset:4096
    ds_read_b64_tr_b16 v[218:219], v234 offset:6144
    ds_read_b64_tr_b16 v[220:221], v235 offset:4096
    ds_read_b64_tr_b16 v[222:223], v235 offset:6144
    s_waitcnt lgkmcnt(8)
    s_add_u32 s3, s49, 4423680
    s_add_u32 m0, s51, 0
    s_nop 0
    buffer_load_dwordx4 v250, s[92:95], s3 offen lds
    s_add_u32 m0, m0, 1024
    s_add_u32 s3, s3, 10240
    buffer_load_dwordx4 v250, s[92:95], s3 offen lds
    s_add_u32 m0, m0, 1024
    s_add_u32 s3, s3, 10240
    buffer_load_dwordx4 v250, s[92:95], s3 offen lds
    s_add_u32 m0, m0, 1024
    s_add_u32 s3, s3, 10240
    buffer_load_dwordx4 v250, s[92:95], s3 offen lds
    s_waitcnt lgkmcnt(0)
    s_add_u32 s3, s49, 4587520
    s_add_u32 m0, s51, 4096
    s_nop 0
    buffer_load_dwordx4 v250, s[92:95], s3 offen lds
    s_add_u32 m0, m0, 1024
    s_add_u32 s3, s3, 10240
    buffer_load_dwordx4 v250, s[92:95], s3 offen lds
    s_add_u32 m0, m0, 1024
    s_add_u32 s3, s3, 10240
    buffer_load_dwordx4 v250, s[92:95], s3 offen lds
    s_add_u32 m0, m0, 1024
    s_add_u32 s3, s3, 10240
    buffer_load_dwordx4 v250, s[92:95], s3 offen lds
    s_waitcnt vmcnt(36)
    v_mfma_f32_16x16x32_bf16 v[0:3], a[0:3], v[64:67], 0
    v_mfma_f32_16x16x32_bf16 v[4:7], a[0:3], v[68:71], 0
    v_mfma_f32_16x16x32_bf16 v[8:11], a[0:3], v[72:75], 0
    v_mfma_f32_16x16x32_bf16 v[12:15], a[0:3], v[76:79], 0
    v_mfma_f32_16x16x32_bf16 v[16:19], a[4:7], v[64:67], 0
    v_mfma_f32_16x16x32_bf16 v[20:23], a[4:7], v[68:71], 0
    v_mfma_f32_16x16x32_bf16 v[24:27], a[4:7], v[72:75], 0
    v_mfma_f32_16x16x32_bf16 v[28:31], a[4:7], v[76:79], 0
    v_mfma_f32_16x16x32_bf16 v[32:35], a[8:11], v[64:67], 0
    v_mfma_f32_16x16x32_bf16 v[36:39], a[8:11], v[68:71], 0
    v_mfma_f32_16x16x32_bf16 v[40:43], a[8:11], v[72:75], 0
    v_mfma_f32_16x16x32_bf16 v[44:47], a[8:11], v[76:79], 0
    v_mfma_f32_16x16x32_bf16 v[48:51], a[12:15], v[64:67], 0
    v_mfma_f32_16x16x32_bf16 v[52:55], a[12:15], v[68:71], 0
    v_mfma_f32_16x16x32_bf16 v[56:59], a[12:15], v[72:75], 0
    v_mfma_f32_16x16x32_bf16 v[60:63], a[12:15], v[76:79], 0
    s_waitcnt vmcnt(32)
    v_mfma_f32_16x16x32_bf16 v[0:3], a[16:19], v[80:83], v[0:3]
    s_mov_b32 s46, 24576
    v_mfma_f32_16x16x32_bf16 v[4:7], a[16:19], v[84:87], v[4:7]
    buffer_load_dwordx4 v[64:67], v224, s[24:27], s46 offen sc1
    v_mfma_f32_16x16x32_bf16 v[8:11], a[16:19], v[88:91], v[8:11]
    buffer_load_dwordx4 v[68:71], v225, s[24:27], s46 offen sc1
    v_mfma_f32_16x16x32_bf16 v[12:15], a[16:19], v[92:95], v[12:15]
    buffer_load_dwordx4 v[72:75], v226, s[24:27], s46 offen sc1
    v_mfma_f32_16x16x32_bf16 v[16:19], a[20:23], v[80:83], v[16:19]
    buffer_load_dwordx4 v[76:79], v227, s[24:27], s46 offen sc1
    v_mfma_f32_16x16x32_bf16 v[20:23], a[20:23], v[84:87], v[20:23]
    v_mfma_f32_16x16x32_bf16 v[24:27], a[20:23], v[88:91], v[24:27]
    ds_read_b64_tr_b16 a[0:1], v232 offset:8192
    v_mfma_f32_16x16x32_bf16 v[28:31], a[20:23], v[92:95], v[28:31]
    ds_read_b64_tr_b16 a[2:3], v232 offset:10240
    v_mfma_f32_16x16x32_bf16 v[32:35], a[24:27], v[80:83], v[32:35]
    ds_read_b64_tr_b16 a[4:5], v233 offset:8192
    v_mfma_f32_16x16x32_bf16 v[36:39], a[24:27], v[84:87], v[36:39]
    ds_read_b64_tr_b16 a[6:7], v233 offset:10240
    v_mfma_f32_16x16x32_bf16 v[40:43], a[24:27], v[88:91], v[40:43]
    v_mfma_f32_16x16x32_bf16 v[44:47], a[24:27], v[92:95], v[44:47]
    ds_read_b64_tr_b16 a[8:9], v234 offset:8192
    v_mfma_f32_16x16x32_bf16 v[48:51], a[28:31], v[80:83], v[48:51]
    ds_read_b64_tr_b16 a[10:11], v234 offset:10240
    v_mfma_f32_16x16x32_bf16 v[52:55], a[28:31], v[84:87], v[52:55]
    ds_read_b64_tr_b16 a[12:13], v235 offset:8192
    v_mfma_f32_16x16x32_bf16 v[56:59], a[28:31], v[88:91], v[56:59]
    ds_read_b64_tr_b16 a[14:15], v235 offset:10240
    v_mfma_f32_16x16x32_bf16 v[60:63], a[28:31], v[92:95], v[60:63]
    s_waitcnt vmcnt(32)
    v_mfma_f32_16x16x32_bf16 v[0:3], a[32:35], v[96:99], v[0:3]
    s_mov_b32 s46, 28672
    buffer_load_dwordx4 v[80:83], v224, s[24:27], s46 offen sc1
    v_mfma_f32_16x16x32_bf16 v[4:7], a[32:35], v[100:103], v[4:7]
    buffer_load_dwordx4 v[84:87], v225, s[24:27], s46 offen sc1
    buffer_load_dwordx4 v[88:91], v226, s[24:27], s46 offen sc1
    v_mfma_f32_16x16x32_bf16 v[8:11], a[32:35], v[104:107], v[8:11]
    buffer_load_dwordx4 v[92:95], v227, s[24:27], s46 offen sc1
    ds_read_b64_tr_b16 a[16:17], v228 offset:0
    v_mfma_f32_16x16x32_bf16 v[12:15], a[32:35], v[108:111], v[12:15]
    ds_read_b64_tr_b16 a[18:19], v228 offset:2048
    v_mfma_f32_16x16x32_bf16 v[16:19], a[36:39], v[96:99], v[16:19]
    ds_read_b64_tr_b16 a[20:21], v229 offset:0
    ds_read_b64_tr_b16 a[22:23], v229 offset:2048
    v_mfma_f32_16x16x32_bf16 v[20:23], a[36:39], v[100:103], v[20:23]
    ds_read_b64_tr_b16 a[24:25], v230 offset:0
    ds_read_b64_tr_b16 a[26:27], v230 offset:2048
    v_mfma_f32_16x16x32_bf16 v[24:27], a[36:39], v[104:107], v[24:27]
    ds_read_b64_tr_b16 a[28:29], v231 offset:0
    v_mfma_f32_16x16x32_bf16 v[28:31], a[36:39], v[108:111], v[28:31]
    ds_read_b64_tr_b16 a[30:31], v231 offset:2048
    s_waitcnt lgkmcnt(8)
    v_mfma_f32_16x16x32_bf16 v[32:35], a[40:43], v[96:99], v[32:35]
    s_add_u32 s3, s49, 4751360
    s_add_u32 m0, s51, 8192
    v_mfma_f32_16x16x32_bf16 v[36:39], a[40:43], v[100:103], v[36:39]
    s_nop 0
    v_mfma_f32_16x16x32_bf16 v[40:43], a[40:43], v[104:107], v[40:43]
    buffer_load_dwordx4 v250, s[92:95], s3 offen lds
    s_add_u32 m0, m0, 1024
    v_mfma_f32_16x16x32_bf16 v[44:47], a[40:43], v[108:111], v[44:47]
    s_add_u32 s3, s3, 10240
    buffer_load_dwordx4 v250, s[92:95], s3 offen lds
    v_mfma_f32_16x16x32_bf16 v[48:51], a[44:47], v[96:99], v[48:51]
    s_add_u32 m0, m0, 1024
    v_mfma_f32_16x16x32_bf16 v[52:55], a[44:47], v[100:103], v[52:55]
    s_add_u32 s3, s3, 10240
    buffer_load_dwordx4 v250, s[92:95], s3 offen lds
    v_mfma_f32_16x16x32_bf16 v[56:59], a[44:47], v[104:107], v[56:59]
    s_add_u32 m0, m0, 1024
    s_add_u32 s3, s3, 10240
    v_mfma_f32_16x16x32_bf16 v[60:63], a[44:47], v[108:111], v[60:63]
    buffer_load_dwordx4 v250, s[92:95], s3 offen lds
    s_waitcnt vmcnt(36)
    v_mfma_f32_16x16x32_bf16 v[0:3], a[48:51], v[112:115], v[0:3]
    s_mov_b32 s46, 32768
    buffer_load_dwordx4 v[96:99], v224, s[24:27], s46 offen sc1
    v_mfma_f32_16x16x32_bf16 v[4:7], a[48:51], v[116:119], v[4:7]
    buffer_load_dwordx4 v[100:103], v225, s[24:27], s46 offen sc1
    buffer_load_dwordx4 v[104:107], v226, s[24:27], s46 offen sc1
    v_mfma_f32_16x16x32_bf16 v[8:11], a[48:51], v[120:123], v[8:11]
    buffer_load_dwordx4 v[108:111], v227, s[24:27], s46 offen sc1
    ds_read_b64_tr_b16 a[32:33], v228 offset:4096
    v_mfma_f32_16x16x32_bf16 v[12:15], a[48:51], v[124:127], v[12:15]
    ds_read_b64_tr_b16 a[34:35], v228 offset:6144
    v_mfma_f32_16x16x32_bf16 v[16:19], a[52:55], v[112:115], v[16:19]
    ds_read_b64_tr_b16 a[36:37], v229 offset:4096
    ds_read_b64_tr_b16 a[38:39], v229 offset:6144
    v_mfma_f32_16x16x32_bf16 v[20:23], a[52:55], v[116:119], v[20:23]
    ds_read_b64_tr_b16 a[40:41], v230 offset:4096
    ds_read_b64_tr_b16 a[42:43], v230 offset:6144
    v_mfma_f32_16x16x32_bf16 v[24:27], a[52:55], v[120:123], v[24:27]
    ds_read_b64_tr_b16 a[44:45], v231 offset:4096
    v_mfma_f32_16x16x32_bf16 v[28:31], a[52:55], v[124:127], v[28:31]
    ds_read_b64_tr_b16 a[46:47], v231 offset:6144
    s_waitcnt lgkmcnt(8)
    v_mfma_f32_16x16x32_bf16 v[32:35], a[56:59], v[112:115], v[32:35]
    s_add_u32 s3, s49, 4915200
    s_add_u32 m0, s41, 0
    v_mfma_f32_16x16x32_bf16 v[36:39], a[56:59], v[116:119], v[36:39]
    s_nop 0
    v_mfma_f32_16x16x32_bf16 v[40:43], a[56:59], v[120:123], v[40:43]
    buffer_load_dwordx4 v250, s[92:95], s3 offen lds
    s_add_u32 m0, m0, 1024
    v_mfma_f32_16x16x32_bf16 v[44:47], a[56:59], v[124:127], v[44:47]
    s_add_u32 s3, s3, 10240
    buffer_load_dwordx4 v250, s[92:95], s3 offen lds
    v_mfma_f32_16x16x32_bf16 v[48:51], a[60:63], v[112:115], v[48:51]
    s_add_u32 m0, m0, 1024
    v_mfma_f32_16x16x32_bf16 v[52:55], a[60:63], v[116:119], v[52:55]
    s_add_u32 s3, s3, 10240
    buffer_load_dwordx4 v250, s[92:95], s3 offen lds
    v_mfma_f32_16x16x32_bf16 v[56:59], a[60:63], v[120:123], v[56:59]
    s_add_u32 m0, m0, 1024
    s_add_u32 s3, s3, 10240
    v_mfma_f32_16x16x32_bf16 v[60:63], a[60:63], v[124:127], v[60:63]
    buffer_load_dwordx4 v250, s[92:95], s3 offen lds
    s_waitcnt vmcnt(40)
    v_mfma_f32_16x16x32_bf16 v[0:3], a[64:67], v[128:131], v[0:3]
    s_mov_b32 s46, 36864
    buffer_load_dwordx4 v[112:115], v224, s[24:27], s46 offen sc1
    v_mfma_f32_16x16x32_bf16 v[4:7], a[64:67], v[132:135], v[4:7]
    buffer_load_dwordx4 v[116:119], v225, s[24:27], s46 offen sc1
    buffer_load_dwordx4 v[120:123], v226, s[24:27], s46 offen sc1
    v_mfma_f32_16x16x32_bf16 v[8:11], a[64:67], v[136:139], v[8:11]
    buffer_load_dwordx4 v[124:127], v227, s[24:27], s46 offen sc1
    ds_read_b64_tr_b16 a[48:49], v228 offset:8192
    v_mfma_f32_16x16x32_bf16 v[12:15], a[64:67], v[140:143], v[12:15]
    ds_read_b64_tr_b16 a[50:51], v228 offset:10240
    v_mfma_f32_16x16x32_bf16 v[16:19], a[68:71], v[128:131], v[16:19]
    ds_read_b64_tr_b16 a[52:53], v229 offset:8192
    ds_read_b64_tr_b16 a[54:55], v229 offset:10240
    v_mfma_f32_16x16x32_bf16 v[20:23], a[68:71], v[132:135], v[20:23]
    ds_read_b64_tr_b16 a[56:57], v230 offset:8192
    ds_read_b64_tr_b16 a[58:59], v230 offset:10240
    v_mfma_f32_16x16x32_bf16 v[24:27], a[68:71], v[136:139], v[24:27]
    ds_read_b64_tr_b16 a[60:61], v231 offset:8192
    v_mfma_f32_16x16x32_bf16 v[28:31], a[68:71], v[140:143], v[28:31]
    ds_read_b64_tr_b16 a[62:63], v231 offset:10240
    s_waitcnt lgkmcnt(8)
    v_mfma_f32_16x16x32_bf16 v[32:35], a[72:75], v[128:131], v[32:35]
    s_add_u32 s3, s49, 5079040
    s_add_u32 m0, s41, 4096
    v_mfma_f32_16x16x32_bf16 v[36:39], a[72:75], v[132:135], v[36:39]
    s_nop 0
    v_mfma_f32_16x16x32_bf16 v[40:43], a[72:75], v[136:139], v[40:43]
    buffer_load_dwordx4 v250, s[92:95], s3 offen lds
    s_add_u32 m0, m0, 1024
    v_mfma_f32_16x16x32_bf16 v[44:47], a[72:75], v[140:143], v[44:47]
    s_add_u32 s3, s3, 10240
    buffer_load_dwordx4 v250, s[92:95], s3 offen lds
    v_mfma_f32_16x16x32_bf16 v[48:51], a[76:79], v[128:131], v[48:51]
    s_add_u32 m0, m0, 1024
    v_mfma_f32_16x16x32_bf16 v[52:55], a[76:79], v[132:135], v[52:55]
    s_add_u32 s3, s3, 10240
    buffer_load_dwordx4 v250, s[92:95], s3 offen lds
    v_mfma_f32_16x16x32_bf16 v[56:59], a[76:79], v[136:139], v[56:59]
    s_add_u32 m0, m0, 1024
    s_add_u32 s3, s3, 10240
    v_mfma_f32_16x16x32_bf16 v[60:63], a[76:79], v[140:143], v[60:63]
    buffer_load_dwordx4 v250, s[92:95], s3 offen lds
    s_waitcnt vmcnt(44)
    v_mfma_f32_16x16x32_bf16 v[0:3], a[80:83], v[144:147], v[0:3]
    s_mov_b32 s46, 40960
    v_mfma_f32_16x16x32_bf16 v[4:7], a[80:83], v[148:151], v[4:7]
    buffer_load_dwordx4 v[128:131], v224, s[24:27], s46 offen sc1
    v_mfma_f32_16x16x32_bf16 v[8:11], a[80:83], v[152:155], v[8:11]
    buffer_load_dwordx4 v[132:135], v225, s[24:27], s46 offen sc1
    v_mfma_f32_16x16x32_bf16 v[12:15], a[80:83], v[156:159], v[12:15]
    buffer_load_dwordx4 v[136:139], v226, s[24:27], s46 offen sc1
    v_mfma_f32_16x16x32_bf16 v[16:19], a[84:87], v[144:147], v[16:19]
    buffer_load_dwordx4 v[140:143], v227, s[24:27], s46 offen sc1
    v_mfma_f32_16x16x32_bf16 v[20:23], a[84:87], v[148:151], v[20:23]
    v_mfma_f32_16x16x32_bf16 v[24:27], a[84:87], v[152:155], v[24:27]
    ds_read_b64_tr_b16 a[64:65], v228 offset:12288
    v_mfma_f32_16x16x32_bf16 v[28:31], a[84:87], v[156:159], v[28:31]
    ds_read_b64_tr_b16 a[66:67], v228 offset:14336
    v_mfma_f32_16x16x32_bf16 v[32:35], a[88:91], v[144:147], v[32:35]
    ds_read_b64_tr_b16 a[68:69], v229 offset:12288
    v_mfma_f32_16x16x32_bf16 v[36:39], a[88:91], v[148:151], v[36:39]
    ds_read_b64_tr_b16 a[70:71], v229 offset:14336
    v_mfma_f32_16x16x32_bf16 v[40:43], a[88:91], v[152:155], v[40:43]
    v_mfma_f32_16x16x32_bf16 v[44:47], a[88:91], v[156:159], v[44:47]
    ds_read_b64_tr_b16 a[72:73], v230 offset:12288
    v_mfma_f32_16x16x32_bf16 v[48:51], a[92:95], v[144:147], v[48:51]
    ds_read_b64_tr_b16 a[74:75], v230 offset:14336
    v_mfma_f32_16x16x32_bf16 v[52:55], a[92:95], v[148:151], v[52:55]
    ds_read_b64_tr_b16 a[76:77], v231 offset:12288
    v_mfma_f32_16x16x32_bf16 v[56:59], a[92:95], v[152:155], v[56:59]
    ds_read_b64_tr_b16 a[78:79], v231 offset:14336
    v_mfma_f32_16x16x32_bf16 v[60:63], a[92:95], v[156:159], v[60:63]
    s_waitcnt vmcnt(28)
    v_mfma_f32_16x16x32_bf16 v[0:3], a[96:99], v[64:67], v[0:3]
    s_mov_b32 s46, 45056
    v_mfma_f32_16x16x32_bf16 v[4:7], a[96:99], v[68:71], v[4:7]
    buffer_load_dwordx4 v[144:147], v224, s[24:27], s46 offen sc1
    v_mfma_f32_16x16x32_bf16 v[8:11], a[96:99], v[72:75], v[8:11]
    buffer_load_dwordx4 v[148:151], v225, s[24:27], s46 offen sc1
    v_mfma_f32_16x16x32_bf16 v[12:15], a[96:99], v[76:79], v[12:15]
    buffer_load_dwordx4 v[152:155], v226, s[24:27], s46 offen sc1
    v_mfma_f32_16x16x32_bf16 v[16:19], a[100:103], v[64:67], v[16:19]
    buffer_load_dwordx4 v[156:159], v227, s[24:27], s46 offen sc1
    v_mfma_f32_16x16x32_bf16 v[20:23], a[100:103], v[68:71], v[20:23]
    v_mfma_f32_16x16x32_bf16 v[24:27], a[100:103], v[72:75], v[24:27]
    ds_read_b64_tr_b16 a[80:81], v228 offset:16384
    v_mfma_f32_16x16x32_bf16 v[28:31], a[100:103], v[76:79], v[28:31]
    ds_read_b64_tr_b16 a[82:83], v228 offset:18432
    v_mfma_f32_16x16x32_bf16 v[32:35], a[104:107], v[64:67], v[32:35]
    ds_read_b64_tr_b16 a[84:85], v229 offset:16384
    v_mfma_f32_16x16x32_bf16 v[36:39], a[104:107], v[68:71], v[36:39]
    ds_read_b64_tr_b16 a[86:87], v229 offset:18432
    v_mfma_f32_16x16x32_bf16 v[40:43], a[104:107], v[72:75], v[40:43]
    v_mfma_f32_16x16x32_bf16 v[44:47], a[104:107], v[76:79], v[44:47]
    ds_read_b64_tr_b16 a[88:89], v230 offset:16384
    v_mfma_f32_16x16x32_bf16 v[48:51], a[108:111], v[64:67], v[48:51]
    ds_read_b64_tr_b16 a[90:91], v230 offset:18432
    v_mfma_f32_16x16x32_bf16 v[52:55], a[108:111], v[68:71], v[52:55]
    ds_read_b64_tr_b16 a[92:93], v231 offset:16384
    v_mfma_f32_16x16x32_bf16 v[56:59], a[108:111], v[72:75], v[56:59]
    ds_read_b64_tr_b16 a[94:95], v231 offset:18432
    v_mfma_f32_16x16x32_bf16 v[60:63], a[108:111], v[76:79], v[60:63]
    s_waitcnt vmcnt(28)
    v_mfma_f32_16x16x32_bf16 v[0:3], a[112:115], v[80:83], v[0:3]
    s_mov_b32 s46, 49152
    v_mfma_f32_16x16x32_bf16 v[4:7], a[112:115], v[84:87], v[4:7]
    buffer_load_dwordx4 v[64:67], v224, s[24:27], s46 offen sc1
    v_mfma_f32_16x16x32_bf16 v[8:11], a[112:115], v[88:91], v[8:11]
    buffer_load_dwordx4 v[68:71], v225, s[24:27], s46 offen sc1
    v_mfma_f32_16x16x32_bf16 v[12:15], a[112:115], v[92:95], v[12:15]
    buffer_load_dwordx4 v[72:75], v226, s[24:27], s46 offen sc1
    v_mfma_f32_16x16x32_bf16 v[16:19], a[116:119], v[80:83], v[16:19]
    buffer_load_dwordx4 v[76:79], v227, s[24:27], s46 offen sc1
    v_mfma_f32_16x16x32_bf16 v[20:23], a[116:119], v[84:87], v[20:23]
    v_mfma_f32_16x16x32_bf16 v[24:27], a[116:119], v[88:91], v[24:27]
    ds_read_b64_tr_b16 a[96:97], v228 offset:20480
    v_mfma_f32_16x16x32_bf16 v[28:31], a[116:119], v[92:95], v[28:31]
    ds_read_b64_tr_b16 a[98:99], v228 offset:22528
    v_mfma_f32_16x16x32_bf16 v[32:35], a[120:123], v[80:83], v[32:35]
    ds_read_b64_tr_b16 a[100:101], v229 offset:20480
    v_mfma_f32_16x16x32_bf16 v[36:39], a[120:123], v[84:87], v[36:39]
    ds_read_b64_tr_b16 a[102:103], v229 offset:22528
    v_mfma_f32_16x16x32_bf16 v[40:43], a[120:123], v[88:91], v[40:43]
    v_mfma_f32_16x16x32_bf16 v[44:47], a[120:123], v[92:95], v[44:47]
    ds_read_b64_tr_b16 a[104:105], v230 offset:20480
    v_mfma_f32_16x16x32_bf16 v[48:51], a[124:127], v[80:83], v[48:51]
    ds_read_b64_tr_b16 a[106:107], v230 offset:22528
    v_mfma_f32_16x16x32_bf16 v[52:55], a[124:127], v[84:87], v[52:55]
    ds_read_b64_tr_b16 a[108:109], v231 offset:20480
    v_mfma_f32_16x16x32_bf16 v[56:59], a[124:127], v[88:91], v[56:59]
    ds_read_b64_tr_b16 a[110:111], v231 offset:22528
    v_mfma_f32_16x16x32_bf16 v[60:63], a[124:127], v[92:95], v[60:63]
    s_waitcnt vmcnt(24)
    v_mfma_f32_16x16x32_bf16 v[0:3], a[128:131], v[96:99], v[0:3]
    s_mov_b32 s46, 53248
    v_mfma_f32_16x16x32_bf16 v[4:7], a[128:131], v[100:103], v[4:7]
    buffer_load_dwordx4 v[80:83], v224, s[24:27], s46 offen sc1
    v_mfma_f32_16x16x32_bf16 v[8:11], a[128:131], v[104:107], v[8:11]
    buffer_load_dwordx4 v[84:87], v225, s[24:27], s46 offen sc1
    v_mfma_f32_16x16x32_bf16 v[12:15], a[128:131], v[108:111], v[12:15]
    buffer_load_dwordx4 v[88:91], v226, s[24:27], s46 offen sc1
    v_mfma_f32_16x16x32_bf16 v[16:19], a[132:135], v[96:99], v[16:19]
    buffer_load_dwordx4 v[92:95], v227, s[24:27], s46 offen sc1
    v_mfma_f32_16x16x32_bf16 v[20:23], a[132:135], v[100:103], v[20:23]
    v_mfma_f32_16x16x32_bf16 v[24:27], a[132:135], v[104:107], v[24:27]
    ds_read_b64_tr_b16 a[112:113], v232 offset:0
    v_mfma_f32_16x16x32_bf16 v[28:31], a[132:135], v[108:111], v[28:31]
    ds_read_b64_tr_b16 a[114:115], v232 offset:2048
    v_mfma_f32_16x16x32_bf16 v[32:35], a[136:139], v[96:99], v[32:35]
    ds_read_b64_tr_b16 a[116:117], v233 offset:0
    v_mfma_f32_16x16x32_bf16 v[36:39], a[136:139], v[100:103], v[36:39]
    ds_read_b64_tr_b16 a[118:119], v233 offset:2048
    v_mfma_f32_16x16x32_bf16 v[40:43], a[136:139], v[104:107], v[40:43]
    v_mfma_f32_16x16x32_bf16 v[44:47], a[136:139], v[108:111], v[44:47]
    ds_read_b64_tr_b16 a[120:121], v234 offset:0
    v_mfma_f32_16x16x32_bf16 v[48:51], a[140:143], v[96:99], v[48:51]
    ds_read_b64_tr_b16 a[122:123], v234 offset:2048
    v_mfma_f32_16x16x32_bf16 v[52:55], a[140:143], v[100:103], v[52:55]
    ds_read_b64_tr_b16 a[124:125], v235 offset:0
    v_mfma_f32_16x16x32_bf16 v[56:59], a[140:143], v[104:107], v[56:59]
    ds_read_b64_tr_b16 a[126:127], v235 offset:2048
    v_mfma_f32_16x16x32_bf16 v[60:63], a[140:143], v[108:111], v[60:63]
    s_waitcnt vmcnt(20)
    v_mfma_f32_16x16x32_bf16 v[0:3], a[144:147], v[112:115], v[0:3]
    s_mov_b32 s46, 57344
    v_mfma_f32_16x16x32_bf16 v[4:7], a[144:147], v[116:119], v[4:7]
    buffer_load_dwordx4 v[96:99], v224, s[24:27], s46 offen sc1
    v_mfma_f32_16x16x32_bf16 v[8:11], a[144:147], v[120:123], v[8:11]
    buffer_load_dwordx4 v[100:103], v225, s[24:27], s46 offen sc1
    v_mfma_f32_16x16x32_bf16 v[12:15], a[144:147], v[124:127], v[12:15]
    buffer_load_dwordx4 v[104:107], v226, s[24:27], s46 offen sc1
    v_mfma_f32_16x16x32_bf16 v[16:19], a[148:151], v[112:115], v[16:19]
    buffer_load_dwordx4 v[108:111], v227, s[24:27], s46 offen sc1
    v_mfma_f32_16x16x32_bf16 v[20:23], a[148:151], v[116:119], v[20:23]
    v_mfma_f32_16x16x32_bf16 v[24:27], a[148:151], v[120:123], v[24:27]
    ds_read_b64_tr_b16 a[128:129], v232 offset:4096
    v_mfma_f32_16x16x32_bf16 v[28:31], a[148:151], v[124:127], v[28:31]
    ds_read_b64_tr_b16 a[130:131], v232 offset:6144
    v_mfma_f32_16x16x32_bf16 v[32:35], a[152:155], v[112:115], v[32:35]
    ds_read_b64_tr_b16 a[132:133], v233 offset:4096
    v_mfma_f32_16x16x32_bf16 v[36:39], a[152:155], v[116:119], v[36:39]
    ds_read_b64_tr_b16 a[134:135], v233 offset:6144
    v_mfma_f32_16x16x32_bf16 v[40:43], a[152:155], v[120:123], v[40:43]
    v_mfma_f32_16x16x32_bf16 v[44:47], a[152:155], v[124:127], v[44:47]
    ds_read_b64_tr_b16 a[136:137], v234 offset:4096
    v_mfma_f32_16x16x32_bf16 v[48:51], a[156:159], v[112:115], v[48:51]
    ds_read_b64_tr_b16 a[138:139], v234 offset:6144
    v_mfma_f32_16x16x32_bf16 v[52:55], a[156:159], v[116:119], v[52:55]
    ds_read_b64_tr_b16 a[140:141], v235 offset:4096
    v_mfma_f32_16x16x32_bf16 v[56:59], a[156:159], v[120:123], v[56:59]
    ds_read_b64_tr_b16 a[142:143], v235 offset:6144
    v_mfma_f32_16x16x32_bf16 v[60:63], a[156:159], v[124:127], v[60:63]
    s_waitcnt vmcnt(16)
    v_mfma_f32_16x16x32_bf16 v[0:3], a[160:163], v[128:131], v[0:3]
    s_mov_b32 s46, 61440
    v_mfma_f32_16x16x32_bf16 v[4:7], a[160:163], v[132:135], v[4:7]
    buffer_load_dwordx4 v[112:115], v224, s[24:27], s46 offen sc1
    v_mfma_f32_16x16x32_bf16 v[8:11], a[160:163], v[136:139], v[8:11]
    buffer_load_dwordx4 v[116:119], v225, s[24:27], s46 offen sc1
    v_mfma_f32_16x16x32_bf16 v[12:15], a[160:163], v[140:143], v[12:15]
    buffer_load_dwordx4 v[120:123], v226, s[24:27], s46 offen sc1
    v_mfma_f32_16x16x32_bf16 v[16:19], a[164:167], v[128:131], v[16:19]
    buffer_load_dwordx4 v[124:127], v227, s[24:27], s46 offen sc1
    v_mfma_f32_16x16x32_bf16 v[20:23], a[164:167], v[132:135], v[20:23]
    v_mfma_f32_16x16x32_bf16 v[24:27], a[164:167], v[136:139], v[24:27]
    ds_read_b64_tr_b16 a[144:145], v232 offset:8192
    v_mfma_f32_16x16x32_bf16 v[28:31], a[164:167], v[140:143], v[28:31]
    ds_read_b64_tr_b16 a[146:147], v232 offset:10240
    v_mfma_f32_16x16x32_bf16 v[32:35], a[168:171], v[128:131], v[32:35]
    ds_read_b64_tr_b16 a[148:149], v233 offset:8192
    v_mfma_f32_16x16x32_bf16 v[36:39], a[168:171], v[132:135], v[36:39]
    ds_read_b64_tr_b16 a[150:151], v233 offset:10240
    v_mfma_f32_16x16x32_bf16 v[40:43], a[168:171], v[136:139], v[40:43]
    v_mfma_f32_16x16x32_bf16 v[44:47], a[168:171], v[140:143], v[44:47]
    ds_read_b64_tr_b16 a[152:153], v234 offset:8192
    v_mfma_f32_16x16x32_bf16 v[48:51], a[172:175], v[128:131], v[48:51]
    ds_read_b64_tr_b16 a[154:155], v234 offset:10240
    v_mfma_f32_16x16x32_bf16 v[52:55], a[172:175], v[132:135], v[52:55]
    ds_read_b64_tr_b16 a[156:157], v235 offset:8192
    v_mfma_f32_16x16x32_bf16 v[56:59], a[172:175], v[136:139], v[56:59]
    ds_read_b64_tr_b16 a[158:159], v235 offset:10240
    v_mfma_f32_16x16x32_bf16 v[60:63], a[172:175], v[140:143], v[60:63]
    s_waitcnt vmcnt(16)
    v_mfma_f32_16x16x32_bf16 v[0:3], a[176:179], v[144:147], v[0:3]
    s_mov_b32 s46, 65536
    v_mfma_f32_16x16x32_bf16 v[4:7], a[176:179], v[148:151], v[4:7]
    buffer_load_dwordx4 v[128:131], v224, s[24:27], s46 offen sc1
    v_mfma_f32_16x16x32_bf16 v[8:11], a[176:179], v[152:155], v[8:11]
    buffer_load_dwordx4 v[132:135], v225, s[24:27], s46 offen sc1
    v_mfma_f32_16x16x32_bf16 v[12:15], a[176:179], v[156:159], v[12:15]
    buffer_load_dwordx4 v[136:139], v226, s[24:27], s46 offen sc1
    v_mfma_f32_16x16x32_bf16 v[16:19], a[180:183], v[144:147], v[16:19]
    buffer_load_dwordx4 v[140:143], v227, s[24:27], s46 offen sc1
    v_mfma_f32_16x16x32_bf16 v[20:23], a[180:183], v[148:151], v[20:23]
    v_mfma_f32_16x16x32_bf16 v[24:27], a[180:183], v[152:155], v[24:27]
    ds_read_b64_tr_b16 a[160:161], v228 offset:0
    v_mfma_f32_16x16x32_bf16 v[28:31], a[180:183], v[156:159], v[28:31]
    ds_read_b64_tr_b16 a[162:163], v228 offset:2048
    v_mfma_f32_16x16x32_bf16 v[32:35], a[184:187], v[144:147], v[32:35]
    ds_read_b64_tr_b16 a[164:165], v229 offset:0
    v_mfma_f32_16x16x32_bf16 v[36:39], a[184:187], v[148:151], v[36:39]
    ds_read_b64_tr_b16 a[166:167], v229 offset:2048
    v_mfma_f32_16x16x32_bf16 v[40:43], a[184:187], v[152:155], v[40:43]
    v_mfma_f32_16x16x32_bf16 v[44:47], a[184:187], v[156:159], v[44:47]
    ds_read_b64_tr_b16 a[168:169], v230 offset:0
    v_mfma_f32_16x16x32_bf16 v[48:51], a[188:191], v[144:147], v[48:51]
    ds_read_b64_tr_b16 a[170:171], v230 offset:2048
    v_mfma_f32_16x16x32_bf16 v[52:55], a[188:191], v[148:151], v[52:55]
    ds_read_b64_tr_b16 a[172:173], v231 offset:0
    v_mfma_f32_16x16x32_bf16 v[56:59], a[188:191], v[152:155], v[56:59]
    ds_read_b64_tr_b16 a[174:175], v231 offset:2048
    v_mfma_f32_16x16x32_bf16 v[60:63], a[188:191], v[156:159], v[60:63]
    s_waitcnt vmcnt(16)
    v_mfma_f32_16x16x32_bf16 v[0:3], a[192:195], v[64:67], v[0:3]
    s_mov_b32 s46, 69632
    v_mfma_f32_16x16x32_bf16 v[4:7], a[192:195], v[68:71], v[4:7]
    buffer_load_dwordx4 v[144:147], v224, s[24:27], s46 offen sc1
    v_mfma_f32_16x16x32_bf16 v[8:11], a[192:195], v[72:75], v[8:11]
    buffer_load_dwordx4 v[148:151], v225, s[24:27], s46 offen sc1
    v_mfma_f32_16x16x32_bf16 v[12:15], a[192:195], v[76:79], v[12:15]
    buffer_load_dwordx4 v[152:155], v226, s[24:27], s46 offen sc1
    v_mfma_f32_16x16x32_bf16 v[16:19], a[196:199], v[64:67], v[16:19]
    buffer_load_dwordx4 v[156:159], v227, s[24:27], s46 offen sc1
    v_mfma_f32_16x16x32_bf16 v[20:23], a[196:199], v[68:71], v[20:23]
    v_mfma_f32_16x16x32_bf16 v[24:27], a[196:199], v[72:75], v[24:27]
    ds_read_b64_tr_b16 a[176:177], v228 offset:4096
    v_mfma_f32_16x16x32_bf16 v[28:31], a[196:199], v[76:79], v[28:31]
    ds_read_b64_tr_b16 a[178:179], v228 offset:6144
    v_mfma_f32_16x16x32_bf16 v[32:35], a[200:203], v[64:67], v[32:35]
    ds_read_b64_tr_b16 a[180:181], v229 offset:4096
    v_mfma_f32_16x16x32_bf16 v[36:39], a[200:203], v[68:71], v[36:39]
    ds_read_b64_tr_b16 a[182:183], v229 offset:6144
    v_mfma_f32_16x16x32_bf16 v[40:43], a[200:203], v[72:75], v[40:43]
    v_mfma_f32_16x16x32_bf16 v[44:47], a[200:203], v[76:79], v[44:47]
    ds_read_b64_tr_b16 a[184:185], v230 offset:4096
    v_mfma_f32_16x16x32_bf16 v[48:51], a[204:207], v[64:67], v[48:51]
    ds_read_b64_tr_b16 a[186:187], v230 offset:6144
    v_mfma_f32_16x16x32_bf16 v[52:55], a[204:207], v[68:71], v[52:55]
    ds_read_b64_tr_b16 a[188:189], v231 offset:4096
    v_mfma_f32_16x16x32_bf16 v[56:59], a[204:207], v[72:75], v[56:59]
    ds_read_b64_tr_b16 a[190:191], v231 offset:6144
    v_mfma_f32_16x16x32_bf16 v[60:63], a[204:207], v[76:79], v[60:63]
    s_waitcnt vmcnt(16)
    v_mfma_f32_16x16x32_bf16 v[0:3], a[208:211], v[80:83], v[0:3]
    s_mov_b32 s46, 73728
    v_mfma_f32_16x16x32_bf16 v[4:7], a[208:211], v[84:87], v[4:7]
    v_mfma_f32_16x16x32_bf16 v[8:11], a[208:211], v[88:91], v[8:11]
    v_mfma_f32_16x16x32_bf16 v[12:15], a[208:211], v[92:95], v[12:15]
    buffer_load_dwordx4 v[64:67], v224, s[24:27], s46 offen sc1
    v_mfma_f32_16x16x32_bf16 v[16:19], a[212:215], v[80:83], v[16:19]
    v_mfma_f32_16x16x32_bf16 v[20:23], a[212:215], v[84:87], v[20:23]
    v_mfma_f32_16x16x32_bf16 v[24:27], a[212:215], v[88:91], v[24:27]
    buffer_load_dwordx4 v[68:71], v225, s[24:27], s46 offen sc1
    v_mfma_f32_16x16x32_bf16 v[28:31], a[212:215], v[92:95], v[28:31]
    v_mfma_f32_16x16x32_bf16 v[32:35], a[216:219], v[80:83], v[32:35]
    v_mfma_f32_16x16x32_bf16 v[36:39], a[216:219], v[84:87], v[36:39]
    buffer_load_dwordx4 v[72:75], v226, s[24:27], s46 offen sc1
    v_mfma_f32_16x16x32_bf16 v[40:43], a[216:219], v[88:91], v[40:43]
    v_mfma_f32_16x16x32_bf16 v[44:47], a[216:219], v[92:95], v[44:47]
    v_mfma_f32_16x16x32_bf16 v[48:51], a[220:223], v[80:83], v[48:51]
    buffer_load_dwordx4 v[76:79], v227, s[24:27], s46 offen sc1
    v_mfma_f32_16x16x32_bf16 v[52:55], a[220:223], v[84:87], v[52:55]
    v_mfma_f32_16x16x32_bf16 v[56:59], a[220:223], v[88:91], v[56:59]
    v_mfma_f32_16x16x32_bf16 v[60:63], a[220:223], v[92:95], v[60:63]
    s_waitcnt vmcnt(16)
    s_waitcnt lgkmcnt(0)
    v_mfma_f32_16x16x32_bf16 v[0:3], a[224:227], v[96:99], v[0:3]
    s_mov_b32 s46, 77824
    v_mfma_f32_16x16x32_bf16 v[4:7], a[224:227], v[100:103], v[4:7]
    v_mfma_f32_16x16x32_bf16 v[8:11], a[224:227], v[104:107], v[8:11]
    v_mfma_f32_16x16x32_bf16 v[12:15], a[224:227], v[108:111], v[12:15]
    buffer_load_dwordx4 v[80:83], v224, s[24:27], s46 offen sc1
    v_mfma_f32_16x16x32_bf16 v[16:19], a[228:231], v[96:99], v[16:19]
    v_mfma_f32_16x16x32_bf16 v[20:23], a[228:231], v[100:103], v[20:23]
    v_mfma_f32_16x16x32_bf16 v[24:27], a[228:231], v[104:107], v[24:27]
    buffer_load_dwordx4 v[84:87], v225, s[24:27], s46 offen sc1
    v_mfma_f32_16x16x32_bf16 v[28:31], a[228:231], v[108:111], v[28:31]
    v_mfma_f32_16x16x32_bf16 v[32:35], a[232:235], v[96:99], v[32:35]
    v_mfma_f32_16x16x32_bf16 v[36:39], a[232:235], v[100:103], v[36:39]
    buffer_load_dwordx4 v[88:91], v226, s[24:27], s46 offen sc1
    v_mfma_f32_16x16x32_bf16 v[40:43], a[232:235], v[104:107], v[40:43]
    v_mfma_f32_16x16x32_bf16 v[44:47], a[232:235], v[108:111], v[44:47]
    v_mfma_f32_16x16x32_bf16 v[48:51], a[236:239], v[96:99], v[48:51]
    buffer_load_dwordx4 v[92:95], v227, s[24:27], s46 offen sc1
    v_mfma_f32_16x16x32_bf16 v[52:55], a[236:239], v[100:103], v[52:55]
    v_mfma_f32_16x16x32_bf16 v[56:59], a[236:239], v[104:107], v[56:59]
    v_mfma_f32_16x16x32_bf16 v[60:63], a[236:239], v[108:111], v[60:63]
    s_waitcnt vmcnt(16)
    v_mfma_f32_16x16x32_bf16 v[0:3], a[240:243], v[112:115], v[0:3]
    s_mov_b32 s46, 81920
    v_mfma_f32_16x16x32_bf16 v[4:7], a[240:243], v[116:119], v[4:7]
    v_mfma_f32_16x16x32_bf16 v[8:11], a[240:243], v[120:123], v[8:11]
    v_mfma_f32_16x16x32_bf16 v[12:15], a[240:243], v[124:127], v[12:15]
    buffer_load_dwordx4 v[96:99], v224, s[24:27], s46 offen sc1
    v_mfma_f32_16x16x32_bf16 v[16:19], a[244:247], v[112:115], v[16:19]
    v_mfma_f32_16x16x32_bf16 v[20:23], a[244:247], v[116:119], v[20:23]
    v_mfma_f32_16x16x32_bf16 v[24:27], a[244:247], v[120:123], v[24:27]
    buffer_load_dwordx4 v[100:103], v225, s[24:27], s46 offen sc1
    v_mfma_f32_16x16x32_bf16 v[28:31], a[244:247], v[124:127], v[28:31]
    v_mfma_f32_16x16x32_bf16 v[32:35], a[248:251], v[112:115], v[32:35]
    v_mfma_f32_16x16x32_bf16 v[36:39], a[248:251], v[116:119], v[36:39]
    buffer_load_dwordx4 v[104:107], v226, s[24:27], s46 offen sc1
    v_mfma_f32_16x16x32_bf16 v[40:43], a[248:251], v[120:123], v[40:43]
    v_mfma_f32_16x16x32_bf16 v[44:47], a[248:251], v[124:127], v[44:47]
    v_mfma_f32_16x16x32_bf16 v[48:51], a[252:255], v[112:115], v[48:51]
    buffer_load_dwordx4 v[108:111], v227, s[24:27], s46 offen sc1
    v_mfma_f32_16x16x32_bf16 v[52:55], a[252:255], v[116:119], v[52:55]
    v_mfma_f32_16x16x32_bf16 v[56:59], a[252:255], v[120:123], v[56:59]
    v_mfma_f32_16x16x32_bf16 v[60:63], a[252:255], v[124:127], v[60:63]
    s_waitcnt vmcnt(16)
    v_mfma_f32_16x16x32_bf16 v[0:3], v[160:163], v[128:131], v[0:3]
    s_mov_b32 s46, 86016
    v_mfma_f32_16x16x32_bf16 v[4:7], v[160:163], v[132:135], v[4:7]
    v_mfma_f32_16x16x32_bf16 v[8:11], v[160:163], v[136:139], v[8:11]
    v_mfma_f32_16x16x32_bf16 v[12:15], v[160:163], v[140:143], v[12:15]
    buffer_load_dwordx4 v[112:115], v224, s[24:27], s46 offen sc1
    v_mfma_f32_16x16x32_bf16 v[16:19], v[164:167], v[128:131], v[16:19]
    v_mfma_f32_16x16x32_bf16 v[20:23], v[164:167], v[132:135], v[20:23]
    v_mfma_f32_16x16x32_bf16 v[24:27], v[164:167], v[136:139], v[24:27]
    buffer_load_dwordx4 v[116:119], v225, s[24:27], s46 offen sc1
    v_mfma_f32_16x16x32_bf16 v[28:31], v[164:167], v[140:143], v[28:31]
    v_mfma_f32_16x16x32_bf16 v[32:35], v[168:171], v[128:131], v[32:35]
    v_mfma_f32_16x16x32_bf16 v[36:39], v[168:171], v[132:135], v[36:39]
    buffer_load_dwordx4 v[120:123], v226, s[24:27], s46 offen sc1
    v_mfma_f32_16x16x32_bf16 v[40:43], v[168:171], v[136:139], v[40:43]
    v_mfma_f32_16x16x32_bf16 v[44:47], v[168:171], v[140:143], v[44:47]
    v_mfma_f32_16x16x32_bf16 v[48:51], v[172:175], v[128:131], v[48:51]
    buffer_load_dwordx4 v[124:127], v227, s[24:27], s46 offen sc1
    v_mfma_f32_16x16x32_bf16 v[52:55], v[172:175], v[132:135], v[52:55]
    v_mfma_f32_16x16x32_bf16 v[56:59], v[172:175], v[136:139], v[56:59]
    v_mfma_f32_16x16x32_bf16 v[60:63], v[172:175], v[140:143], v[60:63]
    s_waitcnt vmcnt(16)
    v_mfma_f32_16x16x32_bf16 v[0:3], v[176:179], v[144:147], v[0:3]
    s_mov_b32 s46, 90112
    v_mfma_f32_16x16x32_bf16 v[4:7], v[176:179], v[148:151], v[4:7]
    v_mfma_f32_16x16x32_bf16 v[8:11], v[176:179], v[152:155], v[8:11]
    v_mfma_f32_16x16x32_bf16 v[12:15], v[176:179], v[156:159], v[12:15]
    buffer_load_dwordx4 v[128:131], v224, s[24:27], s46 offen sc1
    v_mfma_f32_16x16x32_bf16 v[16:19], v[180:183], v[144:147], v[16:19]
    v_mfma_f32_16x16x32_bf16 v[20:23], v[180:183], v[148:151], v[20:23]
    v_mfma_f32_16x16x32_bf16 v[24:27], v[180:183], v[152:155], v[24:27]
    buffer_load_dwordx4 v[132:135], v225, s[24:27], s46 offen sc1
    v_mfma_f32_16x16x32_bf16 v[28:31], v[180:183], v[156:159], v[28:31]
    v_mfma_f32_16x16x32_bf16 v[32:35], v[184:187], v[144:147], v[32:35]
    v_mfma_f32_16x16x32_bf16 v[36:39], v[184:187], v[148:151], v[36:39]
    buffer_load_dwordx4 v[136:139], v226, s[24:27], s46 offen sc1
    v_mfma_f32_16x16x32_bf16 v[40:43], v[184:187], v[152:155], v[40:43]
    v_mfma_f32_16x16x32_bf16 v[44:47], v[184:187], v[156:159], v[44:47]
    v_mfma_f32_16x16x32_bf16 v[48:51], v[188:191], v[144:147], v[48:51]
    buffer_load_dwordx4 v[140:143], v227, s[24:27], s46 offen sc1
    v_mfma_f32_16x16x32_bf16 v[52:55], v[188:191], v[148:151], v[52:55]
    v_mfma_f32_16x16x32_bf16 v[56:59], v[188:191], v[152:155], v[56:59]
    v_mfma_f32_16x16x32_bf16 v[60:63], v[188:191], v[156:159], v[60:63]
    s_waitcnt vmcnt(16)
    v_mfma_f32_16x16x32_bf16 v[0:3], v[192:195], v[64:67], v[0:3]
    s_mov_b32 s46, 94208
    v_mfma_f32_16x16x32_bf16 v[4:7], v[192:195], v[68:71], v[4:7]
    v_mfma_f32_16x16x32_bf16 v[8:11], v[192:195], v[72:75], v[8:11]
    v_mfma_f32_16x16x32_bf16 v[12:15], v[192:195], v[76:79], v[12:15]
    buffer_load_dwordx4 v[144:147], v224, s[24:27], s46 offen sc1
    v_mfma_f32_16x16x32_bf16 v[16:19], v[196:199], v[64:67], v[16:19]
    v_mfma_f32_16x16x32_bf16 v[20:23], v[196:199], v[68:71], v[20:23]
    v_mfma_f32_16x16x32_bf16 v[24:27], v[196:199], v[72:75], v[24:27]
    buffer_load_dwordx4 v[148:151], v225, s[24:27], s46 offen sc1
    v_mfma_f32_16x16x32_bf16 v[28:31], v[196:199], v[76:79], v[28:31]
    v_mfma_f32_16x16x32_bf16 v[32:35], v[200:203], v[64:67], v[32:35]
    v_mfma_f32_16x16x32_bf16 v[36:39], v[200:203], v[68:71], v[36:39]
    buffer_load_dwordx4 v[152:155], v226, s[24:27], s46 offen sc1
    v_mfma_f32_16x16x32_bf16 v[40:43], v[200:203], v[72:75], v[40:43]
    v_mfma_f32_16x16x32_bf16 v[44:47], v[200:203], v[76:79], v[44:47]
    v_mfma_f32_16x16x32_bf16 v[48:51], v[204:207], v[64:67], v[48:51]
    buffer_load_dwordx4 v[156:159], v227, s[24:27], s46 offen sc1
    v_mfma_f32_16x16x32_bf16 v[52:55], v[204:207], v[68:71], v[52:55]
    v_mfma_f32_16x16x32_bf16 v[56:59], v[204:207], v[72:75], v[56:59]
    v_mfma_f32_16x16x32_bf16 v[60:63], v[204:207], v[76:79], v[60:63]
    s_waitcnt vmcnt(16)
    v_mfma_f32_16x16x32_bf16 v[0:3], v[208:211], v[80:83], v[0:3]
    s_mov_b32 s46, 98304
    v_mfma_f32_16x16x32_bf16 v[4:7], v[208:211], v[84:87], v[4:7]
    v_mfma_f32_16x16x32_bf16 v[8:11], v[208:211], v[88:91], v[8:11]
    v_mfma_f32_16x16x32_bf16 v[12:15], v[208:211], v[92:95], v[12:15]
    buffer_load_dwordx4 v[64:67], v224, s[24:27], s46 offen sc1
    v_mfma_f32_16x16x32_bf16 v[16:19], v[212:215], v[80:83], v[16:19]
    v_mfma_f32_16x16x32_bf16 v[20:23], v[212:215], v[84:87], v[20:23]
    v_mfma_f32_16x16x32_bf16 v[24:27], v[212:215], v[88:91], v[24:27]
    buffer_load_dwordx4 v[68:71], v225, s[24:27], s46 offen sc1
    v_mfma_f32_16x16x32_bf16 v[28:31], v[212:215], v[92:95], v[28:31]
    v_mfma_f32_16x16x32_bf16 v[32:35], v[216:219], v[80:83], v[32:35]
    v_mfma_f32_16x16x32_bf16 v[36:39], v[216:219], v[84:87], v[36:39]
    buffer_load_dwordx4 v[72:75], v226, s[24:27], s46 offen sc1
    v_mfma_f32_16x16x32_bf16 v[40:43], v[216:219], v[88:91], v[40:43]
    v_mfma_f32_16x16x32_bf16 v[44:47], v[216:219], v[92:95], v[44:47]
    v_mfma_f32_16x16x32_bf16 v[48:51], v[220:223], v[80:83], v[48:51]
    buffer_load_dwordx4 v[76:79], v227, s[24:27], s46 offen sc1
    v_mfma_f32_16x16x32_bf16 v[52:55], v[220:223], v[84:87], v[52:55]
    v_mfma_f32_16x16x32_bf16 v[56:59], v[220:223], v[88:91], v[56:59]
    v_mfma_f32_16x16x32_bf16 v[60:63], v[220:223], v[92:95], v[60:63]
    s_waitcnt vmcnt(16)
    v_mfma_f32_16x16x32_bf16 v[0:3], a[0:3], v[96:99], v[0:3]
    s_mov_b32 s46, 102400
    v_mfma_f32_16x16x32_bf16 v[4:7], a[0:3], v[100:103], v[4:7]
    v_mfma_f32_16x16x32_bf16 v[8:11], a[0:3], v[104:107], v[8:11]
    v_mfma_f32_16x16x32_bf16 v[12:15], a[0:3], v[108:111], v[12:15]
    buffer_load_dwordx4 v[80:83], v224, s[24:27], s46 offen sc1
    v_mfma_f32_16x16x32_bf16 v[16:19], a[4:7], v[96:99], v[16:19]
    v_mfma_f32_16x16x32_bf16 v[20:23], a[4:7], v[100:103], v[20:23]
    v_mfma_f32_16x16x32_bf16 v[24:27], a[4:7], v[104:107], v[24:27]
    buffer_load_dwordx4 v[84:87], v225, s[24:27], s46 offen sc1
    v_mfma_f32_16x16x32_bf16 v[28:31], a[4:7], v[108:111], v[28:31]
    v_mfma_f32_16x16x32_bf16 v[32:35], a[8:11], v[96:99], v[32:35]
    v_mfma_f32_16x16x32_bf16 v[36:39], a[8:11], v[100:103], v[36:39]
    buffer_load_dwordx4 v[88:91], v226, s[24:27], s46 offen sc1
    v_mfma_f32_16x16x32_bf16 v[40:43], a[8:11], v[104:107], v[40:43]
    v_mfma_f32_16x16x32_bf16 v[44:47], a[8:11], v[108:111], v[44:47]
    v_mfma_f32_16x16x32_bf16 v[48:51], a[12:15], v[96:99], v[48:51]
    buffer_load_dwordx4 v[92:95], v227, s[24:27], s46 offen sc1
    v_mfma_f32_16x16x32_bf16 v[52:55], a[12:15], v[100:103], v[52:55]
    v_mfma_f32_16x16x32_bf16 v[56:59], a[12:15], v[104:107], v[56:59]
    v_mfma_f32_16x16x32_bf16 v[60:63], a[12:15], v[108:111], v[60:63]
    s_waitcnt vmcnt(16)
    v_mfma_f32_16x16x32_bf16 v[0:3], a[16:19], v[112:115], v[0:3]
    s_mov_b32 s46, 106496
    v_mfma_f32_16x16x32_bf16 v[4:7], a[16:19], v[116:119], v[4:7]
    v_mfma_f32_16x16x32_bf16 v[8:11], a[16:19], v[120:123], v[8:11]
    v_mfma_f32_16x16x32_bf16 v[12:15], a[16:19], v[124:127], v[12:15]
    buffer_load_dwordx4 v[96:99], v224, s[24:27], s46 offen sc1
    v_mfma_f32_16x16x32_bf16 v[16:19], a[20:23], v[112:115], v[16:19]
    v_mfma_f32_16x16x32_bf16 v[20:23], a[20:23], v[116:119], v[20:23]
    v_mfma_f32_16x16x32_bf16 v[24:27], a[20:23], v[120:123], v[24:27]
    buffer_load_dwordx4 v[100:103], v225, s[24:27], s46 offen sc1
    v_mfma_f32_16x16x32_bf16 v[28:31], a[20:23], v[124:127], v[28:31]
    v_mfma_f32_16x16x32_bf16 v[32:35], a[24:27], v[112:115], v[32:35]
    v_mfma_f32_16x16x32_bf16 v[36:39], a[24:27], v[116:119], v[36:39]
    buffer_load_dwordx4 v[104:107], v226, s[24:27], s46 offen sc1
    v_mfma_f32_16x16x32_bf16 v[40:43], a[24:27], v[120:123], v[40:43]
    v_mfma_f32_16x16x32_bf16 v[44:47], a[24:27], v[124:127], v[44:47]
    v_mfma_f32_16x16x32_bf16 v[48:51], a[28:31], v[112:115], v[48:51]
    buffer_load_dwordx4 v[108:111], v227, s[24:27], s46 offen sc1
    v_mfma_f32_16x16x32_bf16 v[52:55], a[28:31], v[116:119], v[52:55]
    v_mfma_f32_16x16x32_bf16 v[56:59], a[28:31], v[120:123], v[56:59]
    v_mfma_f32_16x16x32_bf16 v[60:63], a[28:31], v[124:127], v[60:63]
    s_waitcnt vmcnt(16)
    v_mfma_f32_16x16x32_bf16 v[0:3], a[32:35], v[128:131], v[0:3]
    s_mov_b32 s46, 110592
    v_mfma_f32_16x16x32_bf16 v[4:7], a[32:35], v[132:135], v[4:7]
    v_mfma_f32_16x16x32_bf16 v[8:11], a[32:35], v[136:139], v[8:11]
    v_mfma_f32_16x16x32_bf16 v[12:15], a[32:35], v[140:143], v[12:15]
    buffer_load_dwordx4 v[112:115], v224, s[24:27], s46 offen sc1
    v_mfma_f32_16x16x32_bf16 v[16:19], a[36:39], v[128:131], v[16:19]
    v_mfma_f32_16x16x32_bf16 v[20:23], a[36:39], v[132:135], v[20:23]
    v_mfma_f32_16x16x32_bf16 v[24:27], a[36:39], v[136:139], v[24:27]
    buffer_load_dwordx4 v[116:119], v225, s[24:27], s46 offen sc1
    v_mfma_f32_16x16x32_bf16 v[28:31], a[36:39], v[140:143], v[28:31]
    v_mfma_f32_16x16x32_bf16 v[32:35], a[40:43], v[128:131], v[32:35]
    v_mfma_f32_16x16x32_bf16 v[36:39], a[40:43], v[132:135], v[36:39]
    buffer_load_dwordx4 v[120:123], v226, s[24:27], s46 offen sc1
    v_mfma_f32_16x16x32_bf16 v[40:43], a[40:43], v[136:139], v[40:43]
    v_mfma_f32_16x16x32_bf16 v[44:47], a[40:43], v[140:143], v[44:47]
    v_mfma_f32_16x16x32_bf16 v[48:51], a[44:47], v[128:131], v[48:51]
    buffer_load_dwordx4 v[124:127], v227, s[24:27], s46 offen sc1
    v_mfma_f32_16x16x32_bf16 v[52:55], a[44:47], v[132:135], v[52:55]
    v_mfma_f32_16x16x32_bf16 v[56:59], a[44:47], v[136:139], v[56:59]
    v_mfma_f32_16x16x32_bf16 v[60:63], a[44:47], v[140:143], v[60:63]
    s_waitcnt vmcnt(16)
    v_mfma_f32_16x16x32_bf16 v[0:3], a[48:51], v[144:147], v[0:3]
    s_mov_b32 s46, 114688
    v_mfma_f32_16x16x32_bf16 v[4:7], a[48:51], v[148:151], v[4:7]
    v_mfma_f32_16x16x32_bf16 v[8:11], a[48:51], v[152:155], v[8:11]
    v_mfma_f32_16x16x32_bf16 v[12:15], a[48:51], v[156:159], v[12:15]
    buffer_load_dwordx4 v[128:131], v224, s[24:27], s46 offen sc1
    v_mfma_f32_16x16x32_bf16 v[16:19], a[52:55], v[144:147], v[16:19]
    v_mfma_f32_16x16x32_bf16 v[20:23], a[52:55], v[148:151], v[20:23]
    v_mfma_f32_16x16x32_bf16 v[24:27], a[52:55], v[152:155], v[24:27]
    buffer_load_dwordx4 v[132:135], v225, s[24:27], s46 offen sc1
    v_mfma_f32_16x16x32_bf16 v[28:31], a[52:55], v[156:159], v[28:31]
    v_mfma_f32_16x16x32_bf16 v[32:35], a[56:59], v[144:147], v[32:35]
    v_mfma_f32_16x16x32_bf16 v[36:39], a[56:59], v[148:151], v[36:39]
    buffer_load_dwordx4 v[136:139], v226, s[24:27], s46 offen sc1
    v_mfma_f32_16x16x32_bf16 v[40:43], a[56:59], v[152:155], v[40:43]
    v_mfma_f32_16x16x32_bf16 v[44:47], a[56:59], v[156:159], v[44:47]
    v_mfma_f32_16x16x32_bf16 v[48:51], a[60:63], v[144:147], v[48:51]
    buffer_load_dwordx4 v[140:143], v227, s[24:27], s46 offen sc1
    v_mfma_f32_16x16x32_bf16 v[52:55], a[60:63], v[148:151], v[52:55]
    v_mfma_f32_16x16x32_bf16 v[56:59], a[60:63], v[152:155], v[56:59]
    v_mfma_f32_16x16x32_bf16 v[60:63], a[60:63], v[156:159], v[60:63]
    s_waitcnt vmcnt(16)
    v_mfma_f32_16x16x32_bf16 v[0:3], a[64:67], v[64:67], v[0:3]
    s_mov_b32 s46, 118784
    v_mfma_f32_16x16x32_bf16 v[4:7], a[64:67], v[68:71], v[4:7]
    v_mfma_f32_16x16x32_bf16 v[8:11], a[64:67], v[72:75], v[8:11]
    v_mfma_f32_16x16x32_bf16 v[12:15], a[64:67], v[76:79], v[12:15]
    buffer_load_dwordx4 v[144:147], v224, s[24:27], s46 offen sc1
    v_mfma_f32_16x16x32_bf16 v[16:19], a[68:71], v[64:67], v[16:19]
    v_mfma_f32_16x16x32_bf16 v[20:23], a[68:71], v[68:71], v[20:23]
    v_mfma_f32_16x16x32_bf16 v[24:27], a[68:71], v[72:75], v[24:27]
    buffer_load_dwordx4 v[148:151], v225, s[24:27], s46 offen sc1
    v_mfma_f32_16x16x32_bf16 v[28:31], a[68:71], v[76:79], v[28:31]
    v_mfma_f32_16x16x32_bf16 v[32:35], a[72:75], v[64:67], v[32:35]
    v_mfma_f32_16x16x32_bf16 v[36:39], a[72:75], v[68:71], v[36:39]
    buffer_load_dwordx4 v[152:155], v226, s[24:27], s46 offen sc1
    v_mfma_f32_16x16x32_bf16 v[40:43], a[72:75], v[72:75], v[40:43]
    v_mfma_f32_16x16x32_bf16 v[44:47], a[72:75], v[76:79], v[44:47]
    v_mfma_f32_16x16x32_bf16 v[48:51], a[76:79], v[64:67], v[48:51]
    buffer_load_dwordx4 v[156:159], v227, s[24:27], s46 offen sc1
    v_mfma_f32_16x16x32_bf16 v[52:55], a[76:79], v[68:71], v[52:55]
    v_mfma_f32_16x16x32_bf16 v[56:59], a[76:79], v[72:75], v[56:59]
    v_mfma_f32_16x16x32_bf16 v[60:63], a[76:79], v[76:79], v[60:63]
    s_waitcnt vmcnt(16)
    v_mfma_f32_16x16x32_bf16 v[0:3], a[80:83], v[80:83], v[0:3]
    s_mov_b32 s46, 122880
    v_mfma_f32_16x16x32_bf16 v[4:7], a[80:83], v[84:87], v[4:7]
    v_mfma_f32_16x16x32_bf16 v[8:11], a[80:83], v[88:91], v[8:11]
    v_mfma_f32_16x16x32_bf16 v[12:15], a[80:83], v[92:95], v[12:15]
    buffer_load_dwordx4 v[64:67], v224, s[24:27], s46 offen sc1
    v_mfma_f32_16x16x32_bf16 v[16:19], a[84:87], v[80:83], v[16:19]
    v_mfma_f32_16x16x32_bf16 v[20:23], a[84:87], v[84:87], v[20:23]
    v_mfma_f32_16x16x32_bf16 v[24:27], a[84:87], v[88:91], v[24:27]
    buffer_load_dwordx4 v[68:71], v225, s[24:27], s46 offen sc1
    v_mfma_f32_16x16x32_bf16 v[28:31], a[84:87], v[92:95], v[28:31]
    v_mfma_f32_16x16x32_bf16 v[32:35], a[88:91], v[80:83], v[32:35]
    v_mfma_f32_16x16x32_bf16 v[36:39], a[88:91], v[84:87], v[36:39]
    buffer_load_dwordx4 v[72:75], v226, s[24:27], s46 offen sc1
    v_mfma_f32_16x16x32_bf16 v[40:43], a[88:91], v[88:91], v[40:43]
    v_mfma_f32_16x16x32_bf16 v[44:47], a[88:91], v[92:95], v[44:47]
    v_mfma_f32_16x16x32_bf16 v[48:51], a[92:95], v[80:83], v[48:51]
    buffer_load_dwordx4 v[76:79], v227, s[24:27], s46 offen sc1
    v_mfma_f32_16x16x32_bf16 v[52:55], a[92:95], v[84:87], v[52:55]
    v_mfma_f32_16x16x32_bf16 v[56:59], a[92:95], v[88:91], v[56:59]
    v_mfma_f32_16x16x32_bf16 v[60:63], a[92:95], v[92:95], v[60:63]
    s_waitcnt vmcnt(16)
    v_mfma_f32_16x16x32_bf16 v[0:3], a[96:99], v[96:99], v[0:3]
    s_mov_b32 s46, 126976
    v_mfma_f32_16x16x32_bf16 v[4:7], a[96:99], v[100:103], v[4:7]
    v_mfma_f32_16x16x32_bf16 v[8:11], a[96:99], v[104:107], v[8:11]
    v_mfma_f32_16x16x32_bf16 v[12:15], a[96:99], v[108:111], v[12:15]
    buffer_load_dwordx4 v[80:83], v224, s[24:27], s46 offen sc1
    v_mfma_f32_16x16x32_bf16 v[16:19], a[100:103], v[96:99], v[16:19]
    v_mfma_f32_16x16x32_bf16 v[20:23], a[100:103], v[100:103], v[20:23]
    v_mfma_f32_16x16x32_bf16 v[24:27], a[100:103], v[104:107], v[24:27]
    buffer_load_dwordx4 v[84:87], v225, s[24:27], s46 offen sc1
    v_mfma_f32_16x16x32_bf16 v[28:31], a[100:103], v[108:111], v[28:31]
    v_mfma_f32_16x16x32_bf16 v[32:35], a[104:107], v[96:99], v[32:35]
    v_mfma_f32_16x16x32_bf16 v[36:39], a[104:107], v[100:103], v[36:39]
    buffer_load_dwordx4 v[88:91], v226, s[24:27], s46 offen sc1
    v_mfma_f32_16x16x32_bf16 v[40:43], a[104:107], v[104:107], v[40:43]
    v_mfma_f32_16x16x32_bf16 v[44:47], a[104:107], v[108:111], v[44:47]
    v_mfma_f32_16x16x32_bf16 v[48:51], a[108:111], v[96:99], v[48:51]
    buffer_load_dwordx4 v[92:95], v227, s[24:27], s46 offen sc1
    v_mfma_f32_16x16x32_bf16 v[52:55], a[108:111], v[100:103], v[52:55]
    v_mfma_f32_16x16x32_bf16 v[56:59], a[108:111], v[104:107], v[56:59]
    v_mfma_f32_16x16x32_bf16 v[60:63], a[108:111], v[108:111], v[60:63]
    s_waitcnt vmcnt(16)
    v_mfma_f32_16x16x32_bf16 v[0:3], a[112:115], v[112:115], v[0:3]
    v_mfma_f32_16x16x32_bf16 v[4:7], a[112:115], v[116:119], v[4:7]
    v_mfma_f32_16x16x32_bf16 v[8:11], a[112:115], v[120:123], v[8:11]
    v_mfma_f32_16x16x32_bf16 v[12:15], a[112:115], v[124:127], v[12:15]
    v_mfma_f32_16x16x32_bf16 v[16:19], a[116:119], v[112:115], v[16:19]
    v_mfma_f32_16x16x32_bf16 v[20:23], a[116:119], v[116:119], v[20:23]
    v_mfma_f32_16x16x32_bf16 v[24:27], a[116:119], v[120:123], v[24:27]
    v_mfma_f32_16x16x32_bf16 v[28:31], a[116:119], v[124:127], v[28:31]
    v_mfma_f32_16x16x32_bf16 v[32:35], a[120:123], v[112:115], v[32:35]
    v_mfma_f32_16x16x32_bf16 v[36:39], a[120:123], v[116:119], v[36:39]
    v_mfma_f32_16x16x32_bf16 v[40:43], a[120:123], v[120:123], v[40:43]
    v_mfma_f32_16x16x32_bf16 v[44:47], a[120:123], v[124:127], v[44:47]
    v_mfma_f32_16x16x32_bf16 v[48:51], a[124:127], v[112:115], v[48:51]
    v_mfma_f32_16x16x32_bf16 v[52:55], a[124:127], v[116:119], v[52:55]
    v_mfma_f32_16x16x32_bf16 v[56:59], a[124:127], v[120:123], v[56:59]
    v_mfma_f32_16x16x32_bf16 v[60:63], a[124:127], v[124:127], v[60:63]
    s_waitcnt vmcnt(12)
    v_mfma_f32_16x16x32_bf16 v[0:3], a[128:131], v[128:131], v[0:3]
    v_mfma_f32_16x16x32_bf16 v[4:7], a[128:131], v[132:135], v[4:7]
    v_mfma_f32_16x16x32_bf16 v[8:11], a[128:131], v[136:139], v[8:11]
    v_mfma_f32_16x16x32_bf16 v[12:15], a[128:131], v[140:143], v[12:15]
    v_mfma_f32_16x16x32_bf16 v[16:19], a[132:135], v[128:131], v[16:19]
    v_mfma_f32_16x16x32_bf16 v[20:23], a[132:135], v[132:135], v[20:23]
    v_mfma_f32_16x16x32_bf16 v[24:27], a[132:135], v[136:139], v[24:27]
    v_mfma_f32_16x16x32_bf16 v[28:31], a[132:135], v[140:143], v[28:31]
    v_mfma_f32_16x16x32_bf16 v[32:35], a[136:139], v[128:131], v[32:35]
    v_mfma_f32_16x16x32_bf16 v[36:39], a[136:139], v[132:135], v[36:39]
    v_mfma_f32_16x16x32_bf16 v[40:43], a[136:139], v[136:139], v[40:43]
    v_mfma_f32_16x16x32_bf16 v[44:47], a[136:139], v[140:143], v[44:47]
    v_mfma_f32_16x16x32_bf16 v[48:51], a[140:143], v[128:131], v[48:51]
    v_mfma_f32_16x16x32_bf16 v[52:55], a[140:143], v[132:135], v[52:55]
    v_mfma_f32_16x16x32_bf16 v[56:59], a[140:143], v[136:139], v[56:59]
    v_mfma_f32_16x16x32_bf16 v[60:63], a[140:143], v[140:143], v[60:63]
    s_waitcnt vmcnt(8)
    v_mfma_f32_16x16x32_bf16 v[0:3], a[144:147], v[144:147], v[0:3]
    v_mfma_f32_16x16x32_bf16 v[4:7], a[144:147], v[148:151], v[4:7]
    v_mfma_f32_16x16x32_bf16 v[8:11], a[144:147], v[152:155], v[8:11]
    v_mfma_f32_16x16x32_bf16 v[12:15], a[144:147], v[156:159], v[12:15]
    v_mfma_f32_16x16x32_bf16 v[16:19], a[148:151], v[144:147], v[16:19]
    v_mfma_f32_16x16x32_bf16 v[20:23], a[148:151], v[148:151], v[20:23]
    v_mfma_f32_16x16x32_bf16 v[24:27], a[148:151], v[152:155], v[24:27]
    v_mfma_f32_16x16x32_bf16 v[28:31], a[148:151], v[156:159], v[28:31]
    v_mfma_f32_16x16x32_bf16 v[32:35], a[152:155], v[144:147], v[32:35]
    v_mfma_f32_16x16x32_bf16 v[36:39], a[152:155], v[148:151], v[36:39]
    v_mfma_f32_16x16x32_bf16 v[40:43], a[152:155], v[152:155], v[40:43]
    v_mfma_f32_16x16x32_bf16 v[44:47], a[152:155], v[156:159], v[44:47]
    v_mfma_f32_16x16x32_bf16 v[48:51], a[156:159], v[144:147], v[48:51]
    v_mfma_f32_16x16x32_bf16 v[52:55], a[156:159], v[148:151], v[52:55]
    v_mfma_f32_16x16x32_bf16 v[56:59], a[156:159], v[152:155], v[56:59]
    v_mfma_f32_16x16x32_bf16 v[60:63], a[156:159], v[156:159], v[60:63]
    s_waitcnt vmcnt(4)
    v_mfma_f32_16x16x32_bf16 v[0:3], a[160:163], v[64:67], v[0:3]
    v_mfma_f32_16x16x32_bf16 v[4:7], a[160:163], v[68:71], v[4:7]
    v_mfma_f32_16x16x32_bf16 v[8:11], a[160:163], v[72:75], v[8:11]
    v_mfma_f32_16x16x32_bf16 v[12:15], a[160:163], v[76:79], v[12:15]
    v_mfma_f32_16x16x32_bf16 v[16:19], a[164:167], v[64:67], v[16:19]
    v_mfma_f32_16x16x32_bf16 v[20:23], a[164:167], v[68:71], v[20:23]
    v_mfma_f32_16x16x32_bf16 v[24:27], a[164:167], v[72:75], v[24:27]
    v_mfma_f32_16x16x32_bf16 v[28:31], a[164:167], v[76:79], v[28:31]
    v_mfma_f32_16x16x32_bf16 v[32:35], a[168:171], v[64:67], v[32:35]
    v_mfma_f32_16x16x32_bf16 v[36:39], a[168:171], v[68:71], v[36:39]
    v_mfma_f32_16x16x32_bf16 v[40:43], a[168:171], v[72:75], v[40:43]
    v_mfma_f32_16x16x32_bf16 v[44:47], a[168:171], v[76:79], v[44:47]
    v_mfma_f32_16x16x32_bf16 v[48:51], a[172:175], v[64:67], v[48:51]
    v_mfma_f32_16x16x32_bf16 v[52:55], a[172:175], v[68:71], v[52:55]
    v_mfma_f32_16x16x32_bf16 v[56:59], a[172:175], v[72:75], v[56:59]
    v_mfma_f32_16x16x32_bf16 v[60:63], a[172:175], v[76:79], v[60:63]
    s_waitcnt vmcnt(0)
    v_mfma_f32_16x16x32_bf16 v[0:3], a[176:179], v[80:83], v[0:3]
    v_mfma_f32_16x16x32_bf16 v[4:7], a[176:179], v[84:87], v[4:7]
    v_mfma_f32_16x16x32_bf16 v[8:11], a[176:179], v[88:91], v[8:11]
    v_mfma_f32_16x16x32_bf16 v[12:15], a[176:179], v[92:95], v[12:15]
    v_mfma_f32_16x16x32_bf16 v[16:19], a[180:183], v[80:83], v[16:19]
    v_mfma_f32_16x16x32_bf16 v[20:23], a[180:183], v[84:87], v[20:23]
    v_mfma_f32_16x16x32_bf16 v[24:27], a[180:183], v[88:91], v[24:27]
    v_mfma_f32_16x16x32_bf16 v[28:31], a[180:183], v[92:95], v[28:31]
    v_mfma_f32_16x16x32_bf16 v[32:35], a[184:187], v[80:83], v[32:35]
    v_mfma_f32_16x16x32_bf16 v[36:39], a[184:187], v[84:87], v[36:39]
    v_mfma_f32_16x16x32_bf16 v[40:43], a[184:187], v[88:91], v[40:43]
    v_mfma_f32_16x16x32_bf16 v[44:47], a[184:187], v[92:95], v[44:47]
    v_mfma_f32_16x16x32_bf16 v[48:51], a[188:191], v[80:83], v[48:51]
    v_mfma_f32_16x16x32_bf16 v[52:55], a[188:191], v[84:87], v[52:55]
    v_mfma_f32_16x16x32_bf16 v[56:59], a[188:191], v[88:91], v[56:59]
    v_mfma_f32_16x16x32_bf16 v[60:63], a[188:191], v[92:95], v[60:63]
    s_lshl_b32 s3, s32, 14
    v_add_u32 v228, s3, v251
    s_lshl_b32 s3, s32, 12
    v_add_u32 v229, s3, v251
    s_nop 7
    s_barrier
    ds_write_b128 v228, v[0:3] offset:0
    ds_write_b128 v228, v[4:7] offset:1024
    ds_write_b128 v228, v[8:11] offset:2048
    ds_write_b128 v228, v[12:15] offset:3072
    ds_write_b128 v228, v[16:19] offset:4096
    ds_write_b128 v228, v[20:23] offset:5120
    ds_write_b128 v228, v[24:27] offset:6144
    ds_write_b128 v228, v[28:31] offset:7168
    ds_write_b128 v228, v[32:35] offset:8192
    ds_write_b128 v228, v[36:39] offset:9216
    ds_write_b128 v228, v[40:43] offset:10240
    ds_write_b128 v228, v[44:47] offset:11264
    ds_write_b128 v228, v[48:51] offset:12288
    ds_write_b128 v228, v[52:55] offset:13312
    ds_write_b128 v228, v[56:59] offset:14336
    ds_write_b128 v228, v[60:63] offset:15360
    s_lshl_b32 s3, s42, 6
    s_mul_i32 s3, s3, 1280
    s_lshl_b32 s46, s43, 7
    s_add_u32 s3, s3, s46
    s_lshl_b32 s45, s32, 5
    s_add_u32 s3, s3, s45
    v_and_b32 v64, 15, v253
    v_mul_u32_u24 v64, 1280, v64
    v_lshrrev_b32 v65, 4, v253
    v_lshl_add_u32 v64, v65, 3, v64
    v_add_u32 v64, s3, v64
    v_add_u32 v65, 20480, v64
    v_add_u32 v66, 40960, v64
    v_add_u32 v67, 61440, v64
    s_waitcnt lgkmcnt(0)
    s_barrier
    ds_read_b128 v[0:3], v229 offset:0
    ds_read_b128 v[16:19], v229 offset:16384
    ds_read_b128 v[32:35], v229 offset:32768
    ds_read_b128 v[48:51], v229 offset:49152
    ds_read_b128 v[4:7], v229 offset:1024
    ds_read_b128 v[20:23], v229 offset:17408
    ds_read_b128 v[36:39], v229 offset:33792
    ds_read_b128 v[52:55], v229 offset:50176
    ds_read_b128 v[8:11], v229 offset:2048
    ds_read_b128 v[24:27], v229 offset:18432
    ds_read_b128 v[40:43], v229 offset:34816
    ds_read_b128 v[56:59], v229 offset:51200
    ds_read_b128 v[12:15], v229 offset:3072
    ds_read_b128 v[28:31], v229 offset:19456
    ds_read_b128 v[44:47], v229 offset:35840
    ds_read_b128 v[60:63], v229 offset:52224
    s_waitcnt lgkmcnt(12)
    v_pk_add_f32 v[0:1], v[0:1], v[16:17]
    v_pk_add_f32 v[32:33], v[32:33], v[48:49]
    v_pk_add_f32 v[2:3], v[2:3], v[18:19]
    v_pk_add_f32 v[34:35], v[34:35], v[50:51]
    v_pk_add_f32 v[0:1], v[0:1], v[32:33]
    v_pk_add_f32 v[2:3], v[2:3], v[34:35]
    v_cvt_pk_bf16_f32 v68, v0, v1
    v_cvt_pk_bf16_f32 v69, v2, v3
    buffer_store_dwordx2 v[68:69], v64, s[96:99], 0 offen
    s_waitcnt lgkmcnt(8)
    v_pk_add_f32 v[4:5], v[4:5], v[20:21]
    v_pk_add_f32 v[36:37], v[36:37], v[52:53]
    v_pk_add_f32 v[6:7], v[6:7], v[22:23]
    v_pk_add_f32 v[38:39], v[38:39], v[54:55]
    v_pk_add_f32 v[4:5], v[4:5], v[36:37]
    v_pk_add_f32 v[6:7], v[6:7], v[38:39]
    v_cvt_pk_bf16_f32 v70, v4, v5
    v_cvt_pk_bf16_f32 v71, v6, v7
    buffer_store_dwordx2 v[70:71], v65, s[96:99], 0 offen
    s_waitcnt lgkmcnt(4)
    v_pk_add_f32 v[8:9], v[8:9], v[24:25]
    v_pk_add_f32 v[40:41], v[40:41], v[56:57]
    v_pk_add_f32 v[10:11], v[10:11], v[26:27]
    v_pk_add_f32 v[42:43], v[42:43], v[58:59]
    v_pk_add_f32 v[8:9], v[8:9], v[40:41]
    v_pk_add_f32 v[10:11], v[10:11], v[42:43]
    v_cvt_pk_bf16_f32 v72, v8, v9
    v_cvt_pk_bf16_f32 v73, v10, v11
    buffer_store_dwordx2 v[72:73], v66, s[96:99], 0 offen
    s_waitcnt lgkmcnt(0)
    v_pk_add_f32 v[12:13], v[12:13], v[28:29]
    v_pk_add_f32 v[44:45], v[44:45], v[60:61]
    v_pk_add_f32 v[14:15], v[14:15], v[30:31]
    v_pk_add_f32 v[46:47], v[46:47], v[62:63]
    v_pk_add_f32 v[12:13], v[12:13], v[44:45]
    v_pk_add_f32 v[14:15], v[14:15], v[46:47]
    v_cvt_pk_bf16_f32 v74, v12, v13
    v_cvt_pk_bf16_f32 v75, v14, v15
    buffer_store_dwordx2 v[74:75], v67, s[96:99], 0 offen
    s_branch L1_end
L1_notile:
    s_waitcnt vmcnt(0)
    s_barrier
    s_cmp_lg_u32 s32, 0
    s_cbranch_scc1 L_nosig_36
    s_lshl_b32 s3, s33, 5
    v_mov_b32 v254, s3
    v_mov_b32 v255, 1
    s_mov_b64 exec, 1
    global_atomic_add v254, v255, s[28:29] sc1
    s_mov_b64 exec, -1
    L_nosig_36:
L1_end:
    s_endpgm
L_stub_1:
    s_call_b64 s[54:55], L_slow0
    s_branch L_ret_2
L_stub_3:
    s_call_b64 s[54:55], L_slow1
    s_branch L_ret_4
L_stub_5:
    s_call_b64 s[54:55], L_slow0
    s_branch L_ret_6
L_stub_7:
    s_call_b64 s[54:55], L_slow1
    s_branch L_ret_8
L_stub_9:
    s_call_b64 s[54:55], L_slow0
    s_branch L_ret_10
L_stub_11:
    s_call_b64 s[54:55], L_slow1
    s_branch L_ret_12
L_stub_13:
    s_call_b64 s[54:55], L_slow0
    s_branch L_ret_14
L_stub_15:
    s_call_b64 s[54:55], L_slow1
    s_branch L_ret_16
L_stub_17:
    s_call_b64 s[54:55], L_slow0
    s_branch L_ret_18
L_stub_19:
    s_call_b64 s[54:55], L_slow1
    s_branch L_ret_20
L_stub_21:
    s_call_b64 s[54:55], L_slow0
    s_branch L_ret_22
L_stub_23:
    s_call_b64 s[54:55], L_slow1
    s_branch L_ret_24
L_stub_25:
    s_call_b64 s[54:55], L_slow0
    s_branch L_ret_26
L_stub_27:
    s_call_b64 s[54:55], L_slow1
    s_branch L_ret_28
L_stub_29:
    s_call_b64 s[54:55], L_slow0
    s_branch L_ret_30
L_stub_31:
    s_call_b64 s[54:55], L_slow1
    s_branch L_ret_32
L_slow0:
    v_max3_f32 v226, v96, v97, v98
    v_max3_f32 v226, v226, v99, v108
    v_max3_f32 v226, v226, v109, v110
    v_max_f32 v226, v226, v111
    v_max3_f32 v227, v100, v101, v102
    v_max3_f32 v227, v227, v103, v112
    v_max3_f32 v227, v227, v113, v114
    v_max_f32 v227, v227, v115
    v_max3_f32 v228, v104, v105, v106
    v_max3_f32 v228, v228, v107, v116
    v_max3_f32 v228, v228, v117, v118
    v_max_f32 v228, v228, v119
    v_mov_b32 v229, v226
    v_mov_b32 v230, v227
    v_mov_b32 v231, v228
    s_nop 1
    v_permlane16_swap_b32 v226, v229
    v_permlane16_swap_b32 v227, v230
    v_permlane16_swap_b32 v228, v231
    v_max_f32 v226, v226, v229
    v_max_f32 v227, v227, v230
    v_max_f32 v228, v228, v231
    v_mov_b32 v229, v226
    v_mov_b32 v230, v227
    v_mov_b32 v231, v228
    s_nop 1
    v_permlane32_swap_b32 v226, v229
    v_permlane32_swap_b32 v227, v230
    v_permlane32_swap_b32 v228, v231
    v_max_f32 v226, v226, v229
    v_max_f32 v227, v227, v230
    v_max_f32 v228, v228, v231
    v_max_f32 v226, 0, v226
    v_max_f32 v227, 0, v227
    v_max_f32 v228, 0, v228
    v_exp_f32 v229, -v226
    v_exp_f32 v230, -v227
    v_exp_f32 v231, -v228
    v_sub_f32 v96, v96, v226
    v_sub_f32 v97, v97, v226
    v_sub_f32 v98, v98, v226
    v_sub_f32 v99, v99, v226
    v_sub_f32 v108, v108, v226
    v_sub_f32 v109, v109, v226
    v_sub_f32 v110, v110, v226
    v_sub_f32 v111, v111, v226
    v_sub_f32 v168, v168, v226
    v_sub_f32 v169, v169, v226
    v_sub_f32 v170, v170, v226
    v_sub_f32 v171, v171, v226
    v_mul_f32 v192, v192, v229
    v_mul_f32 v0, v0, v229
    v_mul_f32 v1, v1, v229
    v_mul_f32 v2, v2, v229
    v_mul_f32 v3, v3, v229
    v_mul_f32 v24, v24, v229
    v_mul_f32 v25, v25, v229
    v_mul_f32 v26, v26, v229
    v_mul_f32 v27, v27, v229
    v_mul_f32 v48, v48, v229
    v_mul_f32 v49, v49, v229
    v_mul_f32 v50, v50, v229
    v_mul_f32 v51, v51, v229
    v_mul_f32 v72, v72, v229
    v_mul_f32 v73, v73, v229
    v_mul_f32 v74, v74, v229
    v_mul_f32 v75, v75, v229
    v_accvgpr_read_b32 v234, a0
    v_accvgpr_read_b32 v235, a1
    v_accvgpr_read_b32 v236, a2
    v_accvgpr_read_b32 v237, a3
    v_mul_f32 v234, v234, v229
    v_mul_f32 v235, v235, v229
    v_mul_f32 v236, v236, v229
    v_mul_f32 v237, v237, v229
    v_accvgpr_write_b32 a0, v234
    v_accvgpr_write_b32 a1, v235
    v_accvgpr_write_b32 a2, v236
    v_accvgpr_write_b32 a3, v237
    v_accvgpr_read_b32 v234, a24
    v_accvgpr_read_b32 v235, a25
    v_accvgpr_read_b32 v236, a26
    v_accvgpr_read_b32 v237, a27
    v_mul_f32 v234, v234, v229
    v_mul_f32 v235, v235, v229
    v_mul_f32 v236, v236, v229
    v_mul_f32 v237, v237, v229
    v_accvgpr_write_b32 a24, v234
    v_accvgpr_write_b32 a25, v235
    v_accvgpr_write_b32 a26, v236
    v_accvgpr_write_b32 a27, v237
    v_accvgpr_read_b32 v234, a48
    v_accvgpr_read_b32 v235, a49
    v_accvgpr_read_b32 v236, a50
    v_accvgpr_read_b32 v237, a51
    v_mul_f32 v234, v234, v229
    v_mul_f32 v235, v235, v229
    v_mul_f32 v236, v236, v229
    v_mul_f32 v237, v237, v229
    v_accvgpr_write_b32 a48, v234
    v_accvgpr_write_b32 a49, v235
    v_accvgpr_write_b32 a50, v236
    v_accvgpr_write_b32 a51, v237
    v_accvgpr_read_b32 v234, a72
    v_accvgpr_read_b32 v235, a73
    v_accvgpr_read_b32 v236, a74
    v_accvgpr_read_b32 v237, a75
    v_mul_f32 v234, v234, v229
    v_mul_f32 v235, v235, v229
    v_mul_f32 v236, v236, v229
    v_mul_f32 v237, v237, v229
    v_accvgpr_write_b32 a72, v234
    v_accvgpr_write_b32 a73, v235
    v_accvgpr_write_b32 a74, v236
    v_accvgpr_write_b32 a75, v237
    v_sub_f32 v100, v100, v227
    v_sub_f32 v101, v101, v227
    v_sub_f32 v102, v102, v227
    v_sub_f32 v103, v103, v227
    v_sub_f32 v112, v112, v227
    v_sub_f32 v113, v113, v227
    v_sub_f32 v114, v114, v227
    v_sub_f32 v115, v115, v227
    v_sub_f32 v172, v172, v227
    v_sub_f32 v173, v173, v227
    v_sub_f32 v174, v174, v227
    v_sub_f32 v175, v175, v227
    v_mul_f32 v193, v193, v230
    v_mul_f32 v4, v4, v230
    v_mul_f32 v5, v5, v230
    v_mul_f32 v6, v6, v230
    v_mul_f32 v7, v7, v230
    v_mul_f32 v28, v28, v230
    v_mul_f32 v29, v29, v230
    v_mul_f32 v30, v30, v230
    v_mul_f32 v31, v31, v230
    v_mul_f32 v52, v52, v230
    v_mul_f32 v53, v53, v230
    v_mul_f32 v54, v54, v230
    v_mul_f32 v55, v55, v230
    v_mul_f32 v76, v76, v230
    v_mul_f32 v77, v77, v230
    v_mul_f32 v78, v78, v230
    v_mul_f32 v79, v79, v230
    v_accvgpr_read_b32 v234, a4
    v_accvgpr_read_b32 v235, a5
    v_accvgpr_read_b32 v236, a6
    v_accvgpr_read_b32 v237, a7
    v_mul_f32 v234, v234, v230
    v_mul_f32 v235, v235, v230
    v_mul_f32 v236, v236, v230
    v_mul_f32 v237, v237, v230
    v_accvgpr_write_b32 a4, v234
    v_accvgpr_write_b32 a5, v235
    v_accvgpr_write_b32 a6, v236
    v_accvgpr_write_b32 a7, v237
    v_accvgpr_read_b32 v234, a28
    v_accvgpr_read_b32 v235, a29
    v_accvgpr_read_b32 v236, a30
    v_accvgpr_read_b32 v237, a31
    v_mul_f32 v234, v234, v230
    v_mul_f32 v235, v235, v230
    v_mul_f32 v236, v236, v230
    v_mul_f32 v237, v237, v230
    v_accvgpr_write_b32 a28, v234
    v_accvgpr_write_b32 a29, v235
    v_accvgpr_write_b32 a30, v236
    v_accvgpr_write_b32 a31, v237
    v_accvgpr_read_b32 v234, a52
    v_accvgpr_read_b32 v235, a53
    v_accvgpr_read_b32 v236, a54
    v_accvgpr_read_b32 v237, a55
    v_mul_f32 v234, v234, v230
    v_mul_f32 v235, v235, v230
    v_mul_f32 v236, v236, v230
    v_mul_f32 v237, v237, v230
    v_accvgpr_write_b32 a52, v234
    v_accvgpr_write_b32 a53, v235
    v_accvgpr_write_b32 a54, v236
    v_accvgpr_write_b32 a55, v237
    v_accvgpr_read_b32 v234, a76
    v_accvgpr_read_b32 v235, a77
    v_accvgpr_read_b32 v236, a78
    v_accvgpr_read_b32 v237, a79
    v_mul_f32 v234, v234, v230
    v_mul_f32 v235, v235, v230
    v_mul_f32 v236, v236, v230
    v_mul_f32 v237, v237, v230
    v_accvgpr_write_b32 a76, v234
    v_accvgpr_write_b32 a77, v235
    v_accvgpr_write_b32 a78, v236
    v_accvgpr_write_b32 a79, v237
    v_sub_f32 v104, v104, v228
    v_sub_f32 v105, v105, v228
    v_sub_f32 v106, v106, v228
    v_sub_f32 v107, v107, v228
    v_sub_f32 v116, v116, v228
    v_sub_f32 v117, v117, v228
    v_sub_f32 v118, v118, v228
    v_sub_f32 v119, v119, v228
    v_sub_f32 v176, v176, v228
    v_sub_f32 v177, v177, v228
    v_sub_f32 v178, v178, v228
    v_sub_f32 v179, v179, v228
    v_mul_f32 v194, v194, v231
    v_mul_f32 v8, v8, v231
    v_mul_f32 v9, v9, v231
    v_mul_f32 v10, v10, v231
    v_mul_f32 v11, v11, v231
    v_mul_f32 v32, v32, v231
    v_mul_f32 v33, v33, v231
    v_mul_f32 v34, v34, v231
    v_mul_f32 v35, v35, v231
    v_mul_f32 v56, v56, v231
    v_mul_f32 v57, v57, v231
    v_mul_f32 v58, v58, v231
    v_mul_f32 v59, v59, v231
    v_mul_f32 v80, v80, v231
    v_mul_f32 v81, v81, v231
    v_mul_f32 v82, v82, v231
    v_mul_f32 v83, v83, v231
    v_accvgpr_read_b32 v234, a8
    v_accvgpr_read_b32 v235, a9
    v_accvgpr_read_b32 v236, a10
    v_accvgpr_read_b32 v237, a11
    v_mul_f32 v234, v234, v231
    v_mul_f32 v235, v235, v231
    v_mul_f32 v236, v236, v231
    v_mul_f32 v237, v237, v231
    v_accvgpr_write_b32 a8, v234
    v_accvgpr_write_b32 a9, v235
    v_accvgpr_write_b32 a10, v236
    v_accvgpr_write_b32 a11, v237
    v_accvgpr_read_b32 v234, a32
    v_accvgpr_read_b32 v235, a33
    v_accvgpr_read_b32 v236, a34
    v_accvgpr_read_b32 v237, a35
    v_mul_f32 v234, v234, v231
    v_mul_f32 v235, v235, v231
    v_mul_f32 v236, v236, v231
    v_mul_f32 v237, v237, v231
    v_accvgpr_write_b32 a32, v234
    v_accvgpr_write_b32 a33, v235
    v_accvgpr_write_b32 a34, v236
    v_accvgpr_write_b32 a35, v237
    v_accvgpr_read_b32 v234, a56
    v_accvgpr_read_b32 v235, a57
    v_accvgpr_read_b32 v236, a58
    v_accvgpr_read_b32 v237, a59
    v_mul_f32 v234, v234, v231
    v_mul_f32 v235, v235, v231
    v_mul_f32 v236, v236, v231
    v_mul_f32 v237, v237, v231
    v_accvgpr_write_b32 a56, v234
    v_accvgpr_write_b32 a57, v235
    v_accvgpr_write_b32 a58, v236
    v_accvgpr_write_b32 a59, v237
    v_accvgpr_read_b32 v234, a80
    v_accvgpr_read_b32 v235, a81
    v_accvgpr_read_b32 v236, a82
    v_accvgpr_read_b32 v237, a83
    v_mul_f32 v234, v234, v231
    v_mul_f32 v235, v235, v231
    v_mul_f32 v236, v236, v231
    v_mul_f32 v237, v237, v231
    v_accvgpr_write_b32 a80, v234
    v_accvgpr_write_b32 a81, v235
    v_accvgpr_write_b32 a82, v236
    v_accvgpr_write_b32 a83, v237
    v_exp_f32 v226, v96
    v_exp_f32 v227, v97
    v_exp_f32 v228, v98
    v_exp_f32 v229, v99
    v_add_f32 v198, v226, v227
    v_cvt_pk_bf16_f32 v144, v226, v227
    v_exp_f32 v230, v100
    v_exp_f32 v231, v101
    v_add_f32 v198, v198, v228
    v_add_f32 v198, v198, v229
    v_cvt_pk_bf16_f32 v145, v228, v229
    v_exp_f32 v226, v102
    v_exp_f32 v227, v103
    v_add_f32 v199, v230, v231
    v_cvt_pk_bf16_f32 v148, v230, v231
    v_exp_f32 v228, v104
    v_exp_f32 v229, v105
    v_add_f32 v199, v199, v226
    v_add_f32 v199, v199, v227
    v_cvt_pk_bf16_f32 v149, v226, v227
    v_exp_f32 v230, v106
    v_exp_f32 v231, v107
    v_add_f32 v200, v228, v229
    v_cvt_pk_bf16_f32 v152, v228, v229
    v_exp_f32 v226, v108
    v_exp_f32 v227, v109
    v_add_f32 v200, v200, v230
    v_add_f32 v200, v200, v231
    v_cvt_pk_bf16_f32 v153, v230, v231
    v_exp_f32 v228, v110
    v_exp_f32 v229, v111
    v_add_f32 v198, v198, v226
    v_add_f32 v198, v198, v227
    v_cvt_pk_bf16_f32 v146, v226, v227
    v_exp_f32 v230, v112
    v_exp_f32 v231, v113
    v_add_f32 v198, v198, v228
    v_add_f32 v198, v198, v229
    v_cvt_pk_bf16_f32 v147, v228, v229
    v_exp_f32 v226, v114
    v_exp_f32 v227, v115
    v_add_f32 v199, v199, v230
    v_add_f32 v199, v199, v231
    v_cvt_pk_bf16_f32 v150, v230, v231
    v_exp_f32 v228, v116
    v_exp_f32 v229, v117
    v_add_f32 v199, v199, v226
    v_add_f32 v199, v199, v227
    v_cvt_pk_bf16_f32 v151, v226, v227
    v_exp_f32 v230, v118
    v_exp_f32 v231, v119
    v_add_f32 v200, v200, v228
    v_add_f32 v200, v200, v229
    v_cvt_pk_bf16_f32 v154, v228, v229
    v_add_f32 v201, v198, v199
    v_add_f32 v200, v200, v230
    v_add_f32 v200, v200, v231
    v_cvt_pk_bf16_f32 v155, v230, v231
    s_nop 1
    s_setpc_b64 s[54:55]
L_slow1:
    v_max3_f32 v226, v120, v121, v122
    v_max3_f32 v226, v226, v123, v132
    v_max3_f32 v226, v226, v133, v134
    v_max_f32 v226, v226, v135
    v_max3_f32 v227, v124, v125, v126
    v_max3_f32 v227, v227, v127, v136
    v_max3_f32 v227, v227, v137, v138
    v_max_f32 v227, v227, v139
    v_max3_f32 v228, v128, v129, v130
    v_max3_f32 v228, v228, v131, v140
    v_max3_f32 v228, v228, v141, v142
    v_max_f32 v228, v228, v143
    v_mov_b32 v229, v226
    v_mov_b32 v230, v227
    v_mov_b32 v231, v228
    s_nop 1
    v_permlane16_swap_b32 v226, v229
    v_permlane16_swap_b32 v227, v230
    v_permlane16_swap_b32 v228, v231
    v_max_f32 v226, v226, v229
    v_max_f32 v227, v227, v230
    v_max_f32 v228, v228, v231
    v_mov_b32 v229, v226
    v_mov_b32 v230, v227
    v_mov_b32 v231, v228
    s_nop 1
    v_permlane32_swap_b32 v226, v229
    v_permlane32_swap_b32 v227, v230
    v_permlane32_swap_b32 v228, v231
    v_max_f32 v226, v226, v229
    v_max_f32 v227, v227, v230
    v_max_f32 v228, v228, v231
    v_max_f32 v226, 0, v226
    v_max_f32 v227, 0, v227
    v_max_f32 v228, 0, v228
    v_exp_f32 v229, -v226
    v_exp_f32 v230, -v227
    v_exp_f32 v231, -v228
    v_sub_f32 v120, v120, v226
    v_sub_f32 v121, v121, v226
    v_sub_f32 v122, v122, v226
    v_sub_f32 v123, v123, v226
    v_sub_f32 v132, v132, v226
    v_sub_f32 v133, v133, v226
    v_sub_f32 v134, v134, v226
    v_sub_f32 v135, v135, v226
    v_sub_f32 v180, v180, v226
    v_sub_f32 v181, v181, v226
    v_sub_f32 v182, v182, v226
    v_sub_f32 v183, v183, v226
    v_mul_f32 v195, v195, v229
    v_mul_f32 v12, v12, v229
    v_mul_f32 v13, v13, v229
    v_mul_f32 v14, v14, v229
    v_mul_f32 v15, v15, v229
    v_mul_f32 v36, v36, v229
    v_mul_f32 v37, v37, v229
    v_mul_f32 v38, v38, v229
    v_mul_f32 v39, v39, v229
    v_mul_f32 v60, v60, v229
    v_mul_f32 v61, v61, v229
    v_mul_f32 v62, v62, v229
    v_mul_f32 v63, v63, v229
    v_mul_f32 v84, v84, v229
    v_mul_f32 v85, v85, v229
    v_mul_f32 v86, v86, v229
    v_mul_f32 v87, v87, v229
    v_accvgpr_read_b32 v234, a12
    v_accvgpr_read_b32 v235, a13
    v_accvgpr_read_b32 v236, a14
    v_accvgpr_read_b32 v237, a15
    v_mul_f32 v234, v234, v229
    v_mul_f32 v235, v235, v229
    v_mul_f32 v236, v236, v229
    v_mul_f32 v237, v237, v229
    v_accvgpr_write_b32 a12, v234
    v_accvgpr_write_b32 a13, v235
    v_accvgpr_write_b32 a14, v236
    v_accvgpr_write_b32 a15, v237
    v_accvgpr_read_b32 v234, a36
    v_accvgpr_read_b32 v235, a37
    v_accvgpr_read_b32 v236, a38
    v_accvgpr_read_b32 v237, a39
    v_mul_f32 v234, v234, v229
    v_mul_f32 v235, v235, v229
    v_mul_f32 v236, v236, v229
    v_mul_f32 v237, v237, v229
    v_accvgpr_write_b32 a36, v234
    v_accvgpr_write_b32 a37, v235
    v_accvgpr_write_b32 a38, v236
    v_accvgpr_write_b32 a39, v237
    v_accvgpr_read_b32 v234, a60
    v_accvgpr_read_b32 v235, a61
    v_accvgpr_read_b32 v236, a62
    v_accvgpr_read_b32 v237, a63
    v_mul_f32 v234, v234, v229
    v_mul_f32 v235, v235, v229
    v_mul_f32 v236, v236, v229
    v_mul_f32 v237, v237, v229
    v_accvgpr_write_b32 a60, v234
    v_accvgpr_write_b32 a61, v235
    v_accvgpr_write_b32 a62, v236
    v_accvgpr_write_b32 a63, v237
    v_accvgpr_read_b32 v234, a84
    v_accvgpr_read_b32 v235, a85
    v_accvgpr_read_b32 v236, a86
    v_accvgpr_read_b32 v237, a87
    v_mul_f32 v234, v234, v229
    v_mul_f32 v235, v235, v229
    v_mul_f32 v236, v236, v229
    v_mul_f32 v237, v237, v229
    v_accvgpr_write_b32 a84, v234
    v_accvgpr_write_b32 a85, v235
    v_accvgpr_write_b32 a86, v236
    v_accvgpr_write_b32 a87, v237
    v_sub_f32 v124, v124, v227
    v_sub_f32 v125, v125, v227
    v_sub_f32 v126, v126, v227
    v_sub_f32 v127, v127, v227
    v_sub_f32 v136, v136, v227
    v_sub_f32 v137, v137, v227
    v_sub_f32 v138, v138, v227
    v_sub_f32 v139, v139, v227
    v_sub_f32 v184, v184, v227
    v_sub_f32 v185, v185, v227
    v_sub_f32 v186, v186, v227
    v_sub_f32 v187, v187, v227
    v_mul_f32 v196, v196, v230
    v_mul_f32 v16, v16, v230
    v_mul_f32 v17, v17, v230
    v_mul_f32 v18, v18, v230
    v_mul_f32 v19, v19, v230
    v_mul_f32 v40, v40, v230
    v_mul_f32 v41, v41, v230
    v_mul_f32 v42, v42, v230
    v_mul_f32 v43, v43, v230
    v_mul_f32 v64, v64, v230
    v_mul_f32 v65, v65, v230
    v_mul_f32 v66, v66, v230
    v_mul_f32 v67, v67, v230
    v_mul_f32 v88, v88, v230
    v_mul_f32 v89, v89, v230
    v_mul_f32 v90, v90, v230
    v_mul_f32 v91, v91, v230
    v_accvgpr_read_b32 v234, a16
    v_accvgpr_read_b32 v235, a17
    v_accvgpr_read_b32 v236, a18
    v_accvgpr_read_b32 v237, a19
    v_mul_f32 v234, v234, v230
    v_mul_f32 v235, v235, v230
    v_mul_f32 v236, v236, v230
    v_mul_f32 v237, v237, v230
    v_accvgpr_write_b32 a16, v234
    v_accvgpr_write_b32 a17, v235
    v_accvgpr_write_b32 a18, v236
    v_accvgpr_write_b32 a19, v237
    v_accvgpr_read_b32 v234, a40
    v_accvgpr_read_b32 v235, a41
    v_accvgpr_read_b32 v236, a42
    v_accvgpr_read_b32 v237, a43
    v_mul_f32 v234, v234, v230
    v_mul_f32 v235, v235, v230
    v_mul_f32 v236, v236, v230
    v_mul_f32 v237, v237, v230
    v_accvgpr_write_b32 a40, v234
    v_accvgpr_write_b32 a41, v235
    v_accvgpr_write_b32 a42, v236
    v_accvgpr_write_b32 a43, v237
    v_accvgpr_read_b32 v234, a64
    v_accvgpr_read_b32 v235, a65
    v_accvgpr_read_b32 v236, a66
    v_accvgpr_read_b32 v237, a67
    v_mul_f32 v234, v234, v230
    v_mul_f32 v235, v235, v230
    v_mul_f32 v236, v236, v230
    v_mul_f32 v237, v237, v230
    v_accvgpr_write_b32 a64, v234
    v_accvgpr_write_b32 a65, v235
    v_accvgpr_write_b32 a66, v236
    v_accvgpr_write_b32 a67, v237
    v_accvgpr_read_b32 v234, a88
    v_accvgpr_read_b32 v235, a89
    v_accvgpr_read_b32 v236, a90
    v_accvgpr_read_b32 v237, a91
    v_mul_f32 v234, v234, v230
    v_mul_f32 v235, v235, v230
    v_mul_f32 v236, v236, v230
    v_mul_f32 v237, v237, v230
    v_accvgpr_write_b32 a88, v234
    v_accvgpr_write_b32 a89, v235
    v_accvgpr_write_b32 a90, v236
    v_accvgpr_write_b32 a91, v237
    v_sub_f32 v128, v128, v228
    v_sub_f32 v129, v129, v228
    v_sub_f32 v130, v130, v228
    v_sub_f32 v131, v131, v228
    v_sub_f32 v140, v140, v228
    v_sub_f32 v141, v141, v228
    v_sub_f32 v142, v142, v228
    v_sub_f32 v143, v143, v228
    v_sub_f32 v188, v188, v228
    v_sub_f32 v189, v189, v228
    v_sub_f32 v190, v190, v228
    v_sub_f32 v191, v191, v228
    v_mul_f32 v197, v197, v231
    v_mul_f32 v20, v20, v231
    v_mul_f32 v21, v21, v231
    v_mul_f32 v22, v22, v231
    v_mul_f32 v23, v23, v231
    v_mul_f32 v44, v44, v231
    v_mul_f32 v45, v45, v231
    v_mul_f32 v46, v46, v231
    v_mul_f32 v47, v47, v231
    v_mul_f32 v68, v68, v231
    v_mul_f32 v69, v69, v231
    v_mul_f32 v70, v70, v231
    v_mul_f32 v71, v71, v231
    v_mul_f32 v92, v92, v231
    v_mul_f32 v93, v93, v231
    v_mul_f32 v94, v94, v231
    v_mul_f32 v95, v95, v231
    v_accvgpr_read_b32 v234, a20
    v_accvgpr_read_b32 v235, a21
    v_accvgpr_read_b32 v236, a22
    v_accvgpr_read_b32 v237, a23
    v_mul_f32 v234, v234, v231
    v_mul_f32 v235, v235, v231
    v_mul_f32 v236, v236, v231
    v_mul_f32 v237, v237, v231
    v_accvgpr_write_b32 a20, v234
    v_accvgpr_write_b32 a21, v235
    v_accvgpr_write_b32 a22, v236
    v_accvgpr_write_b32 a23, v237
    v_accvgpr_read_b32 v234, a44
    v_accvgpr_read_b32 v235, a45
    v_accvgpr_read_b32 v236, a46
    v_accvgpr_read_b32 v237, a47
    v_mul_f32 v234, v234, v231
    v_mul_f32 v235, v235, v231
    v_mul_f32 v236, v236, v231
    v_mul_f32 v237, v237, v231
    v_accvgpr_write_b32 a44, v234
    v_accvgpr_write_b32 a45, v235
    v_accvgpr_write_b32 a46, v236
    v_accvgpr_write_b32 a47, v237
    v_accvgpr_read_b32 v234, a68
    v_accvgpr_read_b32 v235, a69
    v_accvgpr_read_b32 v236, a70
    v_accvgpr_read_b32 v237, a71
    v_mul_f32 v234, v234, v231
    v_mul_f32 v235, v235, v231
    v_mul_f32 v236, v236, v231
    v_mul_f32 v237, v237, v231
    v_accvgpr_write_b32 a68, v234
    v_accvgpr_write_b32 a69, v235
    v_accvgpr_write_b32 a70, v236
    v_accvgpr_write_b32 a71, v237
    v_accvgpr_read_b32 v234, a92
    v_accvgpr_read_b32 v235, a93
    v_accvgpr_read_b32 v236, a94
    v_accvgpr_read_b32 v237, a95
    v_mul_f32 v234, v234, v231
    v_mul_f32 v235, v235, v231
    v_mul_f32 v236, v236, v231
    v_mul_f32 v237, v237, v231
    v_accvgpr_write_b32 a92, v234
    v_accvgpr_write_b32 a93, v235
    v_accvgpr_write_b32 a94, v236
    v_accvgpr_write_b32 a95, v237
    v_exp_f32 v226, v120
    v_exp_f32 v227, v121
    v_exp_f32 v228, v122
    v_exp_f32 v229, v123
    v_add_f32 v222, v226, v227
    v_cvt_pk_bf16_f32 v156, v226, v227
    v_exp_f32 v230, v124
    v_exp_f32 v231, v125
    v_add_f32 v222, v222, v228
    v_add_f32 v222, v222, v229
    v_cvt_pk_bf16_f32 v157, v228, v229
    v_exp_f32 v226, v126
    v_exp_f32 v227, v127
    v_add_f32 v223, v230, v231
    v_cvt_pk_bf16_f32 v160, v230, v231
    v_exp_f32 v228, v128
    v_exp_f32 v229, v129
    v_add_f32 v223, v223, v226
    v_add_f32 v223, v223, v227
    v_cvt_pk_bf16_f32 v161, v226, v227
    v_exp_f32 v230, v130
    v_exp_f32 v231, v131
    v_add_f32 v224, v228, v229
    v_cvt_pk_bf16_f32 v164, v228, v229
    v_exp_f32 v226, v132
    v_exp_f32 v227, v133
    v_add_f32 v224, v224, v230
    v_add_f32 v224, v224, v231
    v_cvt_pk_bf16_f32 v165, v230, v231
    v_exp_f32 v228, v134
    v_exp_f32 v229, v135
    v_add_f32 v222, v222, v226
    v_add_f32 v222, v222, v227
    v_cvt_pk_bf16_f32 v158, v226, v227
    v_exp_f32 v230, v136
    v_exp_f32 v231, v137
    v_add_f32 v222, v222, v228
    v_add_f32 v222, v222, v229
    v_cvt_pk_bf16_f32 v159, v228, v229
    v_exp_f32 v226, v138
    v_exp_f32 v227, v139
    v_add_f32 v223, v223, v230
    v_add_f32 v223, v223, v231
    v_cvt_pk_bf16_f32 v162, v230, v231
    v_exp_f32 v228, v140
    v_exp_f32 v229, v141
    v_add_f32 v223, v223, v226
    v_add_f32 v223, v223, v227
    v_cvt_pk_bf16_f32 v163, v226, v227
    v_exp_f32 v230, v142
    v_exp_f32 v231, v143
    v_add_f32 v224, v224, v228
    v_add_f32 v224, v224, v229
    v_cvt_pk_bf16_f32 v166, v228, v229
    v_add_f32 v208, v222, v223
    v_add_f32 v224, v224, v230
    v_add_f32 v224, v224, v231
    v_cvt_pk_bf16_f32 v167, v230, v231
    s_nop 1
    s_setpc_b64 s[54:55]
.section .rodata,"a"
.p2align 6
.amdhsa_kernel attn_kernel
  .amdhsa_next_free_vgpr 512
  .amdhsa_next_free_sgpr 102
  .amdhsa_accum_offset 256
  .amdhsa_group_segment_fixed_size 0
  .amdhsa_kernarg_size 64
  .amdhsa_user_sgpr_count 2
  .amdhsa_user_sgpr_kernarg_segment_ptr 1
  .amdhsa_system_sgpr_workgroup_id_x 1
.end_amdhsa_kernel
```
